```python
import torch

def _softmax(x, axis=-1):
    return torch.softmax(x, dim=axis)
def _gelu(x):
    return torch.nn.functional.gelu(x, approximate="tanh")
def _silu(x):
    return torch.nn.functional.silu(x)
def _sigmoid(x):
    return torch.sigmoid(x)
def _layernorm(x, axis=-1, eps=1e-5):
    m = x.mean(dim=axis, keepdim=True)
    v = x.var(dim=axis, keepdim=True, unbiased=False)
    return (x - m) / torch.sqrt(v + eps)
def _scatter_add(tgt, idx, src, axis=0):
    return tgt.clone().index_add_(axis, idx, src)
def _segment_sum(src, seg, n):
    out = torch.zeros((n,) + src.shape[1:], dtype=src.dtype)
    return out.index_add_(0, seg, src)
def _pad(x, pw):
    flat = tuple(v for pair in reversed(pw) for v in pair)
    return torch.nn.functional.pad(x, flat)

kernel_name = 'recurrent_scan__sliding_block_cached__glu_gated_swiglu__prompt'

def setup_inputs():

    _w = (lambda a: (lambda t: t.to(torch.bfloat16) if t.is_floating_point() else t)(torch.as_tensor(a)))
    def _A_setup():
        B, Sq, D = 1, 2048, 640
        Hq, Hkv, Sk, Dh = 32, 32, 2048, 128
        assert Hq % Hkv == 0, (Hq, Hkv)
        return {
            "x": _w((lambda *s: torch.randn(*s, dtype=torch.bfloat16) * 0.05)(B, Sq, D)),
            "k_cache": _w((lambda *s: torch.randn(*s, dtype=torch.bfloat16) * 1.6)(B, Hkv, Sk, Dh)),
            "v_cache": _w((lambda *s: torch.randn(*s, dtype=torch.bfloat16) * 1.6)(B, Hkv, Sk, Dh)),
            "wq": _w((lambda *s: torch.randn(*s, dtype=torch.bfloat16) * 1.6)(D, Hq * Dh) * (D ** -0.5)),
            "wo": _w((lambda *s: torch.randn(*s, dtype=torch.bfloat16) * 1.6)(Hq * Dh, D) * ((Hq * Dh) ** -0.5)),
        }
    _A_in = _A_setup()

    def _B_setup():
        B, S, D, F = 1, 2048, 640, 1728
        return {
            "x": _w((lambda *s: torch.randn(*s, dtype=torch.bfloat16) * 0.05)(B, S, D)),
            "w1": _w((lambda *s: torch.randn(*s, dtype=torch.bfloat16) * 0.2)(D, F) * (2.0 / D) ** 0.5),
            "w3": _w((lambda *s: torch.randn(*s, dtype=torch.bfloat16) * 0.2)(D, F) * (2.0 / D) ** 0.5),
            "w2": _w((lambda *s: torch.randn(*s, dtype=torch.bfloat16) * 0.2)(F, D) * (2.0 / F) ** 0.5),
        }
    _B_in = _B_setup()

    return {
        "A_x": _A_in["x"],
        "A_k_cache": _A_in["k_cache"],
        "A_v_cache": _A_in["v_cache"],
        "A_wq": _A_in["wq"],
        "A_wo": _A_in["wo"],
        "B_x": _B_in["x"],
        "B_w1": _B_in["w1"],
        "B_w3": _B_in["w3"],
        "B_w2": _B_in["w2"],
    }

def reference(A_x, A_k_cache, A_v_cache, A_wq, A_wo, B_x, B_w1, B_w3, B_w2):
    def _A_ref(x, k_cache, v_cache, wq, wo):
        B, Sq, D = x.shape
        Hq, Dh = 32, 128
        Hkv, Sk = k_cache.shape[1], k_cache.shape[2]
        W = min(4096, max(256, Sk // 4))
        rep = Hq // Hkv
        q = (lambda x, *d: x.permute(*d))((x @ wq).reshape(B, Sq, Hq, Dh), 0, 2, 1, 3)
        k = (lambda x, n, axis: torch.repeat_interleave(x, n, dim=axis))(k_cache[:, :, Sk - W:, :], rep, axis=1)
        v = (lambda x, n, axis: torch.repeat_interleave(x, n, dim=axis))(v_cache[:, :, Sk - W:, :], rep, axis=1)
        scores = torch.einsum("bhqd,bhkd->bhqk", q, k) * (Dh ** -0.5)
        p = _softmax(scores, axis=-1)
        o = torch.einsum("bhqk,bhkd->bhqd", p, v)
        return (lambda x, *d: x.permute(*d))(o, 0, 2, 1, 3).reshape(B, Sq, Hq * Dh) @ wo

    def _B_ref(x, w1, w3, w2):
        gate = torch.einsum("bsd,df->bsf", x, w1)
        up = torch.einsum("bsd,df->bsf", x, w3)
        h = _silu(gate) * up
        out = torch.einsum("bsf,fd->bsd", h, w2)
        return out

    x = A_x
    xn = _layernorm(x, axis=-1)
    s = _A_ref(xn, A_k_cache, A_v_cache, A_wq, A_wo)
    g = _silu(_B_ref(xn, B_w1, B_w3, B_w2))
    return x + s * g
```

```asm
; @launch grid=(256,1,1) block=(256,1,1) lds=163840
.amdgcn_target "amdgcn-amd-amdhsa--gfx950"
.text
.globl recurrent_scan__sliding_block_cached__glu_gated_swiglu__prompt_kernel
.p2align 8
.type recurrent_scan__sliding_block_cached__glu_gated_swiglu__prompt_kernel,@function
recurrent_scan__sliding_block_cached__glu_gated_swiglu__prompt_kernel:
    s_cmp_ge_u32 s2, 256
    s_cbranch_scc1 p1_end
    s_load_dwordx16 s[64:79], s[0:1], 0
    s_load_dwordx8 s[80:87], s[0:1], 64
    s_memrealtime s[100:101]
    v_and_b32 v1, 63, v0
    v_lshrrev_b32 v0, 6, v0
    s_and_b32 s6, s2, 7
    v_readfirstlane_b32 s48, v0
    s_lshr_b32 s61, s2, 3
    s_lshr_b32 s50, s61, 2
    s_and_b32 s62, s61, 3
    s_getpc_b64 s[4:5]
p1_pc:
    s_lshl2_add_u32 s7, s61, s48
    s_mul_i32 s7, s7, (p1_last-p1_pc)/1024
    s_lshr_b32 s7, s7, 7
    s_lshl_b32 s7, s7, 10
    v_lshl_add_u32 v48, v1, 4, s7
    global_load_dwordx4 a[240:243], v48, s[4:5]
    s_lshl2_add_u32 s49, s6, s62
    s_sub_u32 s63, s6, s50
    s_add_u32 s63, s63, 3
    s_and_b32 s63, s63, 7
    s_mul_i32 s51, s6, 3
    s_add_u32 s51, s51, s62
    s_add_u32 s7, s63, 24
    s_cmp_eq_u32 s62, 3
    s_cselect_b32 s51, s7, s51
    s_cmp_lt_u32 s51, 27
    s_cselect_b32 s52, 1, 0
    s_sub_u32 s4, s51, 27
    v_lshrrev_b32 v51, 3, v1
    v_and_b32 v50, 7, v1
    v_lshrrev_b32 v56, 4, v1
    v_xor_b32 v57, v50, v56
    v_lshlrev_b32 v57, 4, v57
    s_movk_i32 s6, 1280
    v_mad_u32_u24 v2, v51, s6, v57
    v_xor_b32_e64 v57, 64, v2
    v_add_u32 v3, 9216, v57
    v_add_u32 v4, 18432, v2
    v_add_u32 v5, 27648, v57
    v_add_u32 v6, 40960, v2
    v_add_u32 v7, 50176, v57
    v_add_u32 v8, 59392, v2
    v_add_u32 v9, 68608, v57
    s_lshl2_add_u32 s6, s50, s48
    s_mul_i32 s53, s6, 81920
    s_mul_i32 s88, s6, 745472
    s_lshl_b32 s56, s48, 13
    s_add_u32 s56, s56, 32768
    s_mov_b32 s59, 0
    s_and_b32 s6, s48, 1
    s_lshl_b32 s7, s6, 2
    v_add_u32 v57, s7, v56
    v_lshlrev_b32 v57, 1, v57
    v_and_b32 v58, 15, v1
    v_xor_b32 v57, v57, v58
    v_lshlrev_b32 v57, 4, v57
    s_lshl_b32 s7, s48, 3
    v_add_u32 v59, s7, v56
    v_lshl_add_u32 v10, v59, 13, v57
    v_add_u32 v11, 31744, v10
    v_bfe_u32 v57, v1, 4, 1
    s_lshl_b32 s6, s6, 1
    v_add_u32 v57, s6, v57
    v_lshlrev_b32 v57, 1, v57
    v_xor_b32 v57, v57, v50
    v_lshlrev_b32_e64 v57, 4, v57
    v_add_u32 v59, s7, v51
    s_movk_i32 s6, 3456
    v_mad_u32_u24 v12, v59, s6, v57
    s_lshl_b32 s54, s49, 8
    s_lshl_b32 s55, s51, 7
    s_mov_b32 s60, 0
    s_lshl_b32 s57, s48, 12
    s_add_u32 s57, s57, 98304
    s_mov_b32 s10, 2621440
    s_mov_b32 s11, 0x20000
    s_mov_b32 s14, 5242880
    s_mov_b32 s15, 0x20000
    s_mul_i32 s18, s52, 2213888
    s_mov_b32 s19, 0x20000
    s_mul_i32 s22, s52, 2214912
    s_mov_b32 s23, 0x20000
    s_waitcnt lgkmcnt(0)
    s_mov_b32 s95, s57
    s_mov_b32 s8, s64
    s_and_b32 s9, s65, 0xffff
    s_mov_b32 s12, s70
    s_and_b32 s13, s71, 0xffff
    s_sub_u32 s16, s76, 2048
    s_subb_u32 s17, s77, 0
    s_and_b32 s17, s17, 0xffff
    s_sub_u32 s20, s78, 3072
    s_subb_u32 s21, s79, 0
    s_and_b32 s21, s21, 0xffff
    s_mov_b64 s[76:77], s[8:9]
    s_mov_b64 s[78:79], s[10:11]
    s_movk_i32 s74, 4096
    s_movk_i32 s75, 128
    s_mov_b32 s3, 0x18000
    v_mov_b32 v49, 0
    s_cmp_ge_u32 s4, 4
    s_cbranch_scc0 p1_c1
p1_np1:
    s_max_u32 m0, s57, s59
    s_nop 0
    buffer_load_dwordx4 v10, s[12:15], s54 offen lds
    buffer_load_dwordx4 v11, s[12:15], s54 offen offset:1024 lds
    buffer_load_dwordx4 v12, s[16:19], s55 offen offset:2048 lds
    buffer_load_dwordx4 v12, s[20:23], s55 offen offset:3072 lds
    s_add_u32 s54, s54, 262144
    s_add_u32 s55, s55, 110592
    s_add_u32 s60, s60, 16384
    s_and_b32 s60, s60, 0xffff
    s_add_u32 s57, s60, s95
    s_mov_b32 m0, s56
    s_nop 0
    buffer_load_dwordx4 v2, s[8:11], s53 offen offset:0 lds
    buffer_load_dwordx4 v3, s[8:11], s53 offen offset:1024 lds
    buffer_load_dwordx4 v4, s[8:11], s53 offen offset:2048 lds
    buffer_load_dwordx4 v5, s[8:11], s53 offen offset:3072 lds
    s_add_u32 s32, s86, s88
    s_addc_u32 s33, s87, 0
    s_and_b32 s33, s33, 0xffff
    s_mov_b32 s34, 745472
    s_mov_b32 s35, 0x20000
    s_add_u32 s36, s86, 25165824
    s_addc_u32 s37, s87, 0
    s_and_b32 s37, s37, 0xffff
    s_mov_b32 s38, 7454720
    s_mov_b32 s39, 0x20000
    s_lshl2_add_u32 s62, s49, s48
    s_mul_i32 s92, s62, 10
    s_lshl_b32 s63, s50, 1
    s_add_u32 s92, s92, s63
    s_mul_i32 s62, s62, 40960
    s_lshl_b32 s63, s50, 8
    s_add_u32 s5, s62, s63
    s_mov_b32 s40, s72
    s_and_b32 s41, s73, 0xffff
    s_mov_b32 s42, 5242880
    s_mov_b32 s43, 0x20000
    s_cmp_lt_u32 s50, 5
    s_cselect_b32 s42, s42, 0
    s_cselect_b32 s92, s92, 2000
    v_mov_b32 v50, 0
    s_or_b32 s6, s2, s48
    s_cbranch_scc1 p1_ntag
    s_lshl_b64 s[6:7], s[100:101], 2
    s_or_b32 s7, s7, 0x80000000
    v_mov_b32_e64 v58, s6
    v_mov_b32 v59, s7
    s_mov_b64 exec, 1
    global_store_dwordx2 v50, v[58:59], s[84:85] offset:128 sc1
    s_mov_b64 exec, -1
p1_ntag:
    v_and_b32 v58, 15, v1
    v_lshrrev_b32 v57, 1, v58
    v_xor_b32 v57, v57, v56
    v_lshlrev_b32 v57, 4, v57
    v_lshl_add_u32 v57, v58, 7, v57
    s_lshl_b32 s6, s48, 13
    s_add_u32 s6, s6, 32768
    v_add_u32 v13, s6, v57
    v_xor_b32 v14, 64, v13
    v_lshlrev_b32_e64 v47, 4, v58
    v_bfe_u32 v58, v1, 2, 2
    v_and_b32 v59, 3, v1
    v_lshlrev_b32 v59, 3, v59
    v_lshl_add_u32 v59, v56, 12, v59
    v_add_u32 v59, 98304, v59
    v_bfe_u32 v60, v1, 4, 1
    v_lshl_add_u32 v57, v60, 2, v58
    s_lshl_b32 s6, s48, 1
    v_xor_b32 v57, s6, v57
    v_lshl_add_u32 v57, v57, 5, v59
    v_lshl_add_u32 v15, v58, 8, v57
    v_xor_b32 v16, 32, v15
    v_xor_b32 v17, 64, v15
    v_xor_b32 v18, 96, v15
    v_xor_b32 v19, 128, v15
    v_xor_b32 v20, 160, v15
    v_xor_b32 v21, 192, v15
    v_xor_b32 v22, 224, v15
    v_lshrrev_b32_e64 v57, 1, v58
    v_lshl_add_u32 v57, v60, 1, v57
    v_xor_b32_e64 v57, s48, v57
    v_lshl_add_u32 v57, v57, 5, v59
    v_lshl_add_u32 v23, v58, 7, v57
    v_xor_b32_e64 v24, 32, v23
    v_xor_b32 v25, 64, v23
    v_xor_b32 v26, 96, v23
    s_mov_b32 s24, s66
    s_and_b32 s25, s67, 0xffff
    s_mov_b32 s26, 16777216
    s_mov_b32 s27, 0x20000
    s_mov_b32 s28, s68
    s_and_b32 s29, s69, 0xffff
    s_mov_b32 s30, 16777216
    s_mov_b32 s31, 0x20000
    s_add_u32 s44, s86, 33554432
    s_addc_u32 s45, s87, 0
    s_and_b32 s45, s45, 0xffff
    s_mov_b32 s46, 32768
    s_mov_b32 s47, 0x20000
    s_lshl_b32 s6, s50, 2
    v_mov_b32 v46, s6
    s_movk_i32 s93, 384
    s_mov_b32 s58, 0
    s_cmp_ge_u32 s4, 4
    s_cbranch_scc0 p1_c2
p1_np2:
    v_lshrrev_b32 v56, 4, v1
    v_and_b32 v58, 15, v1
    v_xor_b32 v57, v58, v56
    v_lshlrev_b32 v57, 4, v57
    v_lshl_add_u32 v64, v56, 8, v57
    v_xor_b32_e64 v65, 64, v64
    v_xor_b32 v66, 128, v64
    v_xor_b32 v67, 192, v64
    v_lshlrev_b32 v57, 2, v56
    v_xor_b32 v57, v57, v58
    v_lshlrev_b32_e64 v57, 4, v57
    v_lshl_add_u32 v68, v56, 8, v57
    s_mov_b32 s62, 0
    v_and_b32 v56, 31, v1
    v_lshrrev_b32 v57, 5, v1
    v_and_b32 v58, 15, v1
    v_xor_b32 v58, v58, v57
    s_lshl_b32 s61, s48, 2
    v_xor_b32 v58, s61, v58
    v_lshlrev_b32 v58, 4, v58
    v_lshl_add_u32 v58, v56, 8, v58
    v_add_u32_e64 v69, s62, v58
    v_bfe_u32 v56, v1, 2, 2
    v_lshl_add_u32 v58, v57, 2, v56
    v_lshlrev_b32_e64 v58, 8, v58
    v_lshl_add_u32 v58, v56, 6, v58
    v_bfe_u32 v59, v1, 1, 1
    v_lshl_add_u32 v58, v59, 5, v58
    v_bfe_u32 v59, v1, 4, 1
    v_lshl_add_u32 v58, v59, 4, v58
    v_and_b32_e64 v59, 1, v1
    v_lshl_add_u32 v58, v59, 3, v58
    s_add_u32 s61, s62, 16384
    v_add_u32_e64 v70, s61, v58
    v_bfe_u32 v58, v1, 2, 2
    v_bfe_u32 v60, v1, 4, 1
    v_lshl_add_u32 v58, v60, 2, v58
    v_lshrrev_b32 v57, 1, v58
    v_lshlrev_b32 v57, 5, v57
    v_lshl_add_u32 v57, v58, 7, v57
    v_lshrrev_b32_e64 v59, 5, v1
    v_lshl_add_u32 v57, v59, 10, v57
    v_and_b32 v59, 3, v1
    v_lshl_add_u32 v57, v59, 3, v57
    s_lshl_b32 s6, s48, 13
    s_add_u32 s6, s6, 131072
    v_add_u32 v71, s6, v57
    v_lshrrev_b32 v56, 4, v1
    v_lshlrev_b32 v56, 1, v56
    v_and_b32 v57, 7, v1
    v_xor_b32 v56, v56, v57
    v_lshlrev_b32 v56, 4, v56
    v_lshrrev_b32_e64 v57, 3, v1
    v_mul_u32_u24 v57, 1280, v57
    v_add_u32 v72, v56, v57
    v_mov_b32 v57, v69
    v_mov_b32 v58, v70
    v_mov_b32 v59, v71
    v_mov_b32 v56, v72
    v_lshrrev_b32 v51, 4, v1
    v_lshlrev_b32 v51, 4, v51
    s_lshl_b32 s6, s48, 7
    s_add_u32 s6, s6, 98304
    v_add_u32 v52, s6, v51
    s_lshl_b32 s6, s48, 6
    s_add_u32 s6, s6, 98816
    v_add_u32_e64 v53, s6, v51
    v_lshlrev_b32 v54, 4, v1
    s_lshl_b32 s6, s48, 12
    s_lshl_b32 s88, s49, 19
    s_add_u32 s88, s88, s6
    s_add_u32 s88, s88, 393216
    v_mov_b32 v28, 0
    v_mov_b32 v29, 0
    v_mov_b32 v30, 0
    v_mov_b32 v31, 0
    v_mov_b32 v45, 0x3f803f80
    v_accvgpr_write_b32 a192, v45
    v_accvgpr_write_b32 a193, v45
    v_accvgpr_write_b32 a194, v45
    v_accvgpr_write_b32 a195, v45
    v_mfma_f32_32x32x16_bf16 v[128:143], v[28:31], v[28:31], 0
    v_mfma_f32_32x32x16_bf16 v[144:159], v[28:31], v[28:31], 0
    v_mfma_f32_32x32x16_bf16 v[160:175], v[28:31], v[28:31], 0
    v_mfma_f32_32x32x16_bf16 v[176:191], v[28:31], v[28:31], 0
    v_mfma_f32_32x32x16_bf16 v[192:207], v[28:31], v[28:31], 0
    v_mfma_f32_32x32x16_bf16 v[208:223], v[28:31], v[28:31], 0
    v_mfma_f32_32x32x16_bf16 v[224:239], v[28:31], v[28:31], 0
    v_mfma_f32_32x32x16_bf16 v[240:255], v[28:31], v[28:31], 0
    v_mfma_f32_32x32x16_bf16 a[0:15], v[28:31], v[28:31], 0
    v_mfma_f32_32x32x16_bf16 a[16:31], v[28:31], v[28:31], 0
    v_mfma_f32_32x32x16_bf16 a[32:47], v[28:31], v[28:31], 0
    v_mfma_f32_32x32x16_bf16 a[48:63], v[28:31], v[28:31], 0
    v_mfma_f32_32x32x16_bf16 a[64:79], v[28:31], v[28:31], 0
    v_mfma_f32_32x32x16_bf16 a[80:95], v[28:31], v[28:31], 0
    v_mfma_f32_32x32x16_bf16 a[96:111], v[28:31], v[28:31], 0
    v_mfma_f32_32x32x16_bf16 a[112:127], v[28:31], v[28:31], 0
    v_mfma_f32_32x32x16_bf16 a[128:143], v[28:31], v[28:31], 0
    s_add_u32 m0, s56, s74
    s_nop 0
    buffer_load_dwordx4 v6, s[76:79], s53 offen offset:0 lds
    buffer_load_dwordx4 v7, s[76:79], s53 offen offset:1024 lds
    buffer_load_dwordx4 v8, s[76:79], s53 offen offset:2048 lds
    buffer_load_dwordx4 v9, s[76:79], s53 offen offset:3072 lds
    s_add_u32 s53, s53, s75
    s_xor_b32 s56, s56, s3
    s_max_u32 m0, s57, s59
    s_nop 0
    buffer_load_dwordx4 v10, s[12:15], s54 offen lds
    buffer_load_dwordx4 v11, s[12:15], s54 offen offset:1024 lds
    buffer_load_dwordx4 v12, s[16:19], s55 offen offset:2048 lds
    buffer_load_dwordx4 v12, s[20:23], s55 offen offset:3072 lds
    s_add_u32 s54, s54, 262144
    s_add_u32 s55, s55, 110592
    s_add_u32 s60, s60, 16384
    s_and_b32 s60, s60, 0xffff
    s_add_u32 s57, s60, s95
    s_mov_b32 m0, s56
    s_nop 0
    buffer_load_dwordx4 v2, s[8:11], s53 offen offset:0 lds
    buffer_load_dwordx4 v3, s[8:11], s53 offen offset:1024 lds
    buffer_load_dwordx4 v4, s[8:11], s53 offen offset:2048 lds
    buffer_load_dwordx4 v5, s[8:11], s53 offen offset:3072 lds
    s_max_u32 m0, s57, s59
    s_nop 0
    buffer_load_dwordx4 v10, s[12:15], s54 offen lds
    buffer_load_dwordx4 v11, s[12:15], s54 offen offset:1024 lds
    buffer_load_dwordx4 v12, s[16:19], s55 offen offset:2048 lds
    buffer_load_dwordx4 v12, s[20:23], s55 offen offset:3072 lds
    s_add_u32 s54, s54, 262144
    s_add_u32 s55, s55, 110592
    s_add_u32 s60, s60, 16384
    s_and_b32 s60, s60, 0xffff
    s_add_u32 s57, s60, s95
    s_waitcnt vmcnt(12)
    s_barrier
    s_lshl2_add_u32 s6, s4, s48
    s_and_b32 s6, s6, 0xfffffff3
    s_cbranch_scc1 p1_np3
    v_mov_b32 v45, 1
    v_add_u32 v51, s4, v46
    s_mov_b64 exec, 1
    global_store_byte v51, v45, s[84:85] sc1
    s_mov_b64 exec, -1
p1_np3:
    ds_read_b128 a[144:147], v13 offset:0
    ds_read_b128 a[148:151], v13 offset:2048
    ds_read_b128 a[152:155], v13 offset:4096
    ds_read_b128 a[156:159], v13 offset:6144
    s_cmp_eq_u32 s52, 0
    ds_read_b64_tr_b16 a[176:177], v15 offset:0
    ds_read_b64_tr_b16 a[178:179], v15 offset:1024
    ds_read_b64_tr_b16 a[180:181], v16 offset:0
    ds_read_b64_tr_b16 a[182:183], v16 offset:1024
    ds_read_b64_tr_b16 a[184:185], v17 offset:0
    ds_read_b64_tr_b16 a[186:187], v17 offset:1024
    s_waitcnt lgkmcnt(6)
    s_cbranch_scc1 p1_gn
.p2align 6
p1_gf:
    s_waitcnt lgkmcnt(4)
    v_mfma_f32_16x16x32_bf16 v[128:131], a[176:179], a[144:147], v[128:131]
    ds_read_b64_tr_b16 a[188:189], v18 offset:0
    v_mfma_f32_16x16x32_bf16 v[132:135], a[176:179], a[148:151], v[132:135]
    ds_read_b64_tr_b16 a[190:191], v18 offset:1024
    v_mfma_f32_16x16x32_bf16 v[136:139], a[176:179], a[152:155], v[136:139]
    ds_read_b128 a[160:163], v14 offset:0
    v_mfma_f32_16x16x32_bf16 v[140:143], a[176:179], a[156:159], v[140:143]
    v_mfma_f32_16x16x32_bf16 a[128:131], a[176:179], a[192:195], a[128:131]
    s_waitcnt lgkmcnt(5)
    v_mfma_f32_16x16x32_bf16 v[156:159], a[180:183], a[156:159], v[156:159]
    ds_read_b64_tr_b16 a[176:177], v19 offset:0
    v_mfma_f32_16x16x32_bf16 v[152:155], a[180:183], a[152:155], v[152:155]
    ds_read_b64_tr_b16 a[178:179], v19 offset:1024
    s_add_u32 m0, s56, s74
    v_mfma_f32_16x16x32_bf16 v[148:151], a[180:183], a[148:151], v[148:151]
    ds_read_b128 a[164:167], v14 offset:2048
    v_mfma_f32_16x16x32_bf16 v[144:147], a[180:183], a[144:147], v[144:147]
    v_mfma_f32_16x16x32_bf16 a[132:135], a[180:183], a[192:195], a[132:135]
    s_waitcnt lgkmcnt(6)
    v_mfma_f32_16x16x32_bf16 v[160:163], a[184:187], a[144:147], v[160:163]
    ds_read_b64_tr_b16 a[180:181], v20 offset:0
    v_mfma_f32_16x16x32_bf16 v[164:167], a[184:187], a[148:151], v[164:167]
    ds_read_b64_tr_b16 a[182:183], v20 offset:1024
    v_mfma_f32_16x16x32_bf16 v[168:171], a[184:187], a[152:155], v[168:171]
    buffer_load_dwordx4 v6, s[76:79], s53 offen offset:0 lds
    v_mfma_f32_16x16x32_bf16 v[172:175], a[184:187], a[156:159], v[172:175]
    v_xor_b32 v13, 0x18000, v13
    s_waitcnt lgkmcnt(6)
    v_mfma_f32_16x16x32_bf16 v[188:191], a[188:191], a[156:159], v[188:191]
    ds_read_b64_tr_b16 a[184:185], v21 offset:0
    v_mfma_f32_16x16x32_bf16 v[184:187], a[188:191], a[152:155], v[184:187]
    ds_read_b64_tr_b16 a[186:187], v21 offset:1024
    v_mfma_f32_16x16x32_bf16 v[180:183], a[188:191], a[148:151], v[180:183]
    buffer_load_dwordx4 v7, s[76:79], s53 offen offset:1024 lds
    v_mfma_f32_16x16x32_bf16 v[176:179], a[188:191], a[144:147], v[176:179]
    s_waitcnt lgkmcnt(5)
    v_mfma_f32_16x16x32_bf16 v[192:195], a[176:179], a[144:147], v[192:195]
    ds_read_b64_tr_b16 a[188:189], v22 offset:0
    v_mfma_f32_16x16x32_bf16 v[196:199], a[176:179], a[148:151], v[196:199]
    ds_read_b64_tr_b16 a[190:191], v22 offset:1024
    v_mfma_f32_16x16x32_bf16 v[200:203], a[176:179], a[152:155], v[200:203]
    buffer_load_dwordx4 v8, s[76:79], s53 offen offset:2048 lds
    v_mfma_f32_16x16x32_bf16 v[204:207], a[176:179], a[156:159], v[204:207]
    s_waitcnt lgkmcnt(4)
    v_mfma_f32_16x16x32_bf16 v[220:223], a[180:183], a[156:159], v[220:223]
    ds_read_b64_tr_b16 a[176:177], v23 offset:2048
    v_mfma_f32_16x16x32_bf16 v[216:219], a[180:183], a[152:155], v[216:219]
    ds_read_b64_tr_b16 a[178:179], v23 offset:2560
    v_mfma_f32_16x16x32_bf16 v[212:215], a[180:183], a[148:151], v[212:215]
    buffer_load_dwordx4 v9, s[76:79], s53 offen offset:3072 lds
    v_mfma_f32_16x16x32_bf16 v[208:211], a[180:183], a[144:147], v[208:211]
    s_waitcnt lgkmcnt(4)
    v_mfma_f32_16x16x32_bf16 v[224:227], a[184:187], a[144:147], v[224:227]
    ds_read_b64_tr_b16 a[180:181], v23 offset:3072
    v_mfma_f32_16x16x32_bf16 v[228:231], a[184:187], a[148:151], v[228:231]
    ds_read_b64_tr_b16 a[182:183], v23 offset:3584
    s_add_u32 s53, s53, s75
    s_xor_b32 s56, s56, s3
    v_mfma_f32_16x16x32_bf16 v[232:235], a[184:187], a[152:155], v[232:235]
    ds_read_b128 a[168:171], v14 offset:4096
    v_mfma_f32_16x16x32_bf16 v[236:239], a[184:187], a[156:159], v[236:239]
    s_waitcnt lgkmcnt(5)
    v_mfma_f32_16x16x32_bf16 v[252:255], a[188:191], a[156:159], v[252:255]
    ds_read_b64_tr_b16 a[184:185], v24 offset:2048
    v_mfma_f32_16x16x32_bf16 v[248:251], a[188:191], a[152:155], v[248:251]
    ds_read_b64_tr_b16 a[186:187], v24 offset:2560
    s_max_u32 m0, s57, s59
    v_mfma_f32_16x16x32_bf16 v[244:247], a[188:191], a[148:151], v[244:247]
    ds_read_b128 a[172:175], v14 offset:6144
    v_mfma_f32_16x16x32_bf16 v[240:243], a[188:191], a[144:147], v[240:243]
    s_waitcnt lgkmcnt(6)
    v_mfma_f32_16x16x32_bf16 a[0:3], a[176:179], a[144:147], a[0:3]
    ds_read_b64_tr_b16 a[188:189], v24 offset:3072
    v_mfma_f32_16x16x32_bf16 a[4:7], a[176:179], a[148:151], a[4:7]
    ds_read_b64_tr_b16 a[190:191], v24 offset:3584
    v_mfma_f32_16x16x32_bf16 a[8:11], a[176:179], a[152:155], a[8:11]
    buffer_load_dwordx4 v10, s[12:15], s54 offen lds
    v_mfma_f32_16x16x32_bf16 a[12:15], a[176:179], a[156:159], a[12:15]
    v_mfma_f32_16x16x32_bf16 a[136:139], a[176:179], a[192:195], a[136:139]
    s_waitcnt lgkmcnt(6)
    v_mfma_f32_16x16x32_bf16 a[76:79], a[180:183], a[156:159], a[76:79]
    ds_read_b64_tr_b16 a[176:177], v25 offset:2048
    v_mfma_f32_16x16x32_bf16 a[72:75], a[180:183], a[152:155], a[72:75]
    ds_read_b64_tr_b16 a[178:179], v25 offset:2560
    v_mfma_f32_16x16x32_bf16 a[68:71], a[180:183], a[148:151], a[68:71]
    buffer_load_dwordx4 v11, s[12:15], s54 offen offset:1024 lds
    v_mfma_f32_16x16x32_bf16 a[64:67], a[180:183], a[144:147], a[64:67]
    v_mfma_f32_16x16x32_bf16 a[140:143], a[180:183], a[192:195], a[140:143]
    s_waitcnt lgkmcnt(5)
    v_mfma_f32_16x16x32_bf16 a[16:19], a[184:187], a[144:147], a[16:19]
    ds_read_b64_tr_b16 a[180:181], v25 offset:3072
    v_mfma_f32_16x16x32_bf16 a[20:23], a[184:187], a[148:151], a[20:23]
    ds_read_b64_tr_b16 a[182:183], v25 offset:3584
    v_mfma_f32_16x16x32_bf16 a[24:27], a[184:187], a[152:155], a[24:27]
    buffer_load_dwordx4 v12, s[16:19], s55 offen offset:2048 lds
    v_mfma_f32_16x16x32_bf16 a[28:31], a[184:187], a[156:159], a[28:31]
    s_waitcnt lgkmcnt(4)
    v_mfma_f32_16x16x32_bf16 a[92:95], a[188:191], a[156:159], a[92:95]
    ds_read_b64_tr_b16 a[184:185], v26 offset:2048
    v_mfma_f32_16x16x32_bf16 a[88:91], a[188:191], a[152:155], a[88:91]
    ds_read_b64_tr_b16 a[186:187], v26 offset:2560
    v_mfma_f32_16x16x32_bf16 a[84:87], a[188:191], a[148:151], a[84:87]
    buffer_load_dwordx4 v12, s[20:23], s55 offen offset:3072 lds
    v_mfma_f32_16x16x32_bf16 a[80:83], a[188:191], a[144:147], a[80:83]
    s_waitcnt lgkmcnt(4)
    v_mfma_f32_16x16x32_bf16 a[32:35], a[176:179], a[144:147], a[32:35]
    ds_read_b64_tr_b16 a[188:189], v26 offset:3072
    v_mfma_f32_16x16x32_bf16 a[36:39], a[176:179], a[148:151], a[36:39]
    ds_read_b64_tr_b16 a[190:191], v26 offset:3584
    s_add_u32 s54, s54, 262144
    s_add_u32 s55, s55, 110592
    v_mfma_f32_16x16x32_bf16 a[40:43], a[176:179], a[152:155], a[40:43]
    v_mfma_f32_16x16x32_bf16 a[44:47], a[176:179], a[156:159], a[44:47]
    s_waitcnt lgkmcnt(4)
    v_mfma_f32_16x16x32_bf16 a[108:111], a[180:183], a[156:159], a[108:111]
    v_mfma_f32_16x16x32_bf16 a[104:107], a[180:183], a[152:155], a[104:107]
    s_add_u32 s60, s60, 16384
    s_and_b32 s60, s60, 0xffff
    s_add_u32 s57, s60, s95
    v_mfma_f32_16x16x32_bf16 a[100:103], a[180:183], a[148:151], a[100:103]
    v_mfma_f32_16x16x32_bf16 a[96:99], a[180:183], a[144:147], a[96:99]
    s_waitcnt vmcnt(16) lgkmcnt(0)
    s_barrier
    v_mfma_f32_16x16x32_bf16 a[48:51], a[184:187], a[144:147], a[48:51]
    ds_read_b64_tr_b16 a[176:177], v15 offset:16384
    v_mfma_f32_16x16x32_bf16 a[52:55], a[184:187], a[148:151], a[52:55]
    ds_read_b64_tr_b16 a[178:179], v15 offset:17408
    v_mfma_f32_16x16x32_bf16 a[56:59], a[184:187], a[152:155], a[56:59]
    ds_read_b64_tr_b16 a[180:181], v16 offset:16384
    v_mfma_f32_16x16x32_bf16 a[60:63], a[184:187], a[156:159], a[60:63]
    ds_read_b64_tr_b16 a[182:183], v16 offset:17408
    v_mfma_f32_16x16x32_bf16 a[124:127], a[188:191], a[156:159], a[124:127]
    ds_read_b64_tr_b16 a[184:185], v17 offset:16384
    v_mfma_f32_16x16x32_bf16 a[120:123], a[188:191], a[152:155], a[120:123]
    ds_read_b64_tr_b16 a[186:187], v17 offset:17408
    s_cmp_eq_u32 s58, 8
    v_mfma_f32_16x16x32_bf16 a[116:119], a[188:191], a[148:151], a[116:119]
    v_mfma_f32_16x16x32_bf16 a[112:115], a[188:191], a[144:147], a[112:115]
    s_cbranch_scc1 p1_gf_end
    s_waitcnt lgkmcnt(4)
    v_mfma_f32_16x16x32_bf16 v[128:131], a[176:179], a[160:163], v[128:131]
    ds_read_b64_tr_b16 a[188:189], v18 offset:16384
    v_mfma_f32_16x16x32_bf16 v[132:135], a[176:179], a[164:167], v[132:135]
    ds_read_b64_tr_b16 a[190:191], v18 offset:17408
    s_mov_b32 m0, s56
    v_mfma_f32_16x16x32_bf16 v[136:139], a[176:179], a[168:171], v[136:139]
    buffer_load_dwordx4 v2, s[8:11], s53 offen offset:0 lds
    v_mfma_f32_16x16x32_bf16 v[140:143], a[176:179], a[172:175], v[140:143]
    v_xor_b32 v15, 0x38000, v15
    v_mfma_f32_16x16x32_bf16 a[128:131], a[176:179], a[192:195], a[128:131]
    s_waitcnt lgkmcnt(4)
    v_mfma_f32_16x16x32_bf16 v[156:159], a[180:183], a[172:175], v[156:159]
    ds_read_b64_tr_b16 a[176:177], v19 offset:16384
    v_mfma_f32_16x16x32_bf16 v[152:155], a[180:183], a[168:171], v[152:155]
    ds_read_b64_tr_b16 a[178:179], v19 offset:17408
    v_mfma_f32_16x16x32_bf16 v[148:151], a[180:183], a[164:167], v[148:151]
    buffer_load_dwordx4 v3, s[8:11], s53 offen offset:1024 lds
    v_mfma_f32_16x16x32_bf16 v[144:147], a[180:183], a[160:163], v[144:147]
    v_xor_b32 v16, 0x38000, v16
    v_mfma_f32_16x16x32_bf16 a[132:135], a[180:183], a[192:195], a[132:135]
    s_waitcnt lgkmcnt(4)
    v_mfma_f32_16x16x32_bf16 v[160:163], a[184:187], a[160:163], v[160:163]
    ds_read_b64_tr_b16 a[180:181], v20 offset:16384
    v_mfma_f32_16x16x32_bf16 v[164:167], a[184:187], a[164:167], v[164:167]
    ds_read_b64_tr_b16 a[182:183], v20 offset:17408
    v_mfma_f32_16x16x32_bf16 v[168:171], a[184:187], a[168:171], v[168:171]
    buffer_load_dwordx4 v4, s[8:11], s53 offen offset:2048 lds
    v_mfma_f32_16x16x32_bf16 v[172:175], a[184:187], a[172:175], v[172:175]
    v_xor_b32 v17, 0x38000, v17
    s_waitcnt lgkmcnt(4)
    v_mfma_f32_16x16x32_bf16 v[188:191], a[188:191], a[172:175], v[188:191]
    ds_read_b64_tr_b16 a[184:185], v21 offset:16384
    v_mfma_f32_16x16x32_bf16 v[184:187], a[188:191], a[168:171], v[184:187]
    ds_read_b64_tr_b16 a[186:187], v21 offset:17408
    v_mfma_f32_16x16x32_bf16 v[180:183], a[188:191], a[164:167], v[180:183]
    buffer_load_dwordx4 v5, s[8:11], s53 offen offset:3072 lds
    v_mfma_f32_16x16x32_bf16 v[176:179], a[188:191], a[160:163], v[176:179]
    v_xor_b32 v18, 0x38000, v18
    s_waitcnt lgkmcnt(4)
    v_mfma_f32_16x16x32_bf16 v[192:195], a[176:179], a[160:163], v[192:195]
    ds_read_b64_tr_b16 a[188:189], v22 offset:16384
    v_mfma_f32_16x16x32_bf16 v[196:199], a[176:179], a[164:167], v[196:199]
    ds_read_b64_tr_b16 a[190:191], v22 offset:17408
    s_max_u32 m0, s57, s59
    v_mfma_f32_16x16x32_bf16 v[200:203], a[176:179], a[168:171], v[200:203]
    buffer_load_dwordx4 v10, s[12:15], s54 offen lds
    v_mfma_f32_16x16x32_bf16 v[204:207], a[176:179], a[172:175], v[204:207]
    v_xor_b32 v19, 0x38000, v19
    s_waitcnt lgkmcnt(4)
    v_mfma_f32_16x16x32_bf16 v[220:223], a[180:183], a[172:175], v[220:223]
    ds_read_b64_tr_b16 a[176:177], v23 offset:18432
    v_mfma_f32_16x16x32_bf16 v[216:219], a[180:183], a[168:171], v[216:219]
    ds_read_b64_tr_b16 a[178:179], v23 offset:18944
    v_mfma_f32_16x16x32_bf16 v[212:215], a[180:183], a[164:167], v[212:215]
    buffer_load_dwordx4 v11, s[12:15], s54 offen offset:1024 lds
    v_mfma_f32_16x16x32_bf16 v[208:211], a[180:183], a[160:163], v[208:211]
    v_xor_b32 v20, 0x38000, v20
    s_waitcnt lgkmcnt(4)
    v_mfma_f32_16x16x32_bf16 v[224:227], a[184:187], a[160:163], v[224:227]
    ds_read_b64_tr_b16 a[180:181], v23 offset:19456
    v_mfma_f32_16x16x32_bf16 v[228:231], a[184:187], a[164:167], v[228:231]
    ds_read_b64_tr_b16 a[182:183], v23 offset:19968
    v_mfma_f32_16x16x32_bf16 v[232:235], a[184:187], a[168:171], v[232:235]
    buffer_load_dwordx4 v12, s[16:19], s55 offen offset:2048 lds
    v_mfma_f32_16x16x32_bf16 v[236:239], a[184:187], a[172:175], v[236:239]
    v_xor_b32 v21, 0x38000, v21
    s_waitcnt lgkmcnt(4)
    v_mfma_f32_16x16x32_bf16 v[252:255], a[188:191], a[172:175], v[252:255]
    ds_read_b64_tr_b16 a[184:185], v24 offset:18432
    v_mfma_f32_16x16x32_bf16 v[248:251], a[188:191], a[168:171], v[248:251]
    ds_read_b64_tr_b16 a[186:187], v24 offset:18944
    v_mfma_f32_16x16x32_bf16 v[244:247], a[188:191], a[164:167], v[244:247]
    buffer_load_dwordx4 v12, s[20:23], s55 offen offset:3072 lds
    v_mfma_f32_16x16x32_bf16 v[240:243], a[188:191], a[160:163], v[240:243]
    s_waitcnt vmcnt(12)
    s_waitcnt lgkmcnt(4)
    v_mfma_f32_16x16x32_bf16 a[0:3], a[176:179], a[160:163], a[0:3]
    ds_read_b64_tr_b16 a[188:189], v24 offset:19456
    v_mfma_f32_16x16x32_bf16 a[4:7], a[176:179], a[164:167], a[4:7]
    ds_read_b64_tr_b16 a[190:191], v24 offset:19968
    s_add_u32 s54, s54, 262144
    s_add_u32 s55, s55, 110592
    v_mfma_f32_16x16x32_bf16 a[8:11], a[176:179], a[168:171], a[8:11]
    ds_read_b128 a[144:147], v13 offset:0
    v_mfma_f32_16x16x32_bf16 a[12:15], a[176:179], a[172:175], a[12:15]
    v_xor_b32 v22, 0x38000, v22
    v_mfma_f32_16x16x32_bf16 a[136:139], a[176:179], a[192:195], a[136:139]
    s_waitcnt lgkmcnt(5)
    v_mfma_f32_16x16x32_bf16 a[76:79], a[180:183], a[172:175], a[76:79]
    ds_read_b64_tr_b16 a[176:177], v25 offset:18432
    v_mfma_f32_16x16x32_bf16 a[72:75], a[180:183], a[168:171], a[72:75]
    ds_read_b64_tr_b16 a[178:179], v25 offset:18944
    s_add_u32 s60, s60, 16384
    s_and_b32 s60, s60, 0xffff
    v_mfma_f32_16x16x32_bf16 a[68:71], a[180:183], a[164:167], a[68:71]
    ds_read_b128 a[148:151], v13 offset:2048
    v_mfma_f32_16x16x32_bf16 a[64:67], a[180:183], a[160:163], a[64:67]
    v_xor_b32 v23, 0x38000, v23
    v_mfma_f32_16x16x32_bf16 a[140:143], a[180:183], a[192:195], a[140:143]
    s_waitcnt lgkmcnt(6)
    v_mfma_f32_16x16x32_bf16 a[16:19], a[184:187], a[160:163], a[16:19]
    ds_read_b64_tr_b16 a[180:181], v25 offset:19456
    v_mfma_f32_16x16x32_bf16 a[20:23], a[184:187], a[164:167], a[20:23]
    ds_read_b64_tr_b16 a[182:183], v25 offset:19968
    s_add_u32 s57, s60, s95
    v_mfma_f32_16x16x32_bf16 a[24:27], a[184:187], a[168:171], a[24:27]
    ds_read_b128 a[152:155], v13 offset:4096
    v_mfma_f32_16x16x32_bf16 a[28:31], a[184:187], a[172:175], a[28:31]
    v_xor_b32 v24, 0x38000, v24
    s_waitcnt lgkmcnt(7)
    v_mfma_f32_16x16x32_bf16 a[92:95], a[188:191], a[172:175], a[92:95]
    ds_read_b64_tr_b16 a[184:185], v26 offset:18432
    v_mfma_f32_16x16x32_bf16 a[88:91], a[188:191], a[168:171], a[88:91]
    ds_read_b64_tr_b16 a[186:187], v26 offset:18944
    s_add_u32 s58, s58, 1
    v_mfma_f32_16x16x32_bf16 a[84:87], a[188:191], a[164:167], a[84:87]
    ds_read_b128 a[156:159], v13 offset:6144
    v_mfma_f32_16x16x32_bf16 a[80:83], a[188:191], a[160:163], a[80:83]
    v_xor_b32 v25, 0x38000, v25
    s_waitcnt lgkmcnt(7)
    v_mfma_f32_16x16x32_bf16 a[32:35], a[176:179], a[160:163], a[32:35]
    ds_read_b64_tr_b16 a[188:189], v26 offset:19456
    v_mfma_f32_16x16x32_bf16 a[36:39], a[176:179], a[164:167], a[36:39]
    ds_read_b64_tr_b16 a[190:191], v26 offset:19968
    v_mfma_f32_16x16x32_bf16 a[40:43], a[176:179], a[168:171], a[40:43]
    v_mfma_f32_16x16x32_bf16 a[44:47], a[176:179], a[172:175], a[44:47]
    v_xor_b32 v26, 0x38000, v26
    s_waitcnt lgkmcnt(6)
    v_mfma_f32_16x16x32_bf16 a[108:111], a[180:183], a[172:175], a[108:111]
    v_mfma_f32_16x16x32_bf16 a[104:107], a[180:183], a[168:171], a[104:107]
    v_mfma_f32_16x16x32_bf16 a[100:103], a[180:183], a[164:167], a[100:103]
    v_mfma_f32_16x16x32_bf16 a[96:99], a[180:183], a[160:163], a[96:99]
    s_waitcnt vmcnt(16) lgkmcnt(0)
    s_barrier
    v_mfma_f32_16x16x32_bf16 a[48:51], a[184:187], a[160:163], a[48:51]
    ds_read_b64_tr_b16 a[176:177], v15 offset:0
    v_mfma_f32_16x16x32_bf16 a[52:55], a[184:187], a[164:167], a[52:55]
    ds_read_b64_tr_b16 a[178:179], v15 offset:1024
    v_mfma_f32_16x16x32_bf16 a[56:59], a[184:187], a[168:171], a[56:59]
    ds_read_b64_tr_b16 a[180:181], v16 offset:0
    v_mfma_f32_16x16x32_bf16 a[60:63], a[184:187], a[172:175], a[60:63]
    ds_read_b64_tr_b16 a[182:183], v16 offset:1024
    v_xor_b32 v14, 0x18000, v14
    v_mfma_f32_16x16x32_bf16 a[124:127], a[188:191], a[172:175], a[124:127]
    ds_read_b64_tr_b16 a[184:185], v17 offset:0
    v_mfma_f32_16x16x32_bf16 a[120:123], a[188:191], a[168:171], a[120:123]
    ds_read_b64_tr_b16 a[186:187], v17 offset:1024
    v_mfma_f32_16x16x32_bf16 a[116:119], a[188:191], a[164:167], a[116:119]
    v_mfma_f32_16x16x32_bf16 a[112:115], a[188:191], a[160:163], a[112:115]
    s_branch p1_gf
p1_gf_end:
    s_waitcnt lgkmcnt(4)
    v_mfma_f32_16x16x32_bf16 v[128:131], a[176:179], a[160:163], v[128:131]
    ds_read_b64_tr_b16 a[188:189], v18 offset:16384
    v_mfma_f32_16x16x32_bf16 v[132:135], a[176:179], a[164:167], v[132:135]
    ds_read_b64_tr_b16 a[190:191], v18 offset:17408
    v_mov_b32_e64 v2, v64
    v_mfma_f32_16x16x32_bf16 v[136:139], a[176:179], a[168:171], v[136:139]
    global_load_dword v44, v46, s[84:85] sc1
    v_mfma_f32_16x16x32_bf16 v[140:143], a[176:179], a[172:175], v[140:143]
    v_xor_b32 v15, 0x38000, v15
    v_mfma_f32_16x16x32_bf16 a[128:131], a[176:179], a[192:195], a[128:131]
    s_waitcnt lgkmcnt(4)
    v_mfma_f32_16x16x32_bf16 v[156:159], a[180:183], a[172:175], v[156:159]
    ds_read_b64_tr_b16 a[176:177], v19 offset:16384
    v_mfma_f32_16x16x32_bf16 v[152:155], a[180:183], a[168:171], v[152:155]
    ds_read_b64_tr_b16 a[178:179], v19 offset:17408
    v_mov_b32 v3, v65
    v_mfma_f32_16x16x32_bf16 v[148:151], a[180:183], a[164:167], v[148:151]
    global_load_dwordx2 v[48:49], v50, s[84:85] offset:128 sc1
    v_mfma_f32_16x16x32_bf16 v[144:147], a[180:183], a[160:163], v[144:147]
    v_xor_b32 v16, 0x38000, v16
    v_mfma_f32_16x16x32_bf16 a[132:135], a[180:183], a[192:195], a[132:135]
    s_waitcnt lgkmcnt(4)
    v_mfma_f32_16x16x32_bf16 v[160:163], a[184:187], a[160:163], v[160:163]
    ds_read_b64_tr_b16 a[180:181], v20 offset:16384
    v_mfma_f32_16x16x32_bf16 v[164:167], a[184:187], a[164:167], v[164:167]
    ds_read_b64_tr_b16 a[182:183], v20 offset:17408
    v_mov_b32_e64 v4, v66
    v_mfma_f32_16x16x32_bf16 v[168:171], a[184:187], a[168:171], v[168:171]
    v_mfma_f32_16x16x32_bf16 v[172:175], a[184:187], a[172:175], v[172:175]
    v_xor_b32 v17, 0x38000, v17
    s_waitcnt lgkmcnt(4)
    v_mfma_f32_16x16x32_bf16 v[188:191], a[188:191], a[172:175], v[188:191]
    ds_read_b64_tr_b16 a[184:185], v21 offset:16384
    v_mfma_f32_16x16x32_bf16 v[184:187], a[188:191], a[168:171], v[184:187]
    ds_read_b64_tr_b16 a[186:187], v21 offset:17408
    v_mov_b32 v5, v67
    s_lshl_b32 s89, s48, 12
    s_mov_b32 m0, s89
    v_mfma_f32_16x16x32_bf16 v[180:183], a[188:191], a[164:167], v[180:183]
    v_mfma_f32_16x16x32_bf16 v[176:179], a[188:191], a[160:163], v[176:179]
    v_xor_b32 v18, 0x38000, v18
    s_waitcnt lgkmcnt(4)
    v_mfma_f32_16x16x32_bf16 v[192:195], a[176:179], a[160:163], v[192:195]
    ds_read_b64_tr_b16 a[188:189], v22 offset:16384
    v_mfma_f32_16x16x32_bf16 v[196:199], a[176:179], a[164:167], v[196:199]
    ds_read_b64_tr_b16 a[190:191], v22 offset:17408
    v_mov_b32_e64 v6, v68
    v_mfma_f32_16x16x32_bf16 v[200:203], a[176:179], a[168:171], v[200:203]
    buffer_load_dwordx4 v2, s[24:27], s88 offen offset:0 lds
    v_mfma_f32_16x16x32_bf16 v[204:207], a[176:179], a[172:175], v[204:207]
    v_xor_b32 v19, 0x38000, v19
    s_waitcnt lgkmcnt(4)
    v_mfma_f32_16x16x32_bf16 v[220:223], a[180:183], a[172:175], v[220:223]
    ds_read_b64_tr_b16 a[176:177], v23 offset:18432
    v_mfma_f32_16x16x32_bf16 v[216:219], a[180:183], a[168:171], v[216:219]
    ds_read_b64_tr_b16 a[178:179], v23 offset:18944
    v_mfma_f32_16x16x32_bf16 v[212:215], a[180:183], a[164:167], v[212:215]
    buffer_load_dwordx4 v3, s[24:27], s88 offen offset:1024 lds
    v_mfma_f32_16x16x32_bf16 v[208:211], a[180:183], a[160:163], v[208:211]
    v_xor_b32 v20, 0x38000, v20
    s_waitcnt lgkmcnt(4)
    v_mfma_f32_16x16x32_bf16 v[224:227], a[184:187], a[160:163], v[224:227]
    ds_read_b64_tr_b16 a[180:181], v23 offset:19456
    v_mfma_f32_16x16x32_bf16 v[228:231], a[184:187], a[164:167], v[228:231]
    ds_read_b64_tr_b16 a[182:183], v23 offset:19968
    v_mfma_f32_16x16x32_bf16 v[232:235], a[184:187], a[168:171], v[232:235]
    buffer_load_dwordx4 v4, s[24:27], s88 offen offset:2048 lds
    v_mfma_f32_16x16x32_bf16 v[236:239], a[184:187], a[172:175], v[236:239]
    v_xor_b32 v21, 0x38000, v21
    s_waitcnt lgkmcnt(4)
    v_mfma_f32_16x16x32_bf16 v[252:255], a[188:191], a[172:175], v[252:255]
    ds_read_b64_tr_b16 a[184:185], v24 offset:18432
    v_mfma_f32_16x16x32_bf16 v[248:251], a[188:191], a[168:171], v[248:251]
    ds_read_b64_tr_b16 a[186:187], v24 offset:18944
    v_mfma_f32_16x16x32_bf16 v[244:247], a[188:191], a[164:167], v[244:247]
    buffer_load_dwordx4 v5, s[24:27], s88 offen offset:3072 lds
    v_mfma_f32_16x16x32_bf16 v[240:243], a[188:191], a[160:163], v[240:243]
    s_waitcnt vmcnt(10)
    s_waitcnt lgkmcnt(4)
    v_mfma_f32_16x16x32_bf16 a[0:3], a[176:179], a[160:163], a[0:3]
    ds_read_b64_tr_b16 a[188:189], v24 offset:19456
    v_mfma_f32_16x16x32_bf16 a[4:7], a[176:179], a[164:167], a[4:7]
    ds_read_b64_tr_b16 a[190:191], v24 offset:19968
    v_mfma_f32_16x16x32_bf16 a[8:11], a[176:179], a[168:171], a[8:11]
    ds_read_b128 a[144:147], v13 offset:0
    v_mfma_f32_16x16x32_bf16 a[12:15], a[176:179], a[172:175], a[12:15]
    v_xor_b32 v22, 0x38000, v22
    v_mfma_f32_16x16x32_bf16 a[136:139], a[176:179], a[192:195], a[136:139]
    s_waitcnt lgkmcnt(5)
    v_mfma_f32_16x16x32_bf16 a[76:79], a[180:183], a[172:175], a[76:79]
    ds_read_b64_tr_b16 a[176:177], v25 offset:18432
    v_mfma_f32_16x16x32_bf16 a[72:75], a[180:183], a[168:171], a[72:75]
    ds_read_b64_tr_b16 a[178:179], v25 offset:18944
    v_mfma_f32_16x16x32_bf16 a[68:71], a[180:183], a[164:167], a[68:71]
    ds_read_b128 a[148:151], v13 offset:2048
    v_mfma_f32_16x16x32_bf16 a[64:67], a[180:183], a[160:163], a[64:67]
    v_xor_b32 v23, 0x38000, v23
    v_mfma_f32_16x16x32_bf16 a[140:143], a[180:183], a[192:195], a[140:143]
    s_waitcnt lgkmcnt(6)
    v_mfma_f32_16x16x32_bf16 a[16:19], a[184:187], a[160:163], a[16:19]
    ds_read_b64_tr_b16 a[180:181], v25 offset:19456
    v_mfma_f32_16x16x32_bf16 a[20:23], a[184:187], a[164:167], a[20:23]
    ds_read_b64_tr_b16 a[182:183], v25 offset:19968
    v_mfma_f32_16x16x32_bf16 a[24:27], a[184:187], a[168:171], a[24:27]
    ds_read_b128 a[152:155], v13 offset:4096
    v_mfma_f32_16x16x32_bf16 a[28:31], a[184:187], a[172:175], a[28:31]
    v_xor_b32 v24, 0x38000, v24
    s_waitcnt lgkmcnt(7)
    v_mfma_f32_16x16x32_bf16 a[92:95], a[188:191], a[172:175], a[92:95]
    ds_read_b64_tr_b16 a[184:185], v26 offset:18432
    v_mfma_f32_16x16x32_bf16 a[88:91], a[188:191], a[168:171], a[88:91]
    ds_read_b64_tr_b16 a[186:187], v26 offset:18944
    v_mfma_f32_16x16x32_bf16 a[84:87], a[188:191], a[164:167], a[84:87]
    ds_read_b128 a[156:159], v13 offset:6144
    v_mfma_f32_16x16x32_bf16 a[80:83], a[188:191], a[160:163], a[80:83]
    v_xor_b32 v25, 0x38000, v25
    s_waitcnt lgkmcnt(7)
    v_mfma_f32_16x16x32_bf16 a[32:35], a[176:179], a[160:163], a[32:35]
    ds_read_b64_tr_b16 a[188:189], v26 offset:19456
    v_mfma_f32_16x16x32_bf16 a[36:39], a[176:179], a[164:167], a[36:39]
    ds_read_b64_tr_b16 a[190:191], v26 offset:19968
    v_mfma_f32_16x16x32_bf16 a[40:43], a[176:179], a[168:171], a[40:43]
    v_mfma_f32_16x16x32_bf16 a[44:47], a[176:179], a[172:175], a[44:47]
    v_xor_b32 v26, 0x38000, v26
    s_waitcnt lgkmcnt(6)
    v_mfma_f32_16x16x32_bf16 a[108:111], a[180:183], a[172:175], a[108:111]
    v_mfma_f32_16x16x32_bf16 a[104:107], a[180:183], a[168:171], a[104:107]
    v_mfma_f32_16x16x32_bf16 a[100:103], a[180:183], a[164:167], a[100:103]
    v_mfma_f32_16x16x32_bf16 a[96:99], a[180:183], a[160:163], a[96:99]
    s_waitcnt vmcnt(14) lgkmcnt(0)
    s_barrier
    v_mfma_f32_16x16x32_bf16 a[48:51], a[184:187], a[160:163], a[48:51]
    ds_read_b64_tr_b16 a[176:177], v15 offset:0
    v_mfma_f32_16x16x32_bf16 a[52:55], a[184:187], a[164:167], a[52:55]
    ds_read_b64_tr_b16 a[178:179], v15 offset:1024
    v_mfma_f32_16x16x32_bf16 a[56:59], a[184:187], a[168:171], a[56:59]
    ds_read_b64_tr_b16 a[180:181], v16 offset:0
    v_mfma_f32_16x16x32_bf16 a[60:63], a[184:187], a[172:175], a[60:63]
    ds_read_b64_tr_b16 a[182:183], v16 offset:1024
    v_xor_b32 v14, 0x18000, v14
    v_mfma_f32_16x16x32_bf16 a[124:127], a[188:191], a[172:175], a[124:127]
    ds_read_b64_tr_b16 a[184:185], v17 offset:0
    v_mfma_f32_16x16x32_bf16 a[120:123], a[188:191], a[168:171], a[120:123]
    ds_read_b64_tr_b16 a[186:187], v17 offset:1024
    v_mfma_f32_16x16x32_bf16 a[116:119], a[188:191], a[164:167], a[116:119]
    v_mfma_f32_16x16x32_bf16 a[112:115], a[188:191], a[160:163], a[112:115]
    s_waitcnt lgkmcnt(4)
    v_mfma_f32_16x16x32_bf16 v[128:131], a[176:179], a[144:147], v[128:131]
    ds_read_b64_tr_b16 a[188:189], v18 offset:0
    v_mfma_f32_16x16x32_bf16 v[132:135], a[176:179], a[148:151], v[132:135]
    ds_read_b64_tr_b16 a[190:191], v18 offset:1024
    s_lshl2_add_u32 s61, s50, s48
    s_lshl_b32 s61, s61, 10
    v_mfma_f32_16x16x32_bf16 v[136:139], a[176:179], a[152:155], v[136:139]
    ds_read_b128 a[160:163], v14 offset:0
    v_mfma_f32_16x16x32_bf16 v[140:143], a[176:179], a[156:159], v[140:143]
    s_waitcnt vmcnt(4)
    s_mov_b32 s62, 0
p1_gf_chk:
    v_cmp_ne_u32 vcc, 0x01010101, v44
    v_cmp_eq_u32 s[6:7], 0, v49
    s_nop 3
    s_or_b64 s[6:7], s[6:7], vcc
    s_cbranch_scc0 p1_gf_rdy
    s_add_u32 s62, s62, 1
    s_cmp_ge_u32 s62, 0x40000
    s_cbranch_scc1 p1_gf_rdy
    global_load_dword v44, v46, s[84:85] sc1
    global_load_dwordx2 v[48:49], v50, s[84:85] offset:128 sc1
    s_waitcnt vmcnt(0)
    s_branch p1_gf_chk
p1_gf_rdy:
    v_mfma_f32_16x16x32_bf16 a[128:131], a[176:179], a[192:195], a[128:131]
    s_waitcnt lgkmcnt(5)
    v_mfma_f32_16x16x32_bf16 v[156:159], a[180:183], a[156:159], v[156:159]
    ds_read_b64_tr_b16 a[176:177], v19 offset:0
    v_mfma_f32_16x16x32_bf16 v[152:155], a[180:183], a[152:155], v[152:155]
    ds_read_b64_tr_b16 a[178:179], v19 offset:1024
    v_mfma_f32_16x16x32_bf16 v[148:151], a[180:183], a[148:151], v[148:151]
    ds_read_b128 a[164:167], v14 offset:2048
    v_mfma_f32_16x16x32_bf16 v[144:147], a[180:183], a[144:147], v[144:147]
    v_mfma_f32_16x16x32_bf16 a[132:135], a[180:183], a[192:195], a[132:135]
    s_waitcnt lgkmcnt(6)
    v_mfma_f32_16x16x32_bf16 v[160:163], a[184:187], a[144:147], v[160:163]
    ds_read_b64_tr_b16 a[180:181], v20 offset:0
    v_mfma_f32_16x16x32_bf16 v[164:167], a[184:187], a[148:151], v[164:167]
    ds_read_b64_tr_b16 a[182:183], v20 offset:1024
    v_readfirstlane_b32 s100, v48
    v_mfma_f32_16x16x32_bf16 v[168:171], a[184:187], a[152:155], v[168:171]
    buffer_load_dwordx4 v[28:31], v47, s[44:47], s61 offen offset:0 sc1
    v_mfma_f32_16x16x32_bf16 v[172:175], a[184:187], a[156:159], v[172:175]
    s_waitcnt lgkmcnt(6)
    v_mfma_f32_16x16x32_bf16 v[188:191], a[188:191], a[156:159], v[188:191]
    ds_read_b64_tr_b16 a[184:185], v21 offset:0
    v_mfma_f32_16x16x32_bf16 v[184:187], a[188:191], a[152:155], v[184:187]
    ds_read_b64_tr_b16 a[186:187], v21 offset:1024
    v_readfirstlane_b32 s101, v49
    v_mfma_f32_16x16x32_bf16 v[180:183], a[188:191], a[148:151], v[180:183]
    buffer_load_dwordx4 v[32:35], v47, s[44:47], s61 offen offset:256 sc1
    v_mfma_f32_16x16x32_bf16 v[176:179], a[188:191], a[144:147], v[176:179]
    s_waitcnt lgkmcnt(5)
    v_mfma_f32_16x16x32_bf16 v[192:195], a[176:179], a[144:147], v[192:195]
    ds_read_b64_tr_b16 a[188:189], v22 offset:0
    v_mfma_f32_16x16x32_bf16 v[196:199], a[176:179], a[148:151], v[196:199]
    ds_read_b64_tr_b16 a[190:191], v22 offset:1024
    s_add_u32 s84, s86, 34078720
    s_addc_u32 s85, s87, 0
    v_mfma_f32_16x16x32_bf16 v[200:203], a[176:179], a[152:155], v[200:203]
    buffer_load_dwordx4 v[36:39], v47, s[44:47], s61 offen offset:512 sc1
    v_mfma_f32_16x16x32_bf16 v[204:207], a[176:179], a[156:159], v[204:207]
    s_waitcnt lgkmcnt(4)
    v_mfma_f32_16x16x32_bf16 v[220:223], a[180:183], a[156:159], v[220:223]
    ds_read_b64_tr_b16 a[176:177], v23 offset:2048
    v_mfma_f32_16x16x32_bf16 v[216:219], a[180:183], a[152:155], v[216:219]
    ds_read_b64_tr_b16 a[178:179], v23 offset:2560
    v_mfma_f32_16x16x32_bf16 v[212:215], a[180:183], a[148:151], v[212:215]
    buffer_load_dwordx4 v[40:43], v47, s[44:47], s61 offen offset:768 sc1
    v_mfma_f32_16x16x32_bf16 v[208:211], a[180:183], a[144:147], v[208:211]
    s_waitcnt lgkmcnt(4)
    v_mfma_f32_16x16x32_bf16 v[224:227], a[184:187], a[144:147], v[224:227]
    ds_read_b64_tr_b16 a[180:181], v23 offset:3072
    v_mfma_f32_16x16x32_bf16 v[228:231], a[184:187], a[148:151], v[228:231]
    ds_read_b64_tr_b16 a[182:183], v23 offset:3584
    v_mfma_f32_16x16x32_bf16 v[232:235], a[184:187], a[152:155], v[232:235]
    ds_read_b128 a[168:171], v14 offset:4096
    v_mfma_f32_16x16x32_bf16 v[236:239], a[184:187], a[156:159], v[236:239]
    s_waitcnt lgkmcnt(5)
    v_mfma_f32_16x16x32_bf16 v[252:255], a[188:191], a[156:159], v[252:255]
    ds_read_b64_tr_b16 a[184:185], v24 offset:2048
    v_mfma_f32_16x16x32_bf16 v[248:251], a[188:191], a[152:155], v[248:251]
    ds_read_b64_tr_b16 a[186:187], v24 offset:2560
    s_add_u32 m0, m0, 16384
    v_mfma_f32_16x16x32_bf16 v[244:247], a[188:191], a[148:151], v[244:247]
    ds_read_b128 a[172:175], v14 offset:6144
    v_mfma_f32_16x16x32_bf16 v[240:243], a[188:191], a[144:147], v[240:243]
    s_waitcnt lgkmcnt(6)
    v_mfma_f32_16x16x32_bf16 a[0:3], a[176:179], a[144:147], a[0:3]
    ds_read_b64_tr_b16 a[188:189], v24 offset:3072
    v_mfma_f32_16x16x32_bf16 a[4:7], a[176:179], a[148:151], a[4:7]
    ds_read_b64_tr_b16 a[190:191], v24 offset:3584
    v_mfma_f32_16x16x32_bf16 a[8:11], a[176:179], a[152:155], a[8:11]
    buffer_load_dwordx4 v6, s[28:31], s88 offen offset:0 lds
    v_mfma_f32_16x16x32_bf16 a[12:15], a[176:179], a[156:159], a[12:15]
    v_mfma_f32_16x16x32_bf16 a[136:139], a[176:179], a[192:195], a[136:139]
    s_waitcnt lgkmcnt(6)
    v_mfma_f32_16x16x32_bf16 a[76:79], a[180:183], a[156:159], a[76:79]
    ds_read_b64_tr_b16 a[176:177], v25 offset:2048
    v_mfma_f32_16x16x32_bf16 a[72:75], a[180:183], a[152:155], a[72:75]
    ds_read_b64_tr_b16 a[178:179], v25 offset:2560
    v_mfma_f32_16x16x32_bf16 a[68:71], a[180:183], a[148:151], a[68:71]
    buffer_load_dwordx4 v6, s[28:31], s88 offen offset:1024 lds
    v_mfma_f32_16x16x32_bf16 a[64:67], a[180:183], a[144:147], a[64:67]
    v_mfma_f32_16x16x32_bf16 a[140:143], a[180:183], a[192:195], a[140:143]
    s_waitcnt lgkmcnt(5)
    v_mfma_f32_16x16x32_bf16 a[16:19], a[184:187], a[144:147], a[16:19]
    ds_read_b64_tr_b16 a[180:181], v25 offset:3072
    v_mfma_f32_16x16x32_bf16 a[20:23], a[184:187], a[148:151], a[20:23]
    ds_read_b64_tr_b16 a[182:183], v25 offset:3584
    v_mfma_f32_16x16x32_bf16 a[24:27], a[184:187], a[152:155], a[24:27]
    buffer_load_dwordx4 v6, s[28:31], s88 offen offset:2048 lds
    v_mfma_f32_16x16x32_bf16 a[28:31], a[184:187], a[156:159], a[28:31]
    s_waitcnt lgkmcnt(4)
    v_mfma_f32_16x16x32_bf16 a[92:95], a[188:191], a[156:159], a[92:95]
    ds_read_b64_tr_b16 a[184:185], v26 offset:2048
    v_mfma_f32_16x16x32_bf16 a[88:91], a[188:191], a[152:155], a[88:91]
    ds_read_b64_tr_b16 a[186:187], v26 offset:2560
    v_mfma_f32_16x16x32_bf16 a[84:87], a[188:191], a[148:151], a[84:87]
    buffer_load_dwordx4 v6, s[28:31], s88 offen offset:3072 lds
    v_mfma_f32_16x16x32_bf16 a[80:83], a[188:191], a[144:147], a[80:83]
    s_waitcnt lgkmcnt(4)
    v_mfma_f32_16x16x32_bf16 a[32:35], a[176:179], a[144:147], a[32:35]
    ds_read_b64_tr_b16 a[188:189], v26 offset:3072
    v_mfma_f32_16x16x32_bf16 a[36:39], a[176:179], a[148:151], a[36:39]
    ds_read_b64_tr_b16 a[190:191], v26 offset:3584
    s_add_u32 s88, s88, 16384
    s_add_u32 s89, s89, 32768
    v_mfma_f32_16x16x32_bf16 a[40:43], a[176:179], a[152:155], a[40:43]
    v_mfma_f32_16x16x32_bf16 a[44:47], a[176:179], a[156:159], a[44:47]
    s_waitcnt lgkmcnt(4)
    v_mfma_f32_16x16x32_bf16 a[108:111], a[180:183], a[156:159], a[108:111]
    v_mfma_f32_16x16x32_bf16 a[104:107], a[180:183], a[152:155], a[104:107]
    v_mfma_f32_16x16x32_bf16 a[100:103], a[180:183], a[148:151], a[100:103]
    v_mfma_f32_16x16x32_bf16 a[96:99], a[180:183], a[144:147], a[96:99]
    s_waitcnt vmcnt(14) lgkmcnt(0)
    s_barrier
    v_mfma_f32_16x16x32_bf16 a[48:51], a[184:187], a[144:147], a[48:51]
    ds_read_b64_tr_b16 a[176:177], v15 offset:16384
    v_mfma_f32_16x16x32_bf16 a[52:55], a[184:187], a[148:151], a[52:55]
    ds_read_b64_tr_b16 a[178:179], v15 offset:17408
    v_mfma_f32_16x16x32_bf16 a[56:59], a[184:187], a[152:155], a[56:59]
    ds_read_b64_tr_b16 a[180:181], v16 offset:16384
    v_mfma_f32_16x16x32_bf16 a[60:63], a[184:187], a[156:159], a[60:63]
    ds_read_b64_tr_b16 a[182:183], v16 offset:17408
    v_mfma_f32_16x16x32_bf16 a[124:127], a[188:191], a[156:159], a[124:127]
    ds_read_b64_tr_b16 a[184:185], v17 offset:16384
    v_mfma_f32_16x16x32_bf16 a[120:123], a[188:191], a[152:155], a[120:123]
    ds_read_b64_tr_b16 a[186:187], v17 offset:17408
    v_mfma_f32_16x16x32_bf16 a[116:119], a[188:191], a[148:151], a[116:119]
    v_mfma_f32_16x16x32_bf16 a[112:115], a[188:191], a[144:147], a[112:115]
    s_waitcnt lgkmcnt(4)
    v_mfma_f32_16x16x32_bf16 v[128:131], a[176:179], a[160:163], v[128:131]
    ds_read_b64_tr_b16 a[188:189], v18 offset:16384
    v_mfma_f32_16x16x32_bf16 v[132:135], a[176:179], a[164:167], v[132:135]
    ds_read_b64_tr_b16 a[190:191], v18 offset:17408
    s_mov_b32 m0, s89
    v_mfma_f32_16x16x32_bf16 v[136:139], a[176:179], a[168:171], v[136:139]
    v_mfma_f32_16x16x32_bf16 v[140:143], a[176:179], a[172:175], v[140:143]
    v_mfma_f32_16x16x32_bf16 a[128:131], a[176:179], a[192:195], a[128:131]
    s_waitcnt lgkmcnt(4)
    v_mfma_f32_16x16x32_bf16 v[156:159], a[180:183], a[172:175], v[156:159]
    ds_read_b64_tr_b16 a[176:177], v19 offset:16384
    v_mfma_f32_16x16x32_bf16 v[152:155], a[180:183], a[168:171], v[152:155]
    ds_read_b64_tr_b16 a[178:179], v19 offset:17408
    v_mfma_f32_16x16x32_bf16 v[148:151], a[180:183], a[164:167], v[148:151]
    buffer_load_dwordx4 v2, s[24:27], s88 offen offset:0 lds
    v_mfma_f32_16x16x32_bf16 v[144:147], a[180:183], a[160:163], v[144:147]
    v_mfma_f32_16x16x32_bf16 a[132:135], a[180:183], a[192:195], a[132:135]
    s_waitcnt lgkmcnt(4)
    v_mfma_f32_16x16x32_bf16 v[160:163], a[184:187], a[160:163], v[160:163]
    ds_read_b64_tr_b16 a[180:181], v20 offset:16384
    v_mfma_f32_16x16x32_bf16 v[164:167], a[184:187], a[164:167], v[164:167]
    ds_read_b64_tr_b16 a[182:183], v20 offset:17408
    v_mfma_f32_16x16x32_bf16 v[168:171], a[184:187], a[168:171], v[168:171]
    buffer_load_dwordx4 v3, s[24:27], s88 offen offset:1024 lds
    v_mfma_f32_16x16x32_bf16 v[172:175], a[184:187], a[172:175], v[172:175]
    s_waitcnt lgkmcnt(4)
    v_mfma_f32_16x16x32_bf16 v[188:191], a[188:191], a[172:175], v[188:191]
    ds_read_b64_tr_b16 a[184:185], v21 offset:16384
    v_mfma_f32_16x16x32_bf16 v[184:187], a[188:191], a[168:171], v[184:187]
    ds_read_b64_tr_b16 a[186:187], v21 offset:17408
    v_mfma_f32_16x16x32_bf16 v[180:183], a[188:191], a[164:167], v[180:183]
    ds_write_b128 v52, a[128:131]
    v_mfma_f32_16x16x32_bf16 v[176:179], a[188:191], a[160:163], v[176:179]
    s_waitcnt lgkmcnt(5)
    v_mfma_f32_16x16x32_bf16 v[192:195], a[176:179], a[160:163], v[192:195]
    ds_read_b64_tr_b16 a[188:189], v22 offset:16384
    v_mfma_f32_16x16x32_bf16 v[196:199], a[176:179], a[164:167], v[196:199]
    ds_read_b64_tr_b16 a[190:191], v22 offset:17408
    v_mfma_f32_16x16x32_bf16 v[200:203], a[176:179], a[168:171], v[200:203]
    ds_write_b128 v52, a[132:135] offset:64
    v_mfma_f32_16x16x32_bf16 v[204:207], a[176:179], a[172:175], v[204:207]
    s_waitcnt lgkmcnt(6)
    v_mfma_f32_16x16x32_bf16 v[220:223], a[180:183], a[172:175], v[220:223]
    ds_read_b64_tr_b16 a[176:177], v23 offset:18432
    v_mfma_f32_16x16x32_bf16 v[216:219], a[180:183], a[168:171], v[216:219]
    ds_read_b64_tr_b16 a[178:179], v23 offset:18944
    v_mfma_f32_16x16x32_bf16 v[212:215], a[180:183], a[164:167], v[212:215]
    buffer_load_dwordx4 v4, s[24:27], s88 offen offset:2048 lds
    v_mfma_f32_16x16x32_bf16 v[208:211], a[180:183], a[160:163], v[208:211]
    s_waitcnt lgkmcnt(6)
    v_mfma_f32_16x16x32_bf16 v[224:227], a[184:187], a[160:163], v[224:227]
    ds_read_b64_tr_b16 a[180:181], v23 offset:19456
    v_mfma_f32_16x16x32_bf16 v[228:231], a[184:187], a[164:167], v[228:231]
    ds_read_b64_tr_b16 a[182:183], v23 offset:19968
    v_mfma_f32_16x16x32_bf16 v[232:235], a[184:187], a[168:171], v[232:235]
    buffer_load_dwordx4 v5, s[24:27], s88 offen offset:3072 lds
    v_mfma_f32_16x16x32_bf16 v[236:239], a[184:187], a[172:175], v[236:239]
    s_waitcnt lgkmcnt(5)
    v_mfma_f32_16x16x32_bf16 v[252:255], a[188:191], a[172:175], v[252:255]
    ds_read_b64_tr_b16 a[184:185], v24 offset:18432
    v_mfma_f32_16x16x32_bf16 v[248:251], a[188:191], a[168:171], v[248:251]
    ds_read_b64_tr_b16 a[186:187], v24 offset:18944
    v_mfma_f32_16x16x32_bf16 v[244:247], a[188:191], a[164:167], v[244:247]
    v_mfma_f32_16x16x32_bf16 v[240:243], a[188:191], a[160:163], v[240:243]
    s_waitcnt lgkmcnt(4)
    v_mfma_f32_16x16x32_bf16 a[0:3], a[176:179], a[160:163], a[0:3]
    ds_read_b64_tr_b16 a[188:189], v24 offset:19456
    v_mfma_f32_16x16x32_bf16 a[4:7], a[176:179], a[164:167], a[4:7]
    ds_read_b64_tr_b16 a[190:191], v24 offset:19968
    v_mfma_f32_16x16x32_bf16 a[8:11], a[176:179], a[168:171], a[8:11]
    v_mfma_f32_16x16x32_bf16 a[12:15], a[176:179], a[172:175], a[12:15]
    v_mfma_f32_16x16x32_bf16 a[136:139], a[176:179], a[192:195], a[136:139]
    s_waitcnt lgkmcnt(4)
    v_mfma_f32_16x16x32_bf16 a[76:79], a[180:183], a[172:175], a[76:79]
    ds_read_b64_tr_b16 a[176:177], v25 offset:18432
    v_mfma_f32_16x16x32_bf16 a[72:75], a[180:183], a[168:171], a[72:75]
    ds_read_b64_tr_b16 a[178:179], v25 offset:18944
    v_mfma_f32_16x16x32_bf16 a[68:71], a[180:183], a[164:167], a[68:71]
    v_mfma_f32_16x16x32_bf16 a[64:67], a[180:183], a[160:163], a[64:67]
    v_mfma_f32_16x16x32_bf16 a[140:143], a[180:183], a[192:195], a[140:143]
    s_waitcnt lgkmcnt(4)
    v_mfma_f32_16x16x32_bf16 a[16:19], a[184:187], a[160:163], a[16:19]
    ds_read_b64_tr_b16 a[180:181], v25 offset:19456
    v_mfma_f32_16x16x32_bf16 a[20:23], a[184:187], a[164:167], a[20:23]
    ds_read_b64_tr_b16 a[182:183], v25 offset:19968
    v_mfma_f32_16x16x32_bf16 a[24:27], a[184:187], a[168:171], a[24:27]
    v_mfma_f32_16x16x32_bf16 a[28:31], a[184:187], a[172:175], a[28:31]
    s_waitcnt lgkmcnt(4)
    v_mfma_f32_16x16x32_bf16 a[92:95], a[188:191], a[172:175], a[92:95]
    ds_read_b64_tr_b16 a[184:185], v26 offset:18432
    v_mfma_f32_16x16x32_bf16 a[88:91], a[188:191], a[168:171], a[88:91]
    ds_read_b64_tr_b16 a[186:187], v26 offset:18944
    v_mfma_f32_16x16x32_bf16 a[84:87], a[188:191], a[164:167], a[84:87]
    ds_write_b128 v53, a[136:139]
    v_mfma_f32_16x16x32_bf16 a[80:83], a[188:191], a[160:163], a[80:83]
    s_waitcnt lgkmcnt(5)
    v_mfma_f32_16x16x32_bf16 a[32:35], a[176:179], a[160:163], a[32:35]
    ds_read_b64_tr_b16 a[188:189], v26 offset:19456
    v_mfma_f32_16x16x32_bf16 a[36:39], a[176:179], a[164:167], a[36:39]
    ds_read_b64_tr_b16 a[190:191], v26 offset:19968
    v_mfma_f32_16x16x32_bf16 a[40:43], a[176:179], a[168:171], a[40:43]
    ds_write_b128 v53, a[140:143] offset:256
    v_mfma_f32_16x16x32_bf16 a[44:47], a[176:179], a[172:175], a[44:47]
    s_waitcnt lgkmcnt(6)
    v_mfma_f32_16x16x32_bf16 a[108:111], a[180:183], a[172:175], a[108:111]
    v_mfma_f32_16x16x32_bf16 a[104:107], a[180:183], a[168:171], a[104:107]
    v_mfma_f32_16x16x32_bf16 a[100:103], a[180:183], a[164:167], a[100:103]
    v_mfma_f32_16x16x32_bf16 a[96:99], a[180:183], a[160:163], a[96:99]
    s_waitcnt vmcnt(8) lgkmcnt(0)
    s_barrier
    v_mfma_f32_16x16x32_bf16 a[48:51], a[184:187], a[160:163], a[48:51]
    ds_read_b128 v[14:17], v52
    v_xor_b32 v55, 64, v52
    v_mfma_f32_16x16x32_bf16 a[52:55], a[184:187], a[164:167], a[52:55]
    v_mul_f32 v31, 0x3e0293ee, v29
    v_mul_f32 v29, 0xbfb8aa3b, v29
    v_mfma_f32_16x16x32_bf16 a[56:59], a[184:187], a[168:171], a[56:59]
    ds_read_b128 v[18:21], v55
    v_mul_f32 v35, 0x3e0293ee, v33
    v_mfma_f32_16x16x32_bf16 a[60:63], a[184:187], a[172:175], a[60:63]
    v_mul_f32 v33, 0xbfb8aa3b, v33
    v_mul_f32 v39, 0x3e0293ee, v37
    v_mfma_f32_16x16x32_bf16 a[124:127], a[188:191], a[172:175], a[124:127]
    v_mul_f32 v37, 0xbfb8aa3b, v37
    v_mul_f32 v43, 0x3e0293ee, v41
    v_mfma_f32_16x16x32_bf16 a[120:123], a[188:191], a[168:171], a[120:123]
    v_mul_f32 v41, 0xbfb8aa3b, v41
    v_mov_b32_e64 v48, 0
    v_mfma_f32_16x16x32_bf16 a[116:119], a[188:191], a[164:167], a[116:119]
    v_mov_b32 v49, 0
    v_mov_b32 v50, 0
    v_mfma_f32_16x16x32_bf16 a[112:115], a[188:191], a[160:163], a[112:115]
    v_mov_b32_e64 v51, 0
    s_and_b32 s53, s2, 3
p1_gdone:
    v_xor_b32 v55, 128, v52
    ds_read_b128 v[22:25], v55
    s_waitcnt lgkmcnt(2)
    v_pk_fma_f32 v[128:129], v[14:15], v[28:29], v[128:129] op_sel_hi:[1,0,1]
    v_pk_fma_f32 v[130:131], v[16:17], v[28:29], v[130:131] op_sel_hi:[1,0,1]
    v_pk_fma_f32 v[132:133], v[14:15], v[32:33], v[132:133] op_sel_hi:[1,0,1]
    v_pk_fma_f32 v[134:135], v[16:17], v[32:33], v[134:135] op_sel_hi:[1,0,1]
    v_pk_fma_f32 v[136:137], v[14:15], v[36:37], v[136:137] op_sel_hi:[1,0,1]
    v_pk_fma_f32 v[138:139], v[16:17], v[36:37], v[138:139] op_sel_hi:[1,0,1]
    v_pk_fma_f32 v[140:141], v[14:15], v[40:41], v[140:141] op_sel_hi:[1,0,1]
    v_pk_fma_f32 v[142:143], v[16:17], v[40:41], v[142:143] op_sel_hi:[1,0,1]
    s_add_u32 m0, s89, 16384
    v_pk_mul_f32 v[128:129], v[128:129], v[30:31] op_sel:[0,1]
    v_pk_mul_f32 v[130:131], v[130:131], v[30:31] op_sel:[0,1]
    v_pk_mul_f32 v[132:133], v[132:133], v[34:35] op_sel:[0,1]
    v_pk_mul_f32 v[134:135], v[134:135], v[34:35] op_sel:[0,1]
    v_pk_mul_f32 v[136:137], v[136:137], v[38:39] op_sel:[0,1]
    v_pk_mul_f32 v[138:139], v[138:139], v[38:39] op_sel:[0,1]
    v_pk_mul_f32 v[140:141], v[140:141], v[42:43] op_sel:[0,1]
    v_pk_mul_f32 v[142:143], v[142:143], v[42:43] op_sel:[0,1]
    v_cvt_pk_bf16_f32 v64, v128, v129
    v_cvt_pk_bf16_f32 v65, v130, v131
    v_cvt_pk_bf16_f32 v66, v132, v133
    v_cvt_pk_bf16_f32 v67, v134, v135
    v_cvt_pk_bf16_f32 v96, v136, v137
    v_cvt_pk_bf16_f32 v97, v138, v139
    v_cvt_pk_bf16_f32 v98, v140, v141
    v_cvt_pk_bf16_f32 v99, v142, v143
    v_mfma_f32_32x32x16_bf16 a[128:143], v[48:51], v[48:51], 0
    buffer_load_dwordx4 v6, s[28:31], s88 offen offset:0 lds
    v_xor_b32 v55, 192, v52
    ds_read_b128 v[14:17], v55
    s_waitcnt lgkmcnt(2)
    v_pk_fma_f32 v[144:145], v[18:19], v[28:29], v[144:145] op_sel_hi:[1,0,1]
    v_pk_fma_f32 v[146:147], v[20:21], v[28:29], v[146:147] op_sel_hi:[1,0,1]
    v_pk_fma_f32 v[148:149], v[18:19], v[32:33], v[148:149] op_sel_hi:[1,0,1]
    v_pk_fma_f32 v[150:151], v[20:21], v[32:33], v[150:151] op_sel_hi:[1,0,1]
    v_pk_fma_f32 v[152:153], v[18:19], v[36:37], v[152:153] op_sel_hi:[1,0,1]
    v_pk_fma_f32 v[154:155], v[20:21], v[36:37], v[154:155] op_sel_hi:[1,0,1]
    v_pk_fma_f32 v[156:157], v[18:19], v[40:41], v[156:157] op_sel_hi:[1,0,1]
    v_pk_fma_f32 v[158:159], v[20:21], v[40:41], v[158:159] op_sel_hi:[1,0,1]
    v_pk_mul_f32 v[144:145], v[144:145], v[30:31] op_sel:[0,1]
    v_pk_mul_f32 v[146:147], v[146:147], v[30:31] op_sel:[0,1]
    v_pk_mul_f32 v[148:149], v[148:149], v[34:35] op_sel:[0,1]
    v_pk_mul_f32 v[150:151], v[150:151], v[34:35] op_sel:[0,1]
    v_pk_mul_f32 v[152:153], v[152:153], v[38:39] op_sel:[0,1]
    v_pk_mul_f32 v[154:155], v[154:155], v[38:39] op_sel:[0,1]
    v_pk_mul_f32 v[156:157], v[156:157], v[42:43] op_sel:[0,1]
    v_pk_mul_f32 v[158:159], v[158:159], v[42:43] op_sel:[0,1]
    buffer_load_dwordx4 v6, s[28:31], s88 offen offset:1024 lds
    v_cvt_pk_bf16_f32 v68, v144, v145
    v_cvt_pk_bf16_f32 v69, v146, v147
    v_cvt_pk_bf16_f32 v70, v148, v149
    v_cvt_pk_bf16_f32 v71, v150, v151
    v_cvt_pk_bf16_f32 v100, v152, v153
    v_cvt_pk_bf16_f32 v101, v154, v155
    v_cvt_pk_bf16_f32 v102, v156, v157
    v_cvt_pk_bf16_f32 v103, v158, v159
    v_mfma_f32_32x32x16_bf16 a[144:159], v[48:51], v[48:51], 0
    v_permlane16_swap_b32 v64, v66
    v_permlane16_swap_b32 v65, v67
    v_permlane16_swap_b32 v96, v98
    v_permlane16_swap_b32 v97, v99
    v_xor_b32 v55, 256, v52
    ds_read_b128 v[18:21], v55
    s_waitcnt lgkmcnt(2)
    v_pk_fma_f32 v[160:161], v[22:23], v[28:29], v[160:161] op_sel_hi:[1,0,1]
    v_pk_fma_f32 v[162:163], v[24:25], v[28:29], v[162:163] op_sel_hi:[1,0,1]
    v_pk_fma_f32 v[164:165], v[22:23], v[32:33], v[164:165] op_sel_hi:[1,0,1]
    v_pk_fma_f32 v[166:167], v[24:25], v[32:33], v[166:167] op_sel_hi:[1,0,1]
    v_pk_fma_f32 v[168:169], v[22:23], v[36:37], v[168:169] op_sel_hi:[1,0,1]
    v_pk_fma_f32 v[170:171], v[24:25], v[36:37], v[170:171] op_sel_hi:[1,0,1]
    v_pk_fma_f32 v[172:173], v[22:23], v[40:41], v[172:173] op_sel_hi:[1,0,1]
    v_pk_fma_f32 v[174:175], v[24:25], v[40:41], v[174:175] op_sel_hi:[1,0,1]
    buffer_load_dwordx4 v6, s[28:31], s88 offen offset:2048 lds
    v_pk_mul_f32 v[160:161], v[160:161], v[30:31] op_sel:[0,1]
    v_pk_mul_f32 v[162:163], v[162:163], v[30:31] op_sel:[0,1]
    v_pk_mul_f32 v[164:165], v[164:165], v[34:35] op_sel:[0,1]
    v_pk_mul_f32 v[166:167], v[166:167], v[34:35] op_sel:[0,1]
    v_pk_mul_f32 v[168:169], v[168:169], v[38:39] op_sel:[0,1]
    v_pk_mul_f32 v[170:171], v[170:171], v[38:39] op_sel:[0,1]
    v_pk_mul_f32 v[172:173], v[172:173], v[42:43] op_sel:[0,1]
    v_pk_mul_f32 v[174:175], v[174:175], v[42:43] op_sel:[0,1]
    v_cvt_pk_bf16_f32 v72, v160, v161
    v_cvt_pk_bf16_f32 v73, v162, v163
    v_cvt_pk_bf16_f32 v74, v164, v165
    v_cvt_pk_bf16_f32 v75, v166, v167
    v_cvt_pk_bf16_f32 v104, v168, v169
    v_cvt_pk_bf16_f32 v105, v170, v171
    v_cvt_pk_bf16_f32 v106, v172, v173
    v_cvt_pk_bf16_f32 v107, v174, v175
    v_mfma_f32_32x32x16_bf16 a[160:175], v[48:51], v[48:51], 0
    buffer_load_dwordx4 v6, s[28:31], s88 offen offset:3072 lds
    v_permlane16_swap_b32 v68, v70
    v_permlane16_swap_b32 v69, v71
    v_permlane16_swap_b32_e64 v100, v102
    v_permlane16_swap_b32 v101, v103
    v_xor_b32 v55, 320, v52
    ds_read_b128 v[22:25], v55
    s_waitcnt lgkmcnt(2)
    v_pk_fma_f32 v[176:177], v[14:15], v[28:29], v[176:177] op_sel_hi:[1,0,1]
    v_pk_fma_f32 v[178:179], v[16:17], v[28:29], v[178:179] op_sel_hi:[1,0,1]
    v_pk_fma_f32 v[180:181], v[14:15], v[32:33], v[180:181] op_sel_hi:[1,0,1]
    v_pk_fma_f32 v[182:183], v[16:17], v[32:33], v[182:183] op_sel_hi:[1,0,1]
    v_pk_fma_f32 v[184:185], v[14:15], v[36:37], v[184:185] op_sel_hi:[1,0,1]
    v_pk_fma_f32 v[186:187], v[16:17], v[36:37], v[186:187] op_sel_hi:[1,0,1]
    v_pk_fma_f32 v[188:189], v[14:15], v[40:41], v[188:189] op_sel_hi:[1,0,1]
    v_pk_fma_f32 v[190:191], v[16:17], v[40:41], v[190:191] op_sel_hi:[1,0,1]
    v_pk_mul_f32 v[176:177], v[176:177], v[30:31] op_sel:[0,1]
    v_pk_mul_f32 v[178:179], v[178:179], v[30:31] op_sel:[0,1]
    v_pk_mul_f32 v[180:181], v[180:181], v[34:35] op_sel:[0,1]
    v_pk_mul_f32 v[182:183], v[182:183], v[34:35] op_sel:[0,1]
    v_pk_mul_f32 v[184:185], v[184:185], v[38:39] op_sel:[0,1]
    v_pk_mul_f32 v[186:187], v[186:187], v[38:39] op_sel:[0,1]
    v_pk_mul_f32 v[188:189], v[188:189], v[42:43] op_sel:[0,1]
    v_pk_mul_f32 v[190:191], v[190:191], v[42:43] op_sel:[0,1]
    s_add_u32 s88, s88, 16384
    s_add_u32 s89, s89, 32768
    v_cvt_pk_bf16_f32 v76, v176, v177
    v_cvt_pk_bf16_f32 v77, v178, v179
    v_cvt_pk_bf16_f32 v78, v180, v181
    v_cvt_pk_bf16_f32 v79, v182, v183
    v_cvt_pk_bf16_f32 v108, v184, v185
    v_cvt_pk_bf16_f32 v109, v186, v187
    v_cvt_pk_bf16_f32 v110, v188, v189
    v_cvt_pk_bf16_f32 v111, v190, v191
    v_mfma_f32_32x32x16_bf16 a[176:191], v[48:51], v[48:51], 0
    v_permlane16_swap_b32 v72, v74
    v_permlane16_swap_b32 v73, v75
    v_permlane16_swap_b32_e64 v104, v106
    v_permlane16_swap_b32 v105, v107
    v_xor_b32 v55, 384, v52
    ds_read_b128 v[14:17], v55
    s_waitcnt lgkmcnt(2)
    v_pk_fma_f32 v[192:193], v[18:19], v[28:29], v[192:193] op_sel_hi:[1,0,1]
    v_pk_fma_f32 v[194:195], v[20:21], v[28:29], v[194:195] op_sel_hi:[1,0,1]
    v_pk_fma_f32 v[196:197], v[18:19], v[32:33], v[196:197] op_sel_hi:[1,0,1]
    v_pk_fma_f32 v[198:199], v[20:21], v[32:33], v[198:199] op_sel_hi:[1,0,1]
    v_pk_fma_f32 v[200:201], v[18:19], v[36:37], v[200:201] op_sel_hi:[1,0,1]
    v_pk_fma_f32 v[202:203], v[20:21], v[36:37], v[202:203] op_sel_hi:[1,0,1]
    v_pk_fma_f32 v[204:205], v[18:19], v[40:41], v[204:205] op_sel_hi:[1,0,1]
    v_pk_fma_f32 v[206:207], v[20:21], v[40:41], v[206:207] op_sel_hi:[1,0,1]
    v_pk_mul_f32 v[192:193], v[192:193], v[30:31] op_sel:[0,1]
    v_pk_mul_f32 v[194:195], v[194:195], v[30:31] op_sel:[0,1]
    v_pk_mul_f32 v[196:197], v[196:197], v[34:35] op_sel:[0,1]
    v_pk_mul_f32 v[198:199], v[198:199], v[34:35] op_sel:[0,1]
    v_pk_mul_f32 v[200:201], v[200:201], v[38:39] op_sel:[0,1]
    v_pk_mul_f32 v[202:203], v[202:203], v[38:39] op_sel:[0,1]
    v_pk_mul_f32 v[204:205], v[204:205], v[42:43] op_sel:[0,1]
    v_pk_mul_f32 v[206:207], v[206:207], v[42:43] op_sel:[0,1]
    s_lshl_b32 s6, s48, 13
    s_add_u32 m0, s6, 131072
    v_cvt_pk_bf16_f32 v80, v192, v193
    v_cvt_pk_bf16_f32 v81, v194, v195
    v_cvt_pk_bf16_f32 v82, v196, v197
    v_cvt_pk_bf16_f32 v83, v198, v199
    v_cvt_pk_bf16_f32 v112, v200, v201
    v_cvt_pk_bf16_f32 v113, v202, v203
    v_cvt_pk_bf16_f32 v114, v204, v205
    v_cvt_pk_bf16_f32 v115, v206, v207
    v_mfma_f32_32x32x16_bf16 a[192:207], v[48:51], v[48:51], 0
    v_permlane16_swap_b32 v76, v78
    v_permlane16_swap_b32 v77, v79
    v_permlane16_swap_b32 v108, v110
    v_permlane16_swap_b32 v109, v111
    v_xor_b32 v55, 448, v52
    ds_read_b128 v[18:21], v55
    s_waitcnt lgkmcnt(2)
    v_pk_fma_f32 v[208:209], v[22:23], v[28:29], v[208:209] op_sel_hi:[1,0,1]
    v_pk_fma_f32 v[210:211], v[24:25], v[28:29], v[210:211] op_sel_hi:[1,0,1]
    v_pk_fma_f32 v[212:213], v[22:23], v[32:33], v[212:213] op_sel_hi:[1,0,1]
    v_pk_fma_f32 v[214:215], v[24:25], v[32:33], v[214:215] op_sel_hi:[1,0,1]
    v_pk_fma_f32 v[216:217], v[22:23], v[36:37], v[216:217] op_sel_hi:[1,0,1]
    v_pk_fma_f32 v[218:219], v[24:25], v[36:37], v[218:219] op_sel_hi:[1,0,1]
    v_pk_fma_f32 v[220:221], v[22:23], v[40:41], v[220:221] op_sel_hi:[1,0,1]
    v_pk_fma_f32 v[222:223], v[24:25], v[40:41], v[222:223] op_sel_hi:[1,0,1]
    buffer_load_dwordx4 v56, s[40:43], s5 offen offset:0 lds
    s_add_u32 s5, s5, 9216
    v_pk_mul_f32 v[208:209], v[208:209], v[30:31] op_sel:[0,1]
    v_pk_mul_f32 v[210:211], v[210:211], v[30:31] op_sel:[0,1]
    v_pk_mul_f32 v[212:213], v[212:213], v[34:35] op_sel:[0,1]
    v_pk_mul_f32 v[214:215], v[214:215], v[34:35] op_sel:[0,1]
    v_pk_mul_f32 v[216:217], v[216:217], v[38:39] op_sel:[0,1]
    v_pk_mul_f32 v[218:219], v[218:219], v[38:39] op_sel:[0,1]
    v_pk_mul_f32 v[220:221], v[220:221], v[42:43] op_sel:[0,1]
    v_pk_mul_f32 v[222:223], v[222:223], v[42:43] op_sel:[0,1]
    v_cvt_pk_bf16_f32 v84, v208, v209
    v_cvt_pk_bf16_f32 v85, v210, v211
    v_cvt_pk_bf16_f32 v86, v212, v213
    v_cvt_pk_bf16_f32 v87, v214, v215
    v_cvt_pk_bf16_f32 v116, v216, v217
    v_cvt_pk_bf16_f32 v117, v218, v219
    v_cvt_pk_bf16_f32 v118, v220, v221
    v_cvt_pk_bf16_f32 v119, v222, v223
    v_mfma_f32_32x32x16_bf16 a[208:223], v[48:51], v[48:51], 0
    buffer_load_dwordx4 v56, s[40:43], s5 offen offset:1024 lds
    s_add_u32 s5, s5, 9216
    v_permlane16_swap_b32 v80, v82
    v_permlane16_swap_b32 v81, v83
    v_permlane16_swap_b32_e64 v112, v114
    v_permlane16_swap_b32 v113, v115
    s_waitcnt lgkmcnt(1)
    v_pk_fma_f32 v[224:225], v[14:15], v[28:29], v[224:225] op_sel_hi:[1,0,1]
    v_pk_fma_f32 v[226:227], v[16:17], v[28:29], v[226:227] op_sel_hi:[1,0,1]
    v_pk_fma_f32 v[228:229], v[14:15], v[32:33], v[228:229] op_sel_hi:[1,0,1]
    v_pk_fma_f32 v[230:231], v[16:17], v[32:33], v[230:231] op_sel_hi:[1,0,1]
    v_pk_fma_f32 v[232:233], v[14:15], v[36:37], v[232:233] op_sel_hi:[1,0,1]
    v_pk_fma_f32 v[234:235], v[16:17], v[36:37], v[234:235] op_sel_hi:[1,0,1]
    v_pk_fma_f32 v[236:237], v[14:15], v[40:41], v[236:237] op_sel_hi:[1,0,1]
    v_pk_fma_f32 v[238:239], v[16:17], v[40:41], v[238:239] op_sel_hi:[1,0,1]
    v_pk_mul_f32 v[224:225], v[224:225], v[30:31] op_sel:[0,1]
    v_pk_mul_f32 v[226:227], v[226:227], v[30:31] op_sel:[0,1]
    v_pk_mul_f32 v[228:229], v[228:229], v[34:35] op_sel:[0,1]
    v_pk_mul_f32 v[230:231], v[230:231], v[34:35] op_sel:[0,1]
    v_pk_mul_f32 v[232:233], v[232:233], v[38:39] op_sel:[0,1]
    v_pk_mul_f32 v[234:235], v[234:235], v[38:39] op_sel:[0,1]
    v_pk_mul_f32 v[236:237], v[236:237], v[42:43] op_sel:[0,1]
    v_pk_mul_f32 v[238:239], v[238:239], v[42:43] op_sel:[0,1]
    buffer_load_dwordx4 v56, s[40:43], s5 offen offset:2048 lds
    s_add_u32 s5, s5, 9216
    v_cvt_pk_bf16_f32 v88, v224, v225
    v_cvt_pk_bf16_f32 v89, v226, v227
    v_cvt_pk_bf16_f32 v90, v228, v229
    v_cvt_pk_bf16_f32 v91, v230, v231
    v_cvt_pk_bf16_f32 v120, v232, v233
    v_cvt_pk_bf16_f32 v121, v234, v235
    v_cvt_pk_bf16_f32 v122, v236, v237
    v_cvt_pk_bf16_f32 v123, v238, v239
    v_mfma_f32_32x32x16_bf16 a[224:239], v[48:51], v[48:51], 0
    v_permlane16_swap_b32 v84, v86
    v_permlane16_swap_b32 v85, v87
    v_permlane16_swap_b32_e64 v116, v118
    v_permlane16_swap_b32 v117, v119
    s_waitcnt lgkmcnt(0)
    v_pk_fma_f32 v[240:241], v[18:19], v[28:29], v[240:241] op_sel_hi:[1,0,1]
    v_pk_fma_f32 v[242:243], v[20:21], v[28:29], v[242:243] op_sel_hi:[1,0,1]
    v_pk_fma_f32 v[244:245], v[18:19], v[32:33], v[244:245] op_sel_hi:[1,0,1]
    v_pk_fma_f32 v[246:247], v[20:21], v[32:33], v[246:247] op_sel_hi:[1,0,1]
    v_pk_fma_f32 v[248:249], v[18:19], v[36:37], v[248:249] op_sel_hi:[1,0,1]
    v_pk_fma_f32 v[250:251], v[20:21], v[36:37], v[250:251] op_sel_hi:[1,0,1]
    v_pk_fma_f32 v[252:253], v[18:19], v[40:41], v[252:253] op_sel_hi:[1,0,1]
    v_pk_fma_f32 v[254:255], v[20:21], v[40:41], v[254:255] op_sel_hi:[1,0,1]
    buffer_load_dwordx4 v56, s[40:43], s5 offen offset:3072 lds
    s_sub_u32 s5, s5, 27520
    v_pk_mul_f32 v[240:241], v[240:241], v[30:31] op_sel:[0,1]
    v_pk_mul_f32 v[242:243], v[242:243], v[30:31] op_sel:[0,1]
    v_pk_mul_f32 v[244:245], v[244:245], v[34:35] op_sel:[0,1]
    v_pk_mul_f32 v[246:247], v[246:247], v[34:35] op_sel:[0,1]
    v_pk_mul_f32 v[248:249], v[248:249], v[38:39] op_sel:[0,1]
    v_pk_mul_f32 v[250:251], v[250:251], v[38:39] op_sel:[0,1]
    v_pk_mul_f32 v[252:253], v[252:253], v[42:43] op_sel:[0,1]
    v_pk_mul_f32 v[254:255], v[254:255], v[42:43] op_sel:[0,1]
    v_cvt_pk_bf16_f32 v92, v240, v241
    v_cvt_pk_bf16_f32 v93, v242, v243
    v_cvt_pk_bf16_f32 v94, v244, v245
    v_cvt_pk_bf16_f32 v95, v246, v247
    v_cvt_pk_bf16_f32 v124, v248, v249
    v_cvt_pk_bf16_f32 v125, v250, v251
    v_cvt_pk_bf16_f32 v126, v252, v253
    v_cvt_pk_bf16_f32 v127, v254, v255
    v_mfma_f32_32x32x16_bf16 a[240:255], v[48:51], v[48:51], 0
    v_permlane16_swap_b32 v88, v90
    v_permlane16_swap_b32 v89, v91
    v_permlane16_swap_b32 v120, v122
    v_permlane16_swap_b32 v121, v123
    s_nop 0
    v_permlane16_swap_b32 v92, v94
    v_permlane16_swap_b32 v93, v95
    v_permlane16_swap_b32 v124, v126
    v_permlane16_swap_b32 v125, v127
    v_xor_b32 v14, 0, v57
    v_xor_b32 v15, 32, v57
    v_xor_b32 v16, 64, v57
    v_xor_b32 v17, 96, v57
    v_xor_b32 v18, 128, v57
    v_xor_b32 v19, 160, v57
    v_xor_b32 v20, 192, v57
    v_xor_b32 v21, 224, v57
    s_cmp_eq_u32 s52, 0
    s_cbranch_scc1 p1_noffn
    v_xor_b32_e64 v55, 0, v53
    ds_read_b128 v[184:187], v55
    ds_read_b128 v[188:191], v55 offset:256
    v_xor_b32_e64 v55, 64, v53
    ds_read_b128 v[192:195], v55
    ds_read_b128 v[196:199], v55 offset:256
    v_xor_b32 v55, 128, v53
    ds_read_b128 v[200:203], v55
    ds_read_b128 v[204:207], v55 offset:256
    s_lshr_b32 s7, s48, 1
    s_lshl_b32 s6, s51, 1
    s_add_u32 s6, s6, 128
    s_add_u32 s61, s6, s7
    s_xor_b32 s7, s7, 1
    s_add_u32 s62, s6, s7
    s_lshl_b32 s78, s61, 12
    s_lshl_b32 s79, s62, 12
    s_waitcnt lgkmcnt(0)
    v_accvgpr_read_b32 v160, a0
    v_accvgpr_read_b32 v161, a1
    v_accvgpr_read_b32 v162, a2
    v_accvgpr_read_b32 v163, a3
    v_accvgpr_read_b32 v164, a64
    v_accvgpr_read_b32 v165, a65
    v_accvgpr_read_b32 v166, a66
    v_accvgpr_read_b32 v167, a67
    v_accvgpr_read_b32 v172, a4
    v_accvgpr_read_b32 v173, a5
    v_accvgpr_read_b32 v174, a6
    v_accvgpr_read_b32 v175, a7
    v_accvgpr_read_b32 v176, a68
    v_accvgpr_read_b32 v177, a69
    v_accvgpr_read_b32 v178, a70
    v_accvgpr_read_b32 v179, a71
    s_lshl_b32 s6, s48, 13
    s_add_u32 m0, s6, 135168
    v_pk_fma_f32 v[160:161], v[184:185], v[28:29], v[160:161] op_sel_hi:[1,0,1]
    v_pk_fma_f32 v[162:163], v[186:187], v[28:29], v[162:163] op_sel_hi:[1,0,1]
    v_pk_fma_f32 v[164:165], v[188:189], v[28:29], v[164:165] op_sel_hi:[1,0,1]
    v_pk_fma_f32 v[166:167], v[190:191], v[28:29], v[166:167] op_sel_hi:[1,0,1]
    v_pk_fma_f32 v[172:173], v[184:185], v[32:33], v[172:173] op_sel_hi:[1,0,1]
    v_pk_fma_f32 v[174:175], v[186:187], v[32:33], v[174:175] op_sel_hi:[1,0,1]
    v_pk_fma_f32 v[176:177], v[188:189], v[32:33], v[176:177] op_sel_hi:[1,0,1]
    v_pk_fma_f32 v[178:179], v[190:191], v[32:33], v[178:179] op_sel_hi:[1,0,1]
    v_pk_mul_f32 v[168:169], v[160:161], v[28:29] op_sel:[0,1]
    v_pk_mul_f32 v[170:171], v[162:163], v[28:29] op_sel:[0,1]
    v_pk_mul_f32 v[180:181], v[172:173], v[32:33] op_sel:[0,1]
    v_pk_mul_f32 v[182:183], v[174:175], v[32:33] op_sel:[0,1]
    v_exp_f32 v168, v168
    v_exp_f32 v169, v169
    v_exp_f32 v170, v170
    v_exp_f32 v171, v171
    v_exp_f32 v180, v180
    v_exp_f32 v181, v181
    v_exp_f32 v182, v182
    v_exp_f32_e64 v183, v183
    v_pk_mul_f32 v[160:161], v[160:161], v[164:165]
    v_pk_mul_f32 v[162:163], v[162:163], v[166:167]
    v_pk_mul_f32 v[172:173], v[172:173], v[176:177]
    v_pk_mul_f32 v[174:175], v[174:175], v[178:179]
    v_pk_fma_f32 v[168:169], v[168:169], v[30:31], v[30:31] op_sel_hi:[1,0,0]
    v_pk_fma_f32 v[170:171], v[170:171], v[30:31], v[30:31] op_sel_hi:[1,0,0]
    v_pk_fma_f32 v[180:181], v[180:181], v[34:35], v[34:35] op_sel_hi:[1,0,0]
    v_pk_fma_f32 v[182:183], v[182:183], v[34:35], v[34:35] op_sel_hi:[1,0,0]
    v_rcp_f32 v168, v168
    v_rcp_f32 v169, v169
    v_rcp_f32 v170, v170
    v_rcp_f32 v171, v171
    v_rcp_f32 v180, v180
    v_rcp_f32 v181, v181
    v_rcp_f32 v182, v182
    v_rcp_f32 v183, v183
    buffer_load_dwordx4 v56, s[40:43], s5 offen offset:0 lds
    s_add_u32 s5, s5, 9216
    v_pk_mul_f32 v[160:161], v[160:161], v[168:169]
    v_pk_mul_f32 v[162:163], v[162:163], v[170:171]
    v_pk_mul_f32 v[172:173], v[172:173], v[180:181]
    v_pk_mul_f32 v[174:175], v[174:175], v[182:183]
    v_cvt_pk_bf16_f32 v224, v160, v161
    v_cvt_pk_bf16_f32 v225, v162, v163
    v_cvt_pk_bf16_f32 v228, v172, v173
    v_cvt_pk_bf16_f32 v229, v174, v175
    v_accvgpr_read_b32 v160, a8
    v_accvgpr_read_b32 v161, a9
    v_accvgpr_read_b32 v162, a10
    v_accvgpr_read_b32 v163, a11
    v_accvgpr_read_b32 v164, a72
    v_accvgpr_read_b32 v165, a73
    v_accvgpr_read_b32 v166, a74
    v_accvgpr_read_b32 v167, a75
    v_accvgpr_read_b32 v172, a12
    v_accvgpr_read_b32 v173, a13
    v_accvgpr_read_b32 v174, a14
    v_accvgpr_read_b32 v175, a15
    v_accvgpr_read_b32 v176, a76
    v_accvgpr_read_b32 v177, a77
    v_accvgpr_read_b32 v178, a78
    v_accvgpr_read_b32 v179, a79
    v_pk_fma_f32 v[160:161], v[184:185], v[36:37], v[160:161] op_sel_hi:[1,0,1]
    v_pk_fma_f32 v[162:163], v[186:187], v[36:37], v[162:163] op_sel_hi:[1,0,1]
    v_pk_fma_f32 v[164:165], v[188:189], v[36:37], v[164:165] op_sel_hi:[1,0,1]
    v_pk_fma_f32 v[166:167], v[190:191], v[36:37], v[166:167] op_sel_hi:[1,0,1]
    v_pk_fma_f32 v[172:173], v[184:185], v[40:41], v[172:173] op_sel_hi:[1,0,1]
    v_pk_fma_f32 v[174:175], v[186:187], v[40:41], v[174:175] op_sel_hi:[1,0,1]
    v_pk_fma_f32 v[176:177], v[188:189], v[40:41], v[176:177] op_sel_hi:[1,0,1]
    v_pk_fma_f32 v[178:179], v[190:191], v[40:41], v[178:179] op_sel_hi:[1,0,1]
    v_pk_mul_f32 v[168:169], v[160:161], v[36:37] op_sel:[0,1]
    v_pk_mul_f32 v[170:171], v[162:163], v[36:37] op_sel:[0,1]
    v_pk_mul_f32 v[180:181], v[172:173], v[40:41] op_sel:[0,1]
    v_pk_mul_f32 v[182:183], v[174:175], v[40:41] op_sel:[0,1]
    v_exp_f32 v168, v168
    v_exp_f32 v169, v169
    v_exp_f32 v170, v170
    v_exp_f32 v171, v171
    v_exp_f32 v180, v180
    v_exp_f32 v181, v181
    v_exp_f32 v182, v182
    v_exp_f32 v183, v183
    buffer_load_dwordx4 v56, s[40:43], s5 offen offset:1024 lds
    s_add_u32 s5, s5, 9216
    v_pk_mul_f32 v[160:161], v[160:161], v[164:165]
    v_pk_mul_f32 v[162:163], v[162:163], v[166:167]
    v_pk_mul_f32 v[172:173], v[172:173], v[176:177]
    v_pk_mul_f32 v[174:175], v[174:175], v[178:179]
    v_pk_fma_f32 v[168:169], v[168:169], v[38:39], v[38:39] op_sel_hi:[1,0,0]
    v_pk_fma_f32 v[170:171], v[170:171], v[38:39], v[38:39] op_sel_hi:[1,0,0]
    v_pk_fma_f32 v[180:181], v[180:181], v[42:43], v[42:43] op_sel_hi:[1,0,0]
    v_pk_fma_f32 v[182:183], v[182:183], v[42:43], v[42:43] op_sel_hi:[1,0,0]
    v_rcp_f32 v168, v168
    v_rcp_f32 v169, v169
    v_rcp_f32 v170, v170
    v_rcp_f32 v171, v171
    v_rcp_f32 v180, v180
    v_rcp_f32 v181, v181
    v_rcp_f32 v182, v182
    v_rcp_f32 v183, v183
    v_pk_mul_f32 v[160:161], v[160:161], v[168:169]
    v_pk_mul_f32 v[162:163], v[162:163], v[170:171]
    v_pk_mul_f32 v[172:173], v[172:173], v[180:181]
    v_pk_mul_f32 v[174:175], v[174:175], v[182:183]
    v_cvt_pk_bf16_f32 v232, v160, v161
    v_cvt_pk_bf16_f32 v233, v162, v163
    v_cvt_pk_bf16_f32 v236, v172, v173
    v_cvt_pk_bf16_f32 v237, v174, v175
    v_xor_b32 v55, 192, v53
    ds_read_b128 v[184:187], v55
    ds_read_b128 v[188:191], v55 offset:256
    v_accvgpr_read_b32 v160, a16
    v_accvgpr_read_b32 v161, a17
    v_accvgpr_read_b32 v162, a18
    v_accvgpr_read_b32 v163, a19
    v_accvgpr_read_b32 v164, a80
    v_accvgpr_read_b32 v165, a81
    v_accvgpr_read_b32 v166, a82
    v_accvgpr_read_b32 v167, a83
    v_accvgpr_read_b32 v172, a20
    v_accvgpr_read_b32 v173, a21
    v_accvgpr_read_b32 v174, a22
    v_accvgpr_read_b32 v175, a23
    v_accvgpr_read_b32 v176, a84
    v_accvgpr_read_b32 v177, a85
    v_accvgpr_read_b32 v178, a86
    v_accvgpr_read_b32 v179, a87
    v_pk_fma_f32 v[160:161], v[192:193], v[28:29], v[160:161] op_sel_hi:[1,0,1]
    v_pk_fma_f32 v[162:163], v[194:195], v[28:29], v[162:163] op_sel_hi:[1,0,1]
    v_pk_fma_f32 v[164:165], v[196:197], v[28:29], v[164:165] op_sel_hi:[1,0,1]
    v_pk_fma_f32 v[166:167], v[198:199], v[28:29], v[166:167] op_sel_hi:[1,0,1]
    v_pk_fma_f32 v[172:173], v[192:193], v[32:33], v[172:173] op_sel_hi:[1,0,1]
    v_pk_fma_f32 v[174:175], v[194:195], v[32:33], v[174:175] op_sel_hi:[1,0,1]
    v_pk_fma_f32 v[176:177], v[196:197], v[32:33], v[176:177] op_sel_hi:[1,0,1]
    v_pk_fma_f32 v[178:179], v[198:199], v[32:33], v[178:179] op_sel_hi:[1,0,1]
    v_pk_mul_f32 v[168:169], v[160:161], v[28:29] op_sel:[0,1]
    v_pk_mul_f32 v[170:171], v[162:163], v[28:29] op_sel:[0,1]
    v_pk_mul_f32 v[180:181], v[172:173], v[32:33] op_sel:[0,1]
    v_pk_mul_f32 v[182:183], v[174:175], v[32:33] op_sel:[0,1]
    v_exp_f32 v168, v168
    v_exp_f32 v169, v169
    v_exp_f32 v170, v170
    v_exp_f32 v171, v171
    v_exp_f32 v180, v180
    v_exp_f32 v181, v181
    v_exp_f32 v182, v182
    v_exp_f32 v183, v183
    buffer_load_dwordx4 v56, s[40:43], s5 offen offset:2048 lds
    s_add_u32 s5, s5, 9216
    v_pk_mul_f32 v[160:161], v[160:161], v[164:165]
    v_pk_mul_f32 v[162:163], v[162:163], v[166:167]
    v_pk_mul_f32 v[172:173], v[172:173], v[176:177]
    v_pk_mul_f32 v[174:175], v[174:175], v[178:179]
    v_pk_fma_f32 v[168:169], v[168:169], v[30:31], v[30:31] op_sel_hi:[1,0,0]
    v_pk_fma_f32 v[170:171], v[170:171], v[30:31], v[30:31] op_sel_hi:[1,0,0]
    v_pk_fma_f32 v[180:181], v[180:181], v[34:35], v[34:35] op_sel_hi:[1,0,0]
    v_pk_fma_f32 v[182:183], v[182:183], v[34:35], v[34:35] op_sel_hi:[1,0,0]
    v_rcp_f32 v168, v168
    v_rcp_f32 v169, v169
    v_rcp_f32 v170, v170
    v_rcp_f32 v171, v171
    v_rcp_f32 v180, v180
    v_rcp_f32 v181, v181
    v_rcp_f32 v182, v182
    v_rcp_f32 v183, v183
    v_pk_mul_f32 v[160:161], v[160:161], v[168:169]
    v_pk_mul_f32 v[162:163], v[162:163], v[170:171]
    v_pk_mul_f32 v[172:173], v[172:173], v[180:181]
    v_pk_mul_f32 v[174:175], v[174:175], v[182:183]
    v_cvt_pk_bf16_f32 v226, v160, v161
    v_cvt_pk_bf16_f32 v227, v162, v163
    v_cvt_pk_bf16_f32 v230, v172, v173
    v_cvt_pk_bf16_f32 v231, v174, v175
    v_accvgpr_read_b32 v160, a24
    v_accvgpr_read_b32 v161, a25
    v_accvgpr_read_b32 v162, a26
    v_accvgpr_read_b32 v163, a27
    v_accvgpr_read_b32 v164, a88
    v_accvgpr_read_b32 v165, a89
    v_accvgpr_read_b32 v166, a90
    v_accvgpr_read_b32 v167, a91
    v_accvgpr_read_b32 v172, a28
    v_accvgpr_read_b32 v173, a29
    v_accvgpr_read_b32 v174, a30
    v_accvgpr_read_b32 v175, a31
    v_accvgpr_read_b32 v176, a92
    v_accvgpr_read_b32 v177, a93
    v_accvgpr_read_b32 v178, a94
    v_accvgpr_read_b32 v179, a95
    buffer_load_dwordx4 v56, s[40:43], s5 offen offset:3072 lds
    s_sub_u32 s5, s5, 27520
    v_pk_fma_f32 v[160:161], v[192:193], v[36:37], v[160:161] op_sel_hi:[1,0,1]
    v_pk_fma_f32 v[162:163], v[194:195], v[36:37], v[162:163] op_sel_hi:[1,0,1]
    v_pk_fma_f32 v[164:165], v[196:197], v[36:37], v[164:165] op_sel_hi:[1,0,1]
    v_pk_fma_f32 v[166:167], v[198:199], v[36:37], v[166:167] op_sel_hi:[1,0,1]
    v_pk_fma_f32 v[172:173], v[192:193], v[40:41], v[172:173] op_sel_hi:[1,0,1]
    v_pk_fma_f32 v[174:175], v[194:195], v[40:41], v[174:175] op_sel_hi:[1,0,1]
    v_pk_fma_f32 v[176:177], v[196:197], v[40:41], v[176:177] op_sel_hi:[1,0,1]
    v_pk_fma_f32 v[178:179], v[198:199], v[40:41], v[178:179] op_sel_hi:[1,0,1]
    v_pk_mul_f32 v[168:169], v[160:161], v[36:37] op_sel:[0,1]
    v_pk_mul_f32 v[170:171], v[162:163], v[36:37] op_sel:[0,1]
    v_pk_mul_f32 v[180:181], v[172:173], v[40:41] op_sel:[0,1]
    v_pk_mul_f32 v[182:183], v[174:175], v[40:41] op_sel:[0,1]
    v_exp_f32 v168, v168
    v_exp_f32 v169, v169
    v_exp_f32 v170, v170
    v_exp_f32 v171, v171
    v_exp_f32 v180, v180
    v_exp_f32 v181, v181
    v_exp_f32 v182, v182
    v_exp_f32 v183, v183
    v_pk_mul_f32 v[160:161], v[160:161], v[164:165]
    v_pk_mul_f32 v[162:163], v[162:163], v[166:167]
    v_pk_mul_f32 v[172:173], v[172:173], v[176:177]
    v_pk_mul_f32 v[174:175], v[174:175], v[178:179]
    v_pk_fma_f32 v[168:169], v[168:169], v[38:39], v[38:39] op_sel_hi:[1,0,0]
    v_pk_fma_f32 v[170:171], v[170:171], v[38:39], v[38:39] op_sel_hi:[1,0,0]
    v_pk_fma_f32 v[180:181], v[180:181], v[42:43], v[42:43] op_sel_hi:[1,0,0]
    v_pk_fma_f32 v[182:183], v[182:183], v[42:43], v[42:43] op_sel_hi:[1,0,0]
    v_rcp_f32 v168, v168
    v_rcp_f32 v169, v169
    v_rcp_f32 v170, v170
    v_rcp_f32 v171, v171
    v_rcp_f32 v180, v180
    v_rcp_f32 v181, v181
    v_rcp_f32_e64 v182, v182
    v_rcp_f32 v183, v183
    v_pk_mul_f32 v[160:161], v[160:161], v[168:169]
    v_pk_mul_f32 v[162:163], v[162:163], v[170:171]
    v_pk_mul_f32 v[172:173], v[172:173], v[180:181]
    v_pk_mul_f32 v[174:175], v[174:175], v[182:183]
    v_cvt_pk_bf16_f32 v234, v160, v161
    v_cvt_pk_bf16_f32 v235, v162, v163
    v_cvt_pk_bf16_f32 v238, v172, v173
    v_cvt_pk_bf16_f32 v239, v174, v175
    s_bitcmp1_b32 s48, 0
    s_cbranch_scc0 p1_nsw0
    v_swap_b32 v224, v226
    v_swap_b32 v225, v227
    v_swap_b32 v228, v230
    v_swap_b32 v229, v231
    v_swap_b32 v232, v234
    v_swap_b32 v233, v235
    v_swap_b32 v236, v238
    v_swap_b32 v237, v239
p1_nsw0:
    s_waitcnt lgkmcnt(0)
    v_accvgpr_read_b32 v160, a32
    v_accvgpr_read_b32 v161, a33
    v_accvgpr_read_b32 v162, a34
    v_accvgpr_read_b32 v163, a35
    ds_read_b128 v[208:211], v14 offset:0
    ds_read_b128 v[212:215], v15 offset:0
    ds_read_b128 v[216:219], v16 offset:0
    v_accvgpr_read_b32 v164, a96
    v_accvgpr_read_b32 v165, a97
    v_accvgpr_read_b32 v166, a98
    v_accvgpr_read_b32 v167, a99
    v_accvgpr_read_b32 v172, a36
    v_accvgpr_read_b32 v173, a37
    v_accvgpr_read_b32 v174, a38
    v_accvgpr_read_b32 v175, a39
    v_accvgpr_read_b32 v176, a100
    v_accvgpr_read_b32 v177, a101
    v_accvgpr_read_b32 v178, a102
    v_accvgpr_read_b32 v179, a103
    s_mov_b32 m0, s89
    s_waitcnt lgkmcnt(2)
    v_mfma_f32_32x32x16_bf16 v[128:143], v[208:211], v[64:67], 0
    ds_read_b128 v[220:223], v17 offset:0
    v_pk_fma_f32 v[160:161], v[200:201], v[28:29], v[160:161] op_sel_hi:[1,0,1]
    v_pk_fma_f32 v[162:163], v[202:203], v[28:29], v[162:163] op_sel_hi:[1,0,1]
    v_pk_fma_f32 v[164:165], v[204:205], v[28:29], v[164:165] op_sel_hi:[1,0,1]
    v_pk_fma_f32 v[166:167], v[206:207], v[28:29], v[166:167] op_sel_hi:[1,0,1]
    v_pk_fma_f32 v[172:173], v[200:201], v[32:33], v[172:173] op_sel_hi:[1,0,1]
    v_pk_fma_f32 v[174:175], v[202:203], v[32:33], v[174:175] op_sel_hi:[1,0,1]
    v_pk_fma_f32 v[176:177], v[204:205], v[32:33], v[176:177] op_sel_hi:[1,0,1]
    v_pk_fma_f32 v[178:179], v[206:207], v[32:33], v[178:179] op_sel_hi:[1,0,1]
    v_pk_mul_f32 v[168:169], v[160:161], v[28:29] op_sel:[0,1]
    v_pk_mul_f32 v[170:171], v[162:163], v[28:29] op_sel:[0,1]
    v_pk_mul_f32 v[180:181], v[172:173], v[32:33] op_sel:[0,1]
    v_pk_mul_f32 v[182:183], v[174:175], v[32:33] op_sel:[0,1]
    v_exp_f32 v168, v168
    v_exp_f32 v169, v169
    v_mfma_f32_32x32x16_bf16 v[144:159], v[208:211], v[96:99], 0
    v_exp_f32 v170, v170
    v_exp_f32 v171, v171
    v_exp_f32 v180, v180
    v_exp_f32 v181, v181
    v_exp_f32 v182, v182
    v_exp_f32 v183, v183
    v_pk_mul_f32 v[160:161], v[160:161], v[164:165]
    v_pk_mul_f32 v[162:163], v[162:163], v[166:167]
    v_pk_mul_f32 v[172:173], v[172:173], v[176:177]
    v_pk_mul_f32 v[174:175], v[174:175], v[178:179]
    v_pk_fma_f32 v[168:169], v[168:169], v[30:31], v[30:31] op_sel_hi:[1,0,0]
    v_pk_fma_f32 v[170:171], v[170:171], v[30:31], v[30:31] op_sel_hi:[1,0,0]
    v_pk_fma_f32 v[180:181], v[180:181], v[34:35], v[34:35] op_sel_hi:[1,0,0]
    v_pk_fma_f32 v[182:183], v[182:183], v[34:35], v[34:35] op_sel_hi:[1,0,0]
    v_rcp_f32_e64 v168, v168
    v_rcp_f32 v169, v169
    s_waitcnt lgkmcnt(2)
    v_mfma_f32_32x32x16_bf16 v[128:143], v[212:215], v[68:71], v[128:143]
    ds_read_b128 v[208:211], v18 offset:0
    v_rcp_f32 v170, v170
    v_rcp_f32 v171, v171
    v_rcp_f32 v180, v180
    v_rcp_f32 v181, v181
    v_rcp_f32_e64 v182, v182
    v_rcp_f32 v183, v183
    buffer_load_dwordx4 v2, s[24:27], s88 offen offset:0 lds
    v_pk_mul_f32 v[160:161], v[160:161], v[168:169]
    v_pk_mul_f32 v[162:163], v[162:163], v[170:171]
    v_pk_mul_f32 v[172:173], v[172:173], v[180:181]
    v_pk_mul_f32 v[174:175], v[174:175], v[182:183]
    v_cvt_pk_bf16_f32 v240, v160, v161
    v_cvt_pk_bf16_f32 v241, v162, v163
    v_mfma_f32_32x32x16_bf16 v[144:159], v[212:215], v[100:103], v[144:159]
    v_cvt_pk_bf16_f32 v244, v172, v173
    v_cvt_pk_bf16_f32 v245, v174, v175
    v_accvgpr_read_b32 v160, a40
    v_accvgpr_read_b32 v161, a41
    v_accvgpr_read_b32 v162, a42
    v_accvgpr_read_b32 v163, a43
    v_accvgpr_read_b32 v164, a104
    v_accvgpr_read_b32 v165, a105
    v_accvgpr_read_b32 v166, a106
    s_waitcnt lgkmcnt(2)
    v_mfma_f32_32x32x16_bf16 v[128:143], v[216:219], v[72:75], v[128:143]
    ds_read_b128 v[212:215], v19 offset:0
    v_accvgpr_read_b32 v167, a107
    v_accvgpr_read_b32 v172, a44
    v_accvgpr_read_b32 v173, a45
    v_accvgpr_read_b32 v174, a46
    v_accvgpr_read_b32 v175, a47
    v_accvgpr_read_b32 v176, a108
    v_accvgpr_read_b32 v177, a109
    v_accvgpr_read_b32 v178, a110
    v_accvgpr_read_b32 v179, a111
    v_pk_fma_f32 v[160:161], v[200:201], v[36:37], v[160:161] op_sel_hi:[1,0,1]
    v_pk_fma_f32 v[162:163], v[202:203], v[36:37], v[162:163] op_sel_hi:[1,0,1]
    v_pk_fma_f32 v[164:165], v[204:205], v[36:37], v[164:165] op_sel_hi:[1,0,1]
    v_pk_fma_f32 v[166:167], v[206:207], v[36:37], v[166:167] op_sel_hi:[1,0,1]
    v_pk_fma_f32 v[172:173], v[200:201], v[40:41], v[172:173] op_sel_hi:[1,0,1]
    v_pk_fma_f32 v[174:175], v[202:203], v[40:41], v[174:175] op_sel_hi:[1,0,1]
    v_pk_fma_f32 v[176:177], v[204:205], v[40:41], v[176:177] op_sel_hi:[1,0,1]
    v_pk_fma_f32 v[178:179], v[206:207], v[40:41], v[178:179] op_sel_hi:[1,0,1]
    v_pk_mul_f32 v[168:169], v[160:161], v[36:37] op_sel:[0,1]
    v_pk_mul_f32 v[170:171], v[162:163], v[36:37] op_sel:[0,1]
    v_pk_mul_f32 v[180:181], v[172:173], v[40:41] op_sel:[0,1]
    v_pk_mul_f32 v[182:183], v[174:175], v[40:41] op_sel:[0,1]
    v_exp_f32 v168, v168
    v_exp_f32 v169, v169
    v_mfma_f32_32x32x16_bf16 v[144:159], v[216:219], v[104:107], v[144:159]
    v_exp_f32 v170, v170
    v_exp_f32 v171, v171
    v_exp_f32 v180, v180
    s_waitcnt lgkmcnt(2)
    v_mfma_f32_32x32x16_bf16 v[128:143], v[220:223], v[76:79], v[128:143]
    ds_read_b128 v[216:219], v20 offset:0
    v_exp_f32 v181, v181
    v_exp_f32 v182, v182
    v_exp_f32_e64 v183, v183
    buffer_load_dwordx4 v3, s[24:27], s88 offen offset:1024 lds
    v_pk_mul_f32 v[160:161], v[160:161], v[164:165]
    v_pk_mul_f32 v[162:163], v[162:163], v[166:167]
    v_pk_mul_f32 v[172:173], v[172:173], v[176:177]
    v_pk_mul_f32 v[174:175], v[174:175], v[178:179]
    v_pk_fma_f32 v[168:169], v[168:169], v[38:39], v[38:39] op_sel_hi:[1,0,0]
    v_pk_fma_f32 v[170:171], v[170:171], v[38:39], v[38:39] op_sel_hi:[1,0,0]
    v_pk_fma_f32 v[180:181], v[180:181], v[42:43], v[42:43] op_sel_hi:[1,0,0]
    v_pk_fma_f32 v[182:183], v[182:183], v[42:43], v[42:43] op_sel_hi:[1,0,0]
    v_rcp_f32 v168, v168
    v_rcp_f32 v169, v169
    v_mfma_f32_32x32x16_bf16 v[144:159], v[220:223], v[108:111], v[144:159]
    v_rcp_f32 v170, v170
    v_rcp_f32 v171, v171
    v_rcp_f32 v180, v180
    v_rcp_f32 v181, v181
    v_rcp_f32_e64 v182, v182
    v_rcp_f32 v183, v183
    v_pk_mul_f32 v[160:161], v[160:161], v[168:169]
    v_pk_mul_f32 v[162:163], v[162:163], v[170:171]
    v_pk_mul_f32 v[172:173], v[172:173], v[180:181]
    v_pk_mul_f32 v[174:175], v[174:175], v[182:183]
    v_cvt_pk_bf16_f32 v248, v160, v161
    v_cvt_pk_bf16_f32 v249, v162, v163
    s_waitcnt lgkmcnt(2)
    v_mfma_f32_32x32x16_bf16 v[128:143], v[208:211], v[80:83], v[128:143]
    ds_read_b128 v[220:223], v21 offset:0
    v_cvt_pk_bf16_f32 v252, v172, v173
    v_cvt_pk_bf16_f32 v253, v174, v175
    v_accvgpr_read_b32 v160, a48
    v_accvgpr_read_b32 v161, a49
    v_accvgpr_read_b32 v162, a50
    v_accvgpr_read_b32 v163, a51
    v_accvgpr_read_b32 v164, a112
    v_accvgpr_read_b32 v165, a113
    v_accvgpr_read_b32 v166, a114
    v_accvgpr_read_b32 v167, a115
    v_accvgpr_read_b32 v172, a52
    v_accvgpr_read_b32 v173, a53
    v_accvgpr_read_b32 v174, a54
    v_mfma_f32_32x32x16_bf16 v[144:159], v[208:211], v[112:115], v[144:159]
    v_accvgpr_read_b32 v175, a55
    v_accvgpr_read_b32 v176, a116
    v_accvgpr_read_b32 v177, a117
    v_accvgpr_read_b32 v178, a118
    v_accvgpr_read_b32 v179, a119
    v_pk_fma_f32 v[160:161], v[184:185], v[28:29], v[160:161] op_sel_hi:[1,0,1]
    v_pk_fma_f32 v[162:163], v[186:187], v[28:29], v[162:163] op_sel_hi:[1,0,1]
    v_pk_fma_f32 v[164:165], v[188:189], v[28:29], v[164:165] op_sel_hi:[1,0,1]
    v_pk_fma_f32 v[166:167], v[190:191], v[28:29], v[166:167] op_sel_hi:[1,0,1]
    v_pk_fma_f32 v[172:173], v[184:185], v[32:33], v[172:173] op_sel_hi:[1,0,1]
    v_pk_fma_f32 v[174:175], v[186:187], v[32:33], v[174:175] op_sel_hi:[1,0,1]
    v_pk_fma_f32 v[176:177], v[188:189], v[32:33], v[176:177] op_sel_hi:[1,0,1]
    v_pk_fma_f32 v[178:179], v[190:191], v[32:33], v[178:179] op_sel_hi:[1,0,1]
    v_pk_mul_f32 v[168:169], v[160:161], v[28:29] op_sel:[0,1]
    v_pk_mul_f32 v[170:171], v[162:163], v[28:29] op_sel:[0,1]
    v_pk_mul_f32 v[180:181], v[172:173], v[32:33] op_sel:[0,1]
    v_pk_mul_f32 v[182:183], v[174:175], v[32:33] op_sel:[0,1]
    v_exp_f32_e64 v168, v168
    v_exp_f32 v169, v169
    s_waitcnt lgkmcnt(2)
    v_mfma_f32_32x32x16_bf16 v[128:143], v[212:215], v[84:87], v[128:143]
    v_exp_f32 v170, v170
    v_exp_f32 v171, v171
    v_exp_f32 v180, v180
    v_exp_f32 v181, v181
    v_exp_f32 v182, v182
    v_exp_f32 v183, v183
    buffer_load_dwordx4 v4, s[24:27], s88 offen offset:2048 lds
    v_mfma_f32_32x32x16_bf16 v[144:159], v[212:215], v[116:119], v[144:159]
    v_pk_mul_f32 v[160:161], v[160:161], v[164:165]
    v_pk_mul_f32 v[162:163], v[162:163], v[166:167]
    v_pk_mul_f32 v[172:173], v[172:173], v[176:177]
    v_pk_mul_f32 v[174:175], v[174:175], v[178:179]
    v_pk_fma_f32 v[168:169], v[168:169], v[30:31], v[30:31] op_sel_hi:[1,0,0]
    v_pk_fma_f32 v[170:171], v[170:171], v[30:31], v[30:31] op_sel_hi:[1,0,0]
    v_pk_fma_f32 v[180:181], v[180:181], v[34:35], v[34:35] op_sel_hi:[1,0,0]
    v_pk_fma_f32 v[182:183], v[182:183], v[34:35], v[34:35] op_sel_hi:[1,0,0]
    v_rcp_f32 v168, v168
    v_rcp_f32 v169, v169
    v_rcp_f32 v170, v170
    v_rcp_f32 v171, v171
    v_rcp_f32 v180, v180
    s_waitcnt lgkmcnt(1)
    v_mfma_f32_32x32x16_bf16 v[128:143], v[216:219], v[88:91], v[128:143]
    v_rcp_f32 v181, v181
    v_rcp_f32 v182, v182
    v_rcp_f32_e64 v183, v183
    v_pk_mul_f32 v[160:161], v[160:161], v[168:169]
    v_pk_mul_f32 v[162:163], v[162:163], v[170:171]
    v_pk_mul_f32 v[172:173], v[172:173], v[180:181]
    v_pk_mul_f32 v[174:175], v[174:175], v[182:183]
    v_cvt_pk_bf16_f32 v242, v160, v161
    v_cvt_pk_bf16_f32 v243, v162, v163
    v_cvt_pk_bf16_f32 v246, v172, v173
    v_cvt_pk_bf16_f32 v247, v174, v175
    v_accvgpr_read_b32 v160, a56
    v_accvgpr_read_b32 v161, a57
    v_mfma_f32_32x32x16_bf16 v[144:159], v[216:219], v[120:123], v[144:159]
    v_accvgpr_read_b32 v162, a58
    v_accvgpr_read_b32 v163, a59
    v_accvgpr_read_b32 v164, a120
    v_accvgpr_read_b32 v165, a121
    v_accvgpr_read_b32 v166, a122
    v_accvgpr_read_b32 v167, a123
    v_accvgpr_read_b32 v172, a60
    v_accvgpr_read_b32 v173, a61
    v_accvgpr_read_b32 v174, a62
    v_accvgpr_read_b32 v175, a63
    v_accvgpr_read_b32 v176, a124
    v_accvgpr_read_b32 v177, a125
    v_accvgpr_read_b32 v178, a126
    s_waitcnt lgkmcnt(0)
    v_mfma_f32_32x32x16_bf16 v[128:143], v[220:223], v[92:95], v[128:143]
    v_accvgpr_read_b32 v179, a127
    buffer_load_dwordx4 v5, s[24:27], s88 offen offset:3072 lds
    v_pk_fma_f32 v[160:161], v[184:185], v[36:37], v[160:161] op_sel_hi:[1,0,1]
    v_pk_fma_f32 v[162:163], v[186:187], v[36:37], v[162:163] op_sel_hi:[1,0,1]
    v_pk_fma_f32 v[164:165], v[188:189], v[36:37], v[164:165] op_sel_hi:[1,0,1]
    v_pk_fma_f32 v[166:167], v[190:191], v[36:37], v[166:167] op_sel_hi:[1,0,1]
    v_pk_fma_f32 v[172:173], v[184:185], v[40:41], v[172:173] op_sel_hi:[1,0,1]
    v_pk_fma_f32 v[174:175], v[186:187], v[40:41], v[174:175] op_sel_hi:[1,0,1]
    v_pk_fma_f32 v[176:177], v[188:189], v[40:41], v[176:177] op_sel_hi:[1,0,1]
    v_pk_fma_f32 v[178:179], v[190:191], v[40:41], v[178:179] op_sel_hi:[1,0,1]
    v_pk_mul_f32 v[168:169], v[160:161], v[36:37] op_sel:[0,1]
    v_pk_mul_f32 v[170:171], v[162:163], v[36:37] op_sel:[0,1]
    v_pk_mul_f32 v[180:181], v[172:173], v[40:41] op_sel:[0,1]
    v_pk_mul_f32 v[182:183], v[174:175], v[40:41] op_sel:[0,1]
    v_exp_f32 v168, v168
    v_exp_f32_e64 v169, v169
    v_mfma_f32_32x32x16_bf16 v[144:159], v[220:223], v[124:127], v[144:159]
    v_exp_f32 v170, v170
    v_exp_f32 v171, v171
    v_exp_f32 v180, v180
    v_exp_f32 v181, v181
    v_exp_f32 v182, v182
    v_exp_f32 v183, v183
    v_pk_mul_f32 v[160:161], v[160:161], v[164:165]
    v_pk_mul_f32 v[162:163], v[162:163], v[166:167]
    v_pk_mul_f32 v[172:173], v[172:173], v[176:177]
    v_pk_mul_f32 v[174:175], v[174:175], v[178:179]
    v_pk_fma_f32 v[168:169], v[168:169], v[38:39], v[38:39] op_sel_hi:[1,0,0]
    v_pk_fma_f32 v[170:171], v[170:171], v[38:39], v[38:39] op_sel_hi:[1,0,0]
    v_pk_fma_f32 v[180:181], v[180:181], v[42:43], v[42:43] op_sel_hi:[1,0,0]
    v_pk_fma_f32 v[182:183], v[182:183], v[42:43], v[42:43] op_sel_hi:[1,0,0]
    v_rcp_f32 v168, v168
    v_rcp_f32 v169, v169
    v_rcp_f32 v170, v170
    v_rcp_f32 v171, v171
    v_rcp_f32 v180, v180
    v_rcp_f32 v181, v181
    v_rcp_f32 v182, v182
    v_rcp_f32 v183, v183
    v_pk_mul_f32 v[160:161], v[160:161], v[168:169]
    v_pk_mul_f32 v[162:163], v[162:163], v[170:171]
    v_pk_mul_f32 v[172:173], v[172:173], v[180:181]
    v_pk_mul_f32 v[174:175], v[174:175], v[182:183]
    v_cvt_pk_bf16_f32 v250, v160, v161
    v_cvt_pk_bf16_f32 v251, v162, v163
    v_cvt_pk_bf16_f32 v254, v172, v173
    v_cvt_pk_bf16_f32 v255, v174, v175
    s_bitcmp1_b32 s48, 0
    s_cbranch_scc0 p1_nsw1
    v_swap_b32 v240, v242
    v_swap_b32 v241, v243
    v_swap_b32 v244, v246
    v_swap_b32 v245, v247
    v_swap_b32 v248, v250
    v_swap_b32 v249, v251
    v_swap_b32 v252, v254
    v_swap_b32 v253, v255
p1_nsw1:
    s_add_u32 m0, s89, 16384
    s_nop 0
    buffer_load_dwordx4 v6, s[28:31], s88 offen offset:0 lds
    buffer_load_dwordx4 v6, s[28:31], s88 offen offset:1024 lds
    buffer_load_dwordx4 v6, s[28:31], s88 offen offset:2048 lds
    buffer_load_dwordx4 v6, s[28:31], s88 offen offset:3072 lds
    s_add_u32 s88, s88, 16384
    s_add_u32 s89, s89, 32768
p1_ffnd:
    v_xor_b32 v10, 0, v58
    v_xor_b32_e64 v11, 64, v58
    v_xor_b32 v12, 128, v58
    v_xor_b32 v13, 192, v58
    v_mov_b32 v22, 0
    v_mov_b32 v23, 0
    s_waitcnt vmcnt(24)
    s_barrier
    ds_read_b128 v[208:211], v14 offset:8192
    ds_read_b128 v[212:215], v15 offset:8192
    ds_read_b128 v[216:219], v16 offset:8192
    v_exp_f32 v128, v128
    v_exp_f32 v129, v129
    v_add_f32 v22, v22, v128
    v_exp_f32 v130, v130
    v_add_f32_e64 v22, v22, v129
    v_cvt_pk_bf16_f32 v192, v128, v129
    v_exp_f32 v131, v131
    v_add_f32 v22, v22, v130
    v_exp_f32 v132, v132
    v_add_f32 v22, v22, v131
    v_cvt_pk_bf16_f32 v193, v130, v131
    v_exp_f32 v133, v133
    v_add_f32 v22, v22, v132
    v_exp_f32 v134, v134
    v_add_f32 v22, v22, v133
    v_cvt_pk_bf16_f32 v194, v132, v133
    v_exp_f32 v135, v135
    v_add_f32 v22, v22, v134
    v_exp_f32 v144, v144
    v_add_f32 v22, v22, v135
    v_cvt_pk_bf16_f32 v195, v134, v135
    v_exp_f32_e64 v145, v145
    v_add_f32 v23, v23, v144
    s_waitcnt lgkmcnt(2)
    v_mfma_f32_32x32x16_bf16 v[160:175], v[208:211], v[64:67], 0
    ds_read_b128 v[220:223], v17 offset:8192
    v_exp_f32 v146, v146
    v_add_f32 v23, v23, v145
    v_cvt_pk_bf16_f32 v200, v144, v145
    v_add_u32 v14, 0x8000, v14
    v_mfma_f32_32x32x16_bf16 v[176:191], v[208:211], v[96:99], 0
    v_exp_f32_e64 v147, v147
    v_add_f32 v23, v23, v146
    v_add_u32 v17, 0x8000, v17
    s_waitcnt lgkmcnt(2)
    v_mfma_f32_32x32x16_bf16 v[160:175], v[212:215], v[68:71], v[160:175]
    ds_read_b128 v[208:211], v18 offset:8192
    v_exp_f32 v148, v148
    v_add_f32 v23, v23, v147
    v_cvt_pk_bf16_f32 v201, v146, v147
    v_add_u32 v15, 0x8000, v15
    v_mfma_f32_32x32x16_bf16 v[176:191], v[212:215], v[100:103], v[176:191]
    buffer_store_dwordx4 v[224:227], v54, s[32:35], s78 offen offset:0 sc1
    v_exp_f32_e64 v149, v149
    v_add_f32 v23, v23, v148
    v_add_u32 v18, 0x8000, v18
    s_waitcnt lgkmcnt(2)
    v_mfma_f32_32x32x16_bf16 v[160:175], v[216:219], v[72:75], v[160:175]
    ds_read_b128 v[212:215], v19 offset:8192
    v_exp_f32 v150, v150
    v_add_f32 v23, v23, v149
    v_cvt_pk_bf16_f32 v202, v148, v149
    v_add_u32 v16, 0x8000, v16
    v_mfma_f32_32x32x16_bf16 v[176:191], v[216:219], v[104:107], v[176:191]
    v_exp_f32_e64 v151, v151
    v_add_f32 v23, v23, v150
    v_add_u32 v19, 0x8000, v19
    s_waitcnt lgkmcnt(2)
    v_mfma_f32_32x32x16_bf16 v[160:175], v[220:223], v[76:79], v[160:175]
    ds_read_b128 v[216:219], v20 offset:8192
    v_exp_f32 v136, v136
    v_add_f32 v23, v23, v151
    v_cvt_pk_bf16_f32 v203, v150, v151
    v_mfma_f32_32x32x16_bf16 v[176:191], v[220:223], v[108:111], v[176:191]
    v_exp_f32_e64 v137, v137
    v_add_f32 v22, v22, v136
    v_add_u32 v20, 0x8000, v20
    s_waitcnt lgkmcnt(2)
    v_mfma_f32_32x32x16_bf16 v[160:175], v[208:211], v[80:83], v[160:175]
    ds_read_b128 v[220:223], v21 offset:8192
    v_exp_f32 v138, v138
    v_add_f32 v22, v22, v137
    v_cvt_pk_bf16_f32 v196, v136, v137
    v_mfma_f32_32x32x16_bf16 v[176:191], v[208:211], v[112:115], v[176:191]
    v_exp_f32_e64 v139, v139
    v_add_f32 v22, v22, v138
    v_add_u32 v21, 0x8000, v21
    s_waitcnt lgkmcnt(2)
    v_mfma_f32_32x32x16_bf16 v[160:175], v[212:215], v[84:87], v[160:175]
    ds_read_b64_tr_b16 v[208:209], v10 offset:0
    v_exp_f32 v140, v140
    v_add_f32 v22, v22, v139
    v_cvt_pk_bf16_f32 v197, v138, v139
    v_mfma_f32_32x32x16_bf16 v[176:191], v[212:215], v[116:119], v[176:191]
    ds_read_b64_tr_b16 v[210:211], v10 offset:2048
    v_exp_f32 v141, v141
    v_add_f32 v22, v22, v140
    s_lshr_b32 s77, s2, 6
    s_waitcnt lgkmcnt(3)
    v_mfma_f32_32x32x16_bf16 v[160:175], v[216:219], v[88:91], v[160:175]
    ds_read_b64_tr_b16 v[212:213], v11 offset:0
    v_exp_f32 v142, v142
    v_add_f32 v22, v22, v141
    v_cvt_pk_bf16_f32 v198, v140, v141
    s_bfe_u32 s76, s2, 0x30003
    v_mfma_f32_32x32x16_bf16 v[176:191], v[216:219], v[120:123], v[176:191]
    ds_read_b64_tr_b16 v[214:215], v11 offset:2048
    v_exp_f32_e64 v143, v143
    v_add_f32 v22, v22, v142
    s_and_b32 s6, s2, 4
    s_lshl_b32 s6, s6, 1
    s_waitcnt lgkmcnt(4)
    v_mfma_f32_32x32x16_bf16 v[160:175], v[220:223], v[92:95], v[160:175]
    ds_read_b64_tr_b16 v[216:217], v12 offset:0
    v_exp_f32_e64 v152, v152
    v_add_f32 v22, v22, v143
    v_cvt_pk_bf16_f32 v199, v142, v143
    s_add_u32 s76, s76, s6
    v_mfma_f32_32x32x16_bf16 v[176:191], v[220:223], v[124:127], v[176:191]
    ds_read_b64_tr_b16 v[218:219], v12 offset:2048
    v_exp_f32_e64 v153, v153
    v_add_f32 v23, v23, v152
    s_waitcnt lgkmcnt(4)
    v_mfma_f32_32x32x16_bf16 a[128:143], v[208:211], v[192:195], a[128:143]
    ds_read_b64_tr_b16 v[220:221], v13 offset:0
    v_exp_f32_e64 v154, v154
    v_add_f32 v23, v23, v153
    v_cvt_pk_bf16_f32 v204, v152, v153
    s_lshl2_add_u32 s54, s76, s77
    v_mfma_f32_32x32x16_bf16 a[192:207], v[208:211], v[200:203], a[192:207]
    ds_read_b64_tr_b16 v[222:223], v13 offset:2048
    v_exp_f32_e64 v155, v155
    v_add_f32 v23, v23, v154
    s_mul_i32 s6, s54, 122880
    s_waitcnt lgkmcnt(4)
    v_mfma_f32_32x32x16_bf16 a[144:159], v[212:215], v[192:195], a[144:159]
    ds_read_b64_tr_b16 v[208:209], v10 offset:4096
    v_exp_f32 v156, v156
    v_add_f32 v23, v23, v155
    v_cvt_pk_bf16_f32 v205, v154, v155
    s_add_u32 s6, s6, 34603008
    v_mfma_f32_32x32x16_bf16 a[208:223], v[212:215], v[200:203], a[208:223]
    ds_read_b64_tr_b16 v[210:211], v10 offset:6144
    buffer_store_dwordx4 v[228:231], v54, s[32:35], s78 offen offset:1024 sc1
    v_exp_f32_e64 v157, v157
    v_add_f32 v23, v23, v156
    s_waitcnt lgkmcnt(4)
    v_mfma_f32_32x32x16_bf16 a[160:175], v[216:219], v[192:195], a[160:175]
    ds_read_b64_tr_b16 v[212:213], v11 offset:4096
    v_exp_f32 v158, v158
    v_add_f32 v23, v23, v157
    v_cvt_pk_bf16_f32 v206, v156, v157
    s_add_u32 s44, s86, s6
    s_addc_u32 s45, s87, 0
    v_mfma_f32_32x32x16_bf16 a[224:239], v[216:219], v[200:203], a[224:239]
    ds_read_b64_tr_b16 v[214:215], v11 offset:6144
    v_exp_f32_e64 v159, v159
    v_add_f32 v23, v23, v158
    s_and_b32 s45, s45, 0xffff
    s_waitcnt lgkmcnt(4)
    v_mfma_f32_32x32x16_bf16 a[176:191], v[220:223], v[192:195], a[176:191]
    ds_read_b64_tr_b16 v[216:217], v12 offset:4096
    v_exp_f32 v160, v160
    v_add_f32 v23, v23, v159
    v_cvt_pk_bf16_f32 v207, v158, v159
    s_mov_b32 s46, 122880
    v_mfma_f32_32x32x16_bf16 a[240:255], v[220:223], v[200:203], a[240:255]
    ds_read_b64_tr_b16 v[218:219], v12 offset:6144
    v_exp_f32_e64 v161, v161
    v_add_f32 v22, v22, v160
    s_waitcnt lgkmcnt(4)
    v_mfma_f32_32x32x16_bf16 a[128:143], v[208:211], v[196:199], a[128:143]
    ds_read_b64_tr_b16 v[220:221], v13 offset:4096
    v_exp_f32 v162, v162
    v_add_f32 v22, v22, v161
    v_cvt_pk_bf16_f32 v192, v160, v161
    s_mov_b32 s47, 0x20000
    v_mfma_f32_32x32x16_bf16 a[192:207], v[208:211], v[204:207], a[192:207]
    ds_read_b64_tr_b16 v[222:223], v13 offset:6144
    v_exp_f32 v163, v163
    v_add_f32 v22, v22, v162
    v_mov_b32 v40, -1
    s_waitcnt lgkmcnt(4)
    v_mfma_f32_32x32x16_bf16 a[144:159], v[212:215], v[196:199], a[144:159]
    s_waitcnt vmcnt(10)
    s_barrier
    ds_read_b128 v[208:211], v14 offset:0
    v_exp_f32 v164, v164
    v_add_f32 v22, v22, v163
    v_cvt_pk_bf16_f32 v193, v162, v163
    v_mfma_f32_32x32x16_bf16 a[208:223], v[212:215], v[204:207], a[208:223]
    v_exp_f32 v165, v165
    v_add_f32 v22, v22, v164
    v_mov_b32 v41, -1
    s_waitcnt lgkmcnt(3)
    v_mfma_f32_32x32x16_bf16 a[160:175], v[216:219], v[196:199], a[160:175]
    ds_read_b128 v[212:215], v15 offset:0
    v_exp_f32 v166, v166
    v_add_f32 v22, v22, v165
    v_cvt_pk_bf16_f32 v194, v164, v165
    v_mfma_f32_32x32x16_bf16 a[224:239], v[216:219], v[204:207], a[224:239]
    v_exp_f32 v167, v167
    v_add_f32 v22, v22, v166
    v_mov_b32 v42, -1
    s_waitcnt lgkmcnt(2)
    v_mfma_f32_32x32x16_bf16 a[176:191], v[220:223], v[196:199], a[176:191]
    ds_read_b128 v[216:219], v16 offset:0
    v_exp_f32 v176, v176
    v_add_f32 v22, v22, v167
    v_cvt_pk_bf16_f32 v195, v166, v167
    v_mov_b32_e64 v43, -1
    v_mfma_f32_32x32x16_bf16 a[240:255], v[220:223], v[204:207], a[240:255]
    v_exp_f32 v177, v177
    v_add_f32 v23, v23, v176
    s_mul_i32 s6, s53, 30720
    s_mul_i32 s7, s48, 7680
    s_waitcnt lgkmcnt(2)
    v_mfma_f32_32x32x16_bf16 v[128:143], v[208:211], v[64:67], 0
    ds_read_b128 v[220:223], v17 offset:0
    s_mov_b32 m0, s89
    v_exp_f32 v178, v178
    v_add_f32 v23, v23, v177
    v_cvt_pk_bf16_f32 v200, v176, v177
    v_mfma_f32_32x32x16_bf16 v[144:159], v[208:211], v[96:99], 0
    buffer_load_dwordx4 v2, s[24:27], s88 offen offset:0 lds
    v_exp_f32 v179, v179
    v_add_f32 v23, v23, v178
    s_min_u32 s7, s7, 22528
    s_add_u32 s4, s6, s7
    s_waitcnt lgkmcnt(2)
    v_mfma_f32_32x32x16_bf16 v[128:143], v[212:215], v[68:71], v[128:143]
    ds_read_b128 v[208:211], v18 offset:0
    v_exp_f32 v180, v180
    v_add_f32 v23, v23, v179
    v_cvt_pk_bf16_f32 v201, v178, v179
    v_mfma_f32_32x32x16_bf16 v[144:159], v[212:215], v[100:103], v[144:159]
    v_exp_f32 v181, v181
    v_add_f32 v23, v23, v180
    s_lshl_b32 s5, s92, 12
    s_waitcnt lgkmcnt(2)
    v_mfma_f32_32x32x16_bf16 v[128:143], v[216:219], v[72:75], v[128:143]
    ds_read_b128 v[212:215], v19 offset:0
    v_exp_f32 v182, v182
    v_add_f32 v23, v23, v181
    v_cvt_pk_bf16_f32 v202, v180, v181
    v_add_u32 v55, 4096, v54
    v_mfma_f32_32x32x16_bf16 v[144:159], v[216:219], v[104:107], v[144:159]
    buffer_load_dwordx4 v3, s[24:27], s88 offen offset:1024 lds
    v_exp_f32 v183, v183
    v_add_f32 v23, v23, v182
    s_lshl_b32 s6, s50, 5
    s_add_u32 s7, s6, s49
    s_lshl_b32 s7, s7, 7
    s_waitcnt lgkmcnt(2)
    v_mfma_f32_32x32x16_bf16 v[128:143], v[220:223], v[76:79], v[128:143]
    ds_read_b128 v[216:219], v20 offset:0
    v_exp_f32 v168, v168
    v_add_f32 v23, v23, v183
    v_cvt_pk_bf16_f32 v203, v182, v183
    v_mfma_f32_32x32x16_bf16 v[144:159], v[220:223], v[108:111], v[144:159]
    v_exp_f32 v169, v169
    v_add_f32 v22, v22, v168
    v_mov_b32 v25, s7
    s_waitcnt lgkmcnt(2)
    v_mfma_f32_32x32x16_bf16 v[128:143], v[208:211], v[80:83], v[128:143]
    ds_read_b128 v[220:223], v21 offset:0
    v_exp_f32_e64 v170, v170
    v_add_f32 v22, v22, v169
    v_cvt_pk_bf16_f32 v196, v168, v169
    s_cmp_eq_u32 s48, 0
    s_cselect_b32 s59, 0, 0x8000
    v_mfma_f32_32x32x16_bf16 v[144:159], v[208:211], v[112:115], v[144:159]
    buffer_load_dwordx4 v4, s[24:27], s88 offen offset:2048 lds
    v_exp_f32 v171, v171
    v_add_f32 v22, v22, v170
    s_mov_b32 s16, s84
    s_waitcnt lgkmcnt(2)
    v_mfma_f32_32x32x16_bf16 v[128:143], v[212:215], v[84:87], v[128:143]
    ds_read_b64_tr_b16 v[208:209], v10 offset:8192
    v_exp_f32 v172, v172
    v_add_f32 v22, v22, v171
    v_cvt_pk_bf16_f32 v197, v170, v171
    v_mfma_f32_32x32x16_bf16 v[144:159], v[212:215], v[116:119], v[144:159]
    ds_read_b64_tr_b16 v[210:211], v10 offset:10240
    v_exp_f32_e64 v173, v173
    v_add_f32 v22, v22, v172
    s_and_b32 s17, s85, 0xffff
    s_waitcnt lgkmcnt(3)
    v_mfma_f32_32x32x16_bf16 v[128:143], v[216:219], v[88:91], v[128:143]
    ds_read_b64_tr_b16 v[212:213], v11 offset:8192
    v_exp_f32 v174, v174
    v_add_f32 v22, v22, v173
    v_cvt_pk_bf16_f32 v198, v172, v173
    s_mov_b32 s18, 32768
    v_mfma_f32_32x32x16_bf16 v[144:159], v[216:219], v[120:123], v[144:159]
    ds_read_b64_tr_b16 v[214:215], v11 offset:10240
    buffer_load_dwordx4 v5, s[24:27], s88 offen offset:3072 lds
    v_exp_f32_e64 v175, v175
    v_add_f32 v22, v22, v174
    s_mov_b32 s19, 0x20000
    s_waitcnt lgkmcnt(4)
    v_mfma_f32_32x32x16_bf16 v[128:143], v[220:223], v[92:95], v[128:143]
    ds_read_b64_tr_b16 v[216:217], v12 offset:8192
    v_exp_f32 v184, v184
    v_add_f32 v22, v22, v175
    v_cvt_pk_bf16_f32 v199, v174, v175
    v_mfma_f32_32x32x16_bf16 v[144:159], v[220:223], v[124:127], v[144:159]
    ds_read_b64_tr_b16 v[218:219], v12 offset:10240
    s_add_u32 m0, m0, 16384
    v_exp_f32_e64 v185, v185
    v_add_f32 v23, v23, v184
    s_waitcnt lgkmcnt(4)
    v_mfma_f32_32x32x16_bf16 a[128:143], v[208:211], v[192:195], a[128:143]
    ds_read_b64_tr_b16 v[220:221], v13 offset:8192
    v_exp_f32_e64 v186, v186
    v_add_f32 v23, v23, v185
    v_cvt_pk_bf16_f32 v204, v184, v185
    s_add_u32 s6, s100, 1
    v_mfma_f32_32x32x16_bf16 a[192:207], v[208:211], v[200:203], a[192:207]
    ds_read_b64_tr_b16 v[222:223], v13 offset:10240
    buffer_load_dwordx4 v6, s[28:31], s88 offen offset:0 lds
    v_exp_f32 v187, v187
    v_add_f32 v23, v23, v186
    v_mov_b32 v28, s6
    s_waitcnt lgkmcnt(4)
    v_mfma_f32_32x32x16_bf16 a[144:159], v[212:215], v[192:195], a[144:159]
    ds_read_b64_tr_b16 v[208:209], v10 offset:12288
    v_exp_f32 v188, v188
    v_add_f32 v23, v23, v187
    v_cvt_pk_bf16_f32 v205, v186, v187
    v_mov_b32_e64 v29, s101
    v_mfma_f32_32x32x16_bf16 a[208:223], v[212:215], v[200:203], a[208:223]
    ds_read_b64_tr_b16 v[210:211], v10 offset:14336
    buffer_store_dwordx4 v[232:235], v54, s[32:35], s78 offen offset:2048 sc1
    v_exp_f32_e64 v189, v189
    v_add_f32 v23, v23, v188
    s_waitcnt lgkmcnt(4)
    v_mfma_f32_32x32x16_bf16 a[160:175], v[216:219], v[192:195], a[160:175]
    ds_read_b64_tr_b16 v[212:213], v11 offset:12288
    v_exp_f32 v190, v190
    v_add_f32 v23, v23, v189
    v_cvt_pk_bf16_f32 v206, v188, v189
    v_add_u32 v10, 0x8000, v10
    v_mfma_f32_32x32x16_bf16 a[224:239], v[216:219], v[200:203], a[224:239]
    ds_read_b64_tr_b16 v[214:215], v11 offset:14336
    buffer_load_dwordx4 v6, s[28:31], s88 offen offset:1024 lds
    v_exp_f32_e64 v191, v191
    v_add_f32 v23, v23, v190
    s_waitcnt lgkmcnt(4)
    v_mfma_f32_32x32x16_bf16 a[176:191], v[220:223], v[192:195], a[176:191]
    ds_read_b64_tr_b16 v[216:217], v12 offset:12288
    v_exp_f32 v128, v128
    v_add_f32 v23, v23, v191
    v_cvt_pk_bf16_f32 v207, v190, v191
    v_add_u32 v11, 0x8000, v11
    v_mfma_f32_32x32x16_bf16 a[240:255], v[220:223], v[200:203], a[240:255]
    ds_read_b64_tr_b16 v[218:219], v12 offset:14336
    v_exp_f32_e64 v129, v129
    v_add_f32 v22, v22, v128
    s_waitcnt lgkmcnt(4)
    v_mfma_f32_32x32x16_bf16 a[128:143], v[208:211], v[196:199], a[128:143]
    ds_read_b64_tr_b16 v[220:221], v13 offset:12288
    v_exp_f32 v130, v130
    v_add_f32 v22, v22, v129
    v_cvt_pk_bf16_f32 v192, v128, v129
    v_add_u32 v12, 0x8000, v12
    v_mfma_f32_32x32x16_bf16 a[192:207], v[208:211], v[204:207], a[192:207]
    ds_read_b64_tr_b16 v[222:223], v13 offset:14336
    buffer_load_dwordx4 v6, s[28:31], s88 offen offset:2048 lds
    v_exp_f32_e64 v131, v131
    v_add_f32 v22, v22, v130
    s_waitcnt lgkmcnt(4)
    v_mfma_f32_32x32x16_bf16 a[144:159], v[212:215], v[196:199], a[144:159]
    ds_read_b128 v[208:211], v14 offset:8192
    v_exp_f32 v132, v132
    v_add_f32 v22, v22, v131
    v_cvt_pk_bf16_f32 v193, v130, v131
    v_add_u32 v13, 0x8000, v13
    v_mfma_f32_32x32x16_bf16 a[208:223], v[212:215], v[204:207], a[208:223]
    s_add_u32 s89, s89, 0xfffe8000
    v_exp_f32_e64 v133, v133
    v_add_f32 v22, v22, v132
    s_waitcnt lgkmcnt(3)
    v_mfma_f32_32x32x16_bf16 a[160:175], v[216:219], v[196:199], a[160:175]
    ds_read_b128 v[212:215], v15 offset:8192
    v_exp_f32 v134, v134
    v_add_f32 v22, v22, v133
    v_cvt_pk_bf16_f32 v194, v132, v133
    v_mfma_f32_32x32x16_bf16 a[224:239], v[216:219], v[204:207], a[224:239]
    buffer_load_dwordx4 v6, s[28:31], s88 offen offset:3072 lds
    v_exp_f32_e64 v135, v135
    v_add_f32 v22, v22, v134
    s_waitcnt lgkmcnt(2)
    v_mfma_f32_32x32x16_bf16 a[176:191], v[220:223], v[196:199], a[176:191]
    ds_read_b128 v[216:219], v16 offset:8192
    s_add_u32 s88, s88, 16384
    v_exp_f32 v144, v144
    v_add_f32 v22, v22, v135
    v_cvt_pk_bf16_f32 v195, v134, v135
    v_mfma_f32_32x32x16_bf16 a[240:255], v[220:223], v[204:207], a[240:255]
    v_exp_f32_e64 v145, v145
    v_add_f32 v23, v23, v144
    s_waitcnt lgkmcnt(2)
    v_mfma_f32_32x32x16_bf16 v[160:175], v[208:211], v[64:67], 0
    ds_read_b128 v[220:223], v17 offset:8192
    v_exp_f32 v146, v146
    v_add_f32 v23, v23, v145
    v_cvt_pk_bf16_f32 v200, v144, v145
    v_add_u32 v14, 0x8000, v14
    v_mfma_f32_32x32x16_bf16 v[176:191], v[208:211], v[96:99], 0
    v_exp_f32_e64 v147, v147
    v_add_f32 v23, v23, v146
    v_add_u32 v17, 0x8000, v17
    s_waitcnt lgkmcnt(2)
    v_mfma_f32_32x32x16_bf16 v[160:175], v[212:215], v[68:71], v[160:175]
    ds_read_b128 v[208:211], v18 offset:8192
    v_exp_f32 v148, v148
    v_add_f32 v23, v23, v147
    v_cvt_pk_bf16_f32 v201, v146, v147
    v_add_u32 v15, 0x8000, v15
    v_mfma_f32_32x32x16_bf16 v[176:191], v[212:215], v[100:103], v[176:191]
    buffer_store_dwordx4 v[236:239], v54, s[32:35], s78 offen offset:3072 sc1
    v_exp_f32_e64 v149, v149
    v_add_f32 v23, v23, v148
    v_add_u32 v18, 0x8000, v18
    s_waitcnt lgkmcnt(2)
    v_mfma_f32_32x32x16_bf16 v[160:175], v[216:219], v[72:75], v[160:175]
    ds_read_b128 v[212:215], v19 offset:8192
    v_exp_f32 v150, v150
    v_add_f32 v23, v23, v149
    v_cvt_pk_bf16_f32 v202, v148, v149
    v_add_u32 v16, 0x8000, v16
    v_mfma_f32_32x32x16_bf16 v[176:191], v[216:219], v[104:107], v[176:191]
    v_exp_f32_e64 v151, v151
    v_add_f32 v23, v23, v150
    v_add_u32 v19, 0x8000, v19
    s_waitcnt lgkmcnt(2)
    v_mfma_f32_32x32x16_bf16 v[160:175], v[220:223], v[76:79], v[160:175]
    ds_read_b128 v[216:219], v20 offset:8192
    v_exp_f32 v136, v136
    v_add_f32 v23, v23, v151
    v_cvt_pk_bf16_f32 v203, v150, v151
    v_mfma_f32_32x32x16_bf16 v[176:191], v[220:223], v[108:111], v[176:191]
    v_exp_f32_e64 v137, v137
    v_add_f32 v22, v22, v136
    v_add_u32 v20, 0x8000, v20
    s_waitcnt lgkmcnt(2)
    v_mfma_f32_32x32x16_bf16 v[160:175], v[208:211], v[80:83], v[160:175]
    ds_read_b128 v[220:223], v21 offset:8192
    v_exp_f32 v138, v138
    v_add_f32 v22, v22, v137
    v_cvt_pk_bf16_f32 v196, v136, v137
    v_mfma_f32_32x32x16_bf16 v[176:191], v[208:211], v[112:115], v[176:191]
    v_exp_f32_e64 v139, v139
    v_add_f32 v22, v22, v138
    v_add_u32 v21, 0x8000, v21
    s_waitcnt lgkmcnt(2)
    v_mfma_f32_32x32x16_bf16 v[160:175], v[212:215], v[84:87], v[160:175]
    ds_read_b64_tr_b16 v[208:209], v10 offset:0
    v_exp_f32 v140, v140
    v_add_f32 v22, v22, v139
    v_cvt_pk_bf16_f32 v197, v138, v139
    v_mfma_f32_32x32x16_bf16 v[176:191], v[212:215], v[116:119], v[176:191]
    ds_read_b64_tr_b16 v[210:211], v10 offset:2048
    v_exp_f32_e64 v141, v141
    v_add_f32 v22, v22, v140
    s_waitcnt lgkmcnt(3)
    v_mfma_f32_32x32x16_bf16 v[160:175], v[216:219], v[88:91], v[160:175]
    ds_read_b64_tr_b16 v[212:213], v11 offset:0
    v_exp_f32 v142, v142
    v_add_f32 v22, v22, v141
    v_cvt_pk_bf16_f32 v198, v140, v141
    v_mfma_f32_32x32x16_bf16 v[176:191], v[216:219], v[120:123], v[176:191]
    ds_read_b64_tr_b16 v[214:215], v11 offset:2048
    v_exp_f32_e64 v143, v143
    v_add_f32 v22, v22, v142
    s_waitcnt lgkmcnt(4)
    v_mfma_f32_32x32x16_bf16 v[160:175], v[220:223], v[92:95], v[160:175]
    ds_read_b64_tr_b16 v[216:217], v12 offset:0
    v_exp_f32 v152, v152
    v_add_f32 v22, v22, v143
    v_cvt_pk_bf16_f32 v199, v142, v143
    v_mfma_f32_32x32x16_bf16 v[176:191], v[220:223], v[124:127], v[176:191]
    ds_read_b64_tr_b16 v[218:219], v12 offset:2048
    v_exp_f32_e64 v153, v153
    v_add_f32 v23, v23, v152
    s_waitcnt lgkmcnt(4)
    v_mfma_f32_32x32x16_bf16 a[128:143], v[208:211], v[192:195], a[128:143]
    ds_read_b64_tr_b16 v[220:221], v13 offset:0
    v_exp_f32 v154, v154
    v_add_f32 v23, v23, v153
    v_cvt_pk_bf16_f32 v204, v152, v153
    v_mfma_f32_32x32x16_bf16 a[192:207], v[208:211], v[200:203], a[192:207]
    ds_read_b64_tr_b16 v[222:223], v13 offset:2048
    v_exp_f32_e64 v155, v155
    v_add_f32 v23, v23, v154
    s_waitcnt lgkmcnt(4)
    v_mfma_f32_32x32x16_bf16 a[144:159], v[212:215], v[192:195], a[144:159]
    ds_read_b64_tr_b16 v[208:209], v10 offset:4096
    v_exp_f32 v156, v156
    v_add_f32 v23, v23, v155
    v_cvt_pk_bf16_f32 v205, v154, v155
    v_mfma_f32_32x32x16_bf16 a[208:223], v[212:215], v[200:203], a[208:223]
    ds_read_b64_tr_b16 v[210:211], v10 offset:6144
    buffer_store_dwordx4 v[240:243], v54, s[32:35], s79 offen offset:0 sc1
    v_exp_f32_e64 v157, v157
    v_add_f32 v23, v23, v156
    s_waitcnt lgkmcnt(4)
    v_mfma_f32_32x32x16_bf16 a[160:175], v[216:219], v[192:195], a[160:175]
    ds_read_b64_tr_b16 v[212:213], v11 offset:4096
    v_exp_f32 v158, v158
    v_add_f32 v23, v23, v157
    v_cvt_pk_bf16_f32 v206, v156, v157
    v_mfma_f32_32x32x16_bf16 a[224:239], v[216:219], v[200:203], a[224:239]
    ds_read_b64_tr_b16 v[214:215], v11 offset:6144
    v_exp_f32_e64 v159, v159
    v_add_f32 v23, v23, v158
    s_waitcnt lgkmcnt(4)
    v_mfma_f32_32x32x16_bf16 a[176:191], v[220:223], v[192:195], a[176:191]
    ds_read_b64_tr_b16 v[216:217], v12 offset:4096
    v_exp_f32 v160, v160
    v_add_f32 v23, v23, v159
    v_cvt_pk_bf16_f32 v207, v158, v159
    v_mfma_f32_32x32x16_bf16 a[240:255], v[220:223], v[200:203], a[240:255]
    ds_read_b64_tr_b16 v[218:219], v12 offset:6144
    v_exp_f32_e64 v161, v161
    v_add_f32 v22, v22, v160
    s_waitcnt lgkmcnt(4)
    v_mfma_f32_32x32x16_bf16 a[128:143], v[208:211], v[196:199], a[128:143]
    ds_read_b64_tr_b16 v[220:221], v13 offset:4096
    v_exp_f32 v162, v162
    v_add_f32 v22, v22, v161
    v_cvt_pk_bf16_f32 v192, v160, v161
    v_mfma_f32_32x32x16_bf16 a[192:207], v[208:211], v[204:207], a[192:207]
    ds_read_b64_tr_b16 v[222:223], v13 offset:6144
    v_exp_f32_e64 v163, v163
    v_add_f32 v22, v22, v162
    s_waitcnt lgkmcnt(4)
    v_mfma_f32_32x32x16_bf16 a[144:159], v[212:215], v[196:199], a[144:159]
    s_waitcnt vmcnt(13)
    s_barrier
    ds_read_b128 v[208:211], v14 offset:0
    v_exp_f32 v164, v164
    v_add_f32 v22, v22, v163
    v_cvt_pk_bf16_f32 v193, v162, v163
    v_mfma_f32_32x32x16_bf16 a[208:223], v[212:215], v[204:207], a[208:223]
    v_exp_f32_e64 v165, v165
    v_add_f32 v22, v22, v164
    s_waitcnt lgkmcnt(3)
    v_mfma_f32_32x32x16_bf16 a[160:175], v[216:219], v[196:199], a[160:175]
    ds_read_b128 v[212:215], v15 offset:0
    v_exp_f32 v166, v166
    v_add_f32 v22, v22, v165
    v_cvt_pk_bf16_f32 v194, v164, v165
    v_mfma_f32_32x32x16_bf16 a[224:239], v[216:219], v[204:207], a[224:239]
    v_exp_f32_e64 v167, v167
    v_add_f32 v22, v22, v166
    s_waitcnt lgkmcnt(2)
    v_mfma_f32_32x32x16_bf16 a[176:191], v[220:223], v[196:199], a[176:191]
    ds_read_b128 v[216:219], v16 offset:0
    v_exp_f32 v176, v176
    v_add_f32 v22, v22, v167
    v_cvt_pk_bf16_f32 v195, v166, v167
    v_mfma_f32_32x32x16_bf16 a[240:255], v[220:223], v[204:207], a[240:255]
    v_exp_f32_e64 v177, v177
    v_add_f32 v23, v23, v176
    s_waitcnt lgkmcnt(2)
    v_mfma_f32_32x32x16_bf16 v[128:143], v[208:211], v[64:67], 0
    ds_read_b128 v[220:223], v17 offset:0
    s_mov_b32 m0, s89
    v_exp_f32 v178, v178
    v_add_f32_e64 v23, v23, v177
    v_cvt_pk_bf16_f32 v200, v176, v177
    v_mfma_f32_32x32x16_bf16 v[144:159], v[208:211], v[96:99], 0
    buffer_load_dwordx4 v2, s[24:27], s88 offen offset:0 lds
    v_exp_f32_e64 v179, v179
    v_add_f32 v23, v23, v178
    s_waitcnt lgkmcnt(2)
    v_mfma_f32_32x32x16_bf16 v[128:143], v[212:215], v[68:71], v[128:143]
    ds_read_b128 v[208:211], v18 offset:0
    v_exp_f32 v180, v180
    v_add_f32 v23, v23, v179
    v_cvt_pk_bf16_f32 v201, v178, v179
    v_mfma_f32_32x32x16_bf16 v[144:159], v[212:215], v[100:103], v[144:159]
    v_exp_f32_e64 v181, v181
    v_add_f32 v23, v23, v180
    s_waitcnt lgkmcnt(2)
    v_mfma_f32_32x32x16_bf16 v[128:143], v[216:219], v[72:75], v[128:143]
    ds_read_b128 v[212:215], v19 offset:0
    v_exp_f32 v182, v182
    v_add_f32 v23, v23, v181
    v_cvt_pk_bf16_f32 v202, v180, v181
    v_mfma_f32_32x32x16_bf16 v[144:159], v[216:219], v[104:107], v[144:159]
    buffer_load_dwordx4 v3, s[24:27], s88 offen offset:1024 lds
    v_exp_f32_e64 v183, v183
    v_add_f32 v23, v23, v182
    s_waitcnt lgkmcnt(2)
    v_mfma_f32_32x32x16_bf16 v[128:143], v[220:223], v[76:79], v[128:143]
    ds_read_b128 v[216:219], v20 offset:0
    v_exp_f32 v168, v168
    v_add_f32 v23, v23, v183
    v_cvt_pk_bf16_f32 v203, v182, v183
    v_mfma_f32_32x32x16_bf16 v[144:159], v[220:223], v[108:111], v[144:159]
    v_exp_f32_e64 v169, v169
    v_add_f32 v22, v22, v168
    s_waitcnt lgkmcnt(2)
    v_mfma_f32_32x32x16_bf16 v[128:143], v[208:211], v[80:83], v[128:143]
    ds_read_b128 v[220:223], v21 offset:0
    v_exp_f32 v170, v170
    v_add_f32 v22, v22, v169
    v_cvt_pk_bf16_f32 v196, v168, v169
    v_mfma_f32_32x32x16_bf16 v[144:159], v[208:211], v[112:115], v[144:159]
    buffer_load_dwordx4 v4, s[24:27], s88 offen offset:2048 lds
    v_exp_f32_e64 v171, v171
    v_add_f32 v22, v22, v170
    s_waitcnt lgkmcnt(2)
    v_mfma_f32_32x32x16_bf16 v[128:143], v[212:215], v[84:87], v[128:143]
    ds_read_b64_tr_b16 v[208:209], v10 offset:8192
    v_exp_f32 v172, v172
    v_add_f32 v22, v22, v171
    v_cvt_pk_bf16_f32 v197, v170, v171
    v_mfma_f32_32x32x16_bf16 v[144:159], v[212:215], v[116:119], v[144:159]
    ds_read_b64_tr_b16 v[210:211], v10 offset:10240
    v_exp_f32_e64 v173, v173
    v_add_f32 v22, v22, v172
    s_waitcnt lgkmcnt(3)
    v_mfma_f32_32x32x16_bf16 v[128:143], v[216:219], v[88:91], v[128:143]
    ds_read_b64_tr_b16 v[212:213], v11 offset:8192
    v_exp_f32 v174, v174
    v_add_f32 v22, v22, v173
    v_cvt_pk_bf16_f32 v198, v172, v173
    v_mfma_f32_32x32x16_bf16 v[144:159], v[216:219], v[120:123], v[144:159]
    ds_read_b64_tr_b16 v[214:215], v11 offset:10240
    buffer_load_dwordx4 v5, s[24:27], s88 offen offset:3072 lds
    v_exp_f32_e64 v175, v175
    v_add_f32 v22, v22, v174
    s_waitcnt lgkmcnt(4)
    v_mfma_f32_32x32x16_bf16 v[128:143], v[220:223], v[92:95], v[128:143]
    ds_read_b64_tr_b16 v[216:217], v12 offset:8192
    v_exp_f32 v184, v184
    v_add_f32 v22, v22, v175
    v_cvt_pk_bf16_f32 v199, v174, v175
    v_mfma_f32_32x32x16_bf16 v[144:159], v[220:223], v[124:127], v[144:159]
    ds_read_b64_tr_b16 v[218:219], v12 offset:10240
    s_add_u32 m0, m0, 16384
    v_exp_f32_e64 v185, v185
    v_add_f32 v23, v23, v184
    s_waitcnt lgkmcnt(4)
    v_mfma_f32_32x32x16_bf16 a[128:143], v[208:211], v[192:195], a[128:143]
    ds_read_b64_tr_b16 v[220:221], v13 offset:8192
    v_exp_f32 v186, v186
    v_add_f32 v23, v23, v185
    v_cvt_pk_bf16_f32 v204, v184, v185
    v_mfma_f32_32x32x16_bf16 a[192:207], v[208:211], v[200:203], a[192:207]
    ds_read_b64_tr_b16 v[222:223], v13 offset:10240
    buffer_load_dwordx4 v6, s[28:31], s88 offen offset:0 lds
    v_exp_f32_e64 v187, v187
    v_add_f32 v23, v23, v186
    s_waitcnt lgkmcnt(4)
    v_mfma_f32_32x32x16_bf16 a[144:159], v[212:215], v[192:195], a[144:159]
    ds_read_b64_tr_b16 v[208:209], v10 offset:12288
    v_exp_f32 v188, v188
    v_add_f32 v23, v23, v187
    v_cvt_pk_bf16_f32 v205, v186, v187
    v_mfma_f32_32x32x16_bf16 a[208:223], v[212:215], v[200:203], a[208:223]
    ds_read_b64_tr_b16 v[210:211], v10 offset:14336
    buffer_store_dwordx4 v[244:247], v54, s[32:35], s79 offen offset:1024 sc1
    v_exp_f32_e64 v189, v189
    v_add_f32 v23, v23, v188
    s_waitcnt lgkmcnt(4)
    v_mfma_f32_32x32x16_bf16 a[160:175], v[216:219], v[192:195], a[160:175]
    ds_read_b64_tr_b16 v[212:213], v11 offset:12288
    v_exp_f32 v190, v190
    v_add_f32 v23, v23, v189
    v_cvt_pk_bf16_f32 v206, v188, v189
    v_add_u32 v10, 0x8000, v10
    v_mfma_f32_32x32x16_bf16 a[224:239], v[216:219], v[200:203], a[224:239]
    ds_read_b64_tr_b16 v[214:215], v11 offset:14336
    buffer_load_dwordx4 v6, s[28:31], s88 offen offset:1024 lds
    v_exp_f32_e64 v191, v191
    v_add_f32 v23, v23, v190
    s_waitcnt lgkmcnt(4)
    v_mfma_f32_32x32x16_bf16 a[176:191], v[220:223], v[192:195], a[176:191]
    ds_read_b64_tr_b16 v[216:217], v12 offset:12288
    v_exp_f32 v128, v128
    v_add_f32 v23, v23, v191
    v_cvt_pk_bf16_f32 v207, v190, v191
    v_add_u32 v11, 0x8000, v11
    v_mfma_f32_32x32x16_bf16 a[240:255], v[220:223], v[200:203], a[240:255]
    ds_read_b64_tr_b16 v[218:219], v12 offset:14336
    v_exp_f32_e64 v129, v129
    v_add_f32 v22, v22, v128
    s_waitcnt lgkmcnt(4)
    v_mfma_f32_32x32x16_bf16 a[128:143], v[208:211], v[196:199], a[128:143]
    ds_read_b64_tr_b16 v[220:221], v13 offset:12288
    v_exp_f32 v130, v130
    v_add_f32 v22, v22, v129
    v_cvt_pk_bf16_f32 v192, v128, v129
    v_add_u32 v12, 0x8000, v12
    v_mfma_f32_32x32x16_bf16 a[192:207], v[208:211], v[204:207], a[192:207]
    ds_read_b64_tr_b16 v[222:223], v13 offset:14336
    buffer_load_dwordx4 v6, s[28:31], s88 offen offset:2048 lds
    v_exp_f32_e64 v131, v131
    v_add_f32 v22, v22, v130
    s_waitcnt lgkmcnt(4)
    v_mfma_f32_32x32x16_bf16 a[144:159], v[212:215], v[196:199], a[144:159]
    ds_read_b128 v[208:211], v14 offset:8192
    v_exp_f32 v132, v132
    v_add_f32 v22, v22, v131
    v_cvt_pk_bf16_f32 v193, v130, v131
    v_add_u32 v13, 0x8000, v13
    v_mfma_f32_32x32x16_bf16 a[208:223], v[212:215], v[204:207], a[208:223]
    s_add_u32 s89, s89, 32768
    v_exp_f32_e64 v133, v133
    v_add_f32 v22, v22, v132
    s_waitcnt lgkmcnt(3)
    v_mfma_f32_32x32x16_bf16 a[160:175], v[216:219], v[196:199], a[160:175]
    ds_read_b128 v[212:215], v15 offset:8192
    v_exp_f32 v134, v134
    v_add_f32 v22, v22, v133
    v_cvt_pk_bf16_f32 v194, v132, v133
    v_mfma_f32_32x32x16_bf16 a[224:239], v[216:219], v[204:207], a[224:239]
    buffer_load_dwordx4 v6, s[28:31], s88 offen offset:3072 lds
    v_exp_f32_e64 v135, v135
    v_add_f32 v22, v22, v134
    s_waitcnt lgkmcnt(2)
    v_mfma_f32_32x32x16_bf16 a[176:191], v[220:223], v[196:199], a[176:191]
    ds_read_b128 v[216:219], v16 offset:8192
    s_add_u32 s88, s88, 16384
    v_exp_f32 v144, v144
    v_add_f32 v22, v22, v135
    v_cvt_pk_bf16_f32 v195, v134, v135
    v_mfma_f32_32x32x16_bf16 a[240:255], v[220:223], v[204:207], a[240:255]
    v_exp_f32_e64 v145, v145
    v_add_f32 v23, v23, v144
    s_waitcnt lgkmcnt(2)
    v_mfma_f32_32x32x16_bf16 v[160:175], v[208:211], v[64:67], 0
    ds_read_b128 v[220:223], v17 offset:8192
    v_exp_f32 v146, v146
    v_add_f32 v23, v23, v145
    v_cvt_pk_bf16_f32 v200, v144, v145
    v_add_u32 v14, 0x8000, v14
    v_mfma_f32_32x32x16_bf16 v[176:191], v[208:211], v[96:99], 0
    v_exp_f32_e64 v147, v147
    v_add_f32 v23, v23, v146
    v_add_u32 v17, 0x8000, v17
    s_waitcnt lgkmcnt(2)
    v_mfma_f32_32x32x16_bf16 v[160:175], v[212:215], v[68:71], v[160:175]
    ds_read_b128 v[208:211], v18 offset:8192
    v_exp_f32 v148, v148
    v_add_f32 v23, v23, v147
    v_cvt_pk_bf16_f32 v201, v146, v147
    v_add_u32 v15, 0x8000, v15
    v_mfma_f32_32x32x16_bf16 v[176:191], v[212:215], v[100:103], v[176:191]
    buffer_store_dwordx4 v[248:251], v54, s[32:35], s79 offen offset:2048 sc1
    v_exp_f32_e64 v149, v149
    v_add_f32 v23, v23, v148
    v_add_u32 v18, 0x8000, v18
    s_waitcnt lgkmcnt(2)
    v_mfma_f32_32x32x16_bf16 v[160:175], v[216:219], v[72:75], v[160:175]
    ds_read_b128 v[212:215], v19 offset:8192
    v_exp_f32 v150, v150
    v_add_f32 v23, v23, v149
    v_cvt_pk_bf16_f32 v202, v148, v149
    v_add_u32 v16, 0x8000, v16
    v_mfma_f32_32x32x16_bf16 v[176:191], v[216:219], v[104:107], v[176:191]
    v_exp_f32_e64 v151, v151
    v_add_f32 v23, v23, v150
    v_add_u32 v19, 0x8000, v19
    s_waitcnt lgkmcnt(2)
    v_mfma_f32_32x32x16_bf16 v[160:175], v[220:223], v[76:79], v[160:175]
    ds_read_b128 v[216:219], v20 offset:8192
    v_exp_f32 v136, v136
    v_add_f32 v23, v23, v151
    v_cvt_pk_bf16_f32 v203, v150, v151
    v_mfma_f32_32x32x16_bf16 v[176:191], v[220:223], v[108:111], v[176:191]
    v_exp_f32_e64 v137, v137
    v_add_f32 v22, v22, v136
    v_add_u32 v20, 0x8000, v20
    s_waitcnt lgkmcnt(2)
    v_mfma_f32_32x32x16_bf16 v[160:175], v[208:211], v[80:83], v[160:175]
    ds_read_b128 v[220:223], v21 offset:8192
    v_exp_f32 v138, v138
    v_add_f32 v22, v22, v137
    v_cvt_pk_bf16_f32 v196, v136, v137
    v_mfma_f32_32x32x16_bf16 v[176:191], v[208:211], v[112:115], v[176:191]
    v_exp_f32_e64 v139, v139
    v_add_f32 v22, v22, v138
    v_add_u32 v21, 0x8000, v21
    s_waitcnt lgkmcnt(2)
    v_mfma_f32_32x32x16_bf16 v[160:175], v[212:215], v[84:87], v[160:175]
    ds_read_b64_tr_b16 v[208:209], v10 offset:0
    v_exp_f32 v140, v140
    v_add_f32 v22, v22, v139
    v_cvt_pk_bf16_f32 v197, v138, v139
    v_mfma_f32_32x32x16_bf16 v[176:191], v[212:215], v[116:119], v[176:191]
    ds_read_b64_tr_b16 v[210:211], v10 offset:2048
    v_exp_f32_e64 v141, v141
    v_add_f32 v22, v22, v140
    s_waitcnt lgkmcnt(3)
    v_mfma_f32_32x32x16_bf16 v[160:175], v[216:219], v[88:91], v[160:175]
    ds_read_b64_tr_b16 v[212:213], v11 offset:0
    v_exp_f32 v142, v142
    v_add_f32 v22, v22, v141
    v_cvt_pk_bf16_f32 v198, v140, v141
    v_mfma_f32_32x32x16_bf16 v[176:191], v[216:219], v[120:123], v[176:191]
    ds_read_b64_tr_b16 v[214:215], v11 offset:2048
    v_exp_f32_e64 v143, v143
    v_add_f32 v22, v22, v142
    s_waitcnt lgkmcnt(4)
    v_mfma_f32_32x32x16_bf16 v[160:175], v[220:223], v[92:95], v[160:175]
    ds_read_b64_tr_b16 v[216:217], v12 offset:0
    v_exp_f32 v152, v152
    v_add_f32 v22, v22, v143
    v_cvt_pk_bf16_f32 v199, v142, v143
    v_mfma_f32_32x32x16_bf16 v[176:191], v[220:223], v[124:127], v[176:191]
    ds_read_b64_tr_b16 v[218:219], v12 offset:2048
    v_exp_f32_e64 v153, v153
    v_add_f32 v23, v23, v152
    s_waitcnt lgkmcnt(4)
    v_mfma_f32_32x32x16_bf16 a[128:143], v[208:211], v[192:195], a[128:143]
    ds_read_b64_tr_b16 v[220:221], v13 offset:0
    v_exp_f32 v154, v154
    v_add_f32 v23, v23, v153
    v_cvt_pk_bf16_f32 v204, v152, v153
    v_mfma_f32_32x32x16_bf16 a[192:207], v[208:211], v[200:203], a[192:207]
    ds_read_b64_tr_b16 v[222:223], v13 offset:2048
    v_exp_f32_e64 v155, v155
    v_add_f32 v23, v23, v154
    s_waitcnt lgkmcnt(4)
    v_mfma_f32_32x32x16_bf16 a[144:159], v[212:215], v[192:195], a[144:159]
    ds_read_b64_tr_b16 v[208:209], v10 offset:4096
    v_exp_f32 v156, v156
    v_add_f32 v23, v23, v155
    v_cvt_pk_bf16_f32 v205, v154, v155
    v_mfma_f32_32x32x16_bf16 a[208:223], v[212:215], v[200:203], a[208:223]
    ds_read_b64_tr_b16 v[210:211], v10 offset:6144
    buffer_store_dwordx4 v[252:255], v54, s[32:35], s79 offen offset:3072 sc1
    v_exp_f32_e64 v157, v157
    v_add_f32 v23, v23, v156
    s_waitcnt lgkmcnt(4)
    v_mfma_f32_32x32x16_bf16 a[160:175], v[216:219], v[192:195], a[160:175]
    ds_read_b64_tr_b16 v[212:213], v11 offset:4096
    v_exp_f32 v158, v158
    v_add_f32 v23, v23, v157
    v_cvt_pk_bf16_f32 v206, v156, v157
    v_mfma_f32_32x32x16_bf16 a[224:239], v[216:219], v[200:203], a[224:239]
    ds_read_b64_tr_b16 v[214:215], v11 offset:6144
    v_exp_f32_e64 v159, v159
    v_add_f32 v23, v23, v158
    s_waitcnt lgkmcnt(4)
    v_mfma_f32_32x32x16_bf16 a[176:191], v[220:223], v[192:195], a[176:191]
    ds_read_b64_tr_b16 v[216:217], v12 offset:4096
    v_exp_f32 v160, v160
    v_add_f32 v23, v23, v159
    v_cvt_pk_bf16_f32 v207, v158, v159
    v_mfma_f32_32x32x16_bf16 a[240:255], v[220:223], v[200:203], a[240:255]
    ds_read_b64_tr_b16 v[218:219], v12 offset:6144
    v_exp_f32_e64 v161, v161
    v_add_f32 v22, v22, v160
    s_waitcnt lgkmcnt(4)
    v_mfma_f32_32x32x16_bf16 a[128:143], v[208:211], v[196:199], a[128:143]
    ds_read_b64_tr_b16 v[220:221], v13 offset:4096
    v_exp_f32 v162, v162
    v_add_f32 v22, v22, v161
    v_cvt_pk_bf16_f32 v192, v160, v161
    v_mfma_f32_32x32x16_bf16 a[192:207], v[208:211], v[204:207], a[192:207]
    ds_read_b64_tr_b16 v[222:223], v13 offset:6144
    v_exp_f32_e64 v163, v163
    v_add_f32 v22, v22, v162
    s_waitcnt lgkmcnt(4)
    v_mfma_f32_32x32x16_bf16 a[144:159], v[212:215], v[196:199], a[144:159]
    s_waitcnt vmcnt(13)
    s_barrier
    ds_read_b128 v[208:211], v14 offset:0
    v_exp_f32 v164, v164
    v_add_f32 v22, v22, v163
    v_cvt_pk_bf16_f32 v193, v162, v163
    v_mfma_f32_32x32x16_bf16 a[208:223], v[212:215], v[204:207], a[208:223]
    v_exp_f32_e64 v165, v165
    v_add_f32 v22, v22, v164
    s_waitcnt lgkmcnt(3)
    v_mfma_f32_32x32x16_bf16 a[160:175], v[216:219], v[196:199], a[160:175]
    ds_read_b128 v[212:215], v15 offset:0
    v_exp_f32 v166, v166
    v_add_f32 v22, v22, v165
    v_cvt_pk_bf16_f32 v194, v164, v165
    v_mfma_f32_32x32x16_bf16 a[224:239], v[216:219], v[204:207], a[224:239]
    v_exp_f32_e64 v167, v167
    v_add_f32 v22, v22, v166
    s_waitcnt lgkmcnt(2)
    v_mfma_f32_32x32x16_bf16 a[176:191], v[220:223], v[196:199], a[176:191]
    ds_read_b128 v[216:219], v16 offset:0
    v_exp_f32 v176, v176
    v_add_f32 v22, v22, v167
    v_cvt_pk_bf16_f32 v195, v166, v167
    v_mfma_f32_32x32x16_bf16 a[240:255], v[220:223], v[204:207], a[240:255]
    v_exp_f32_e64 v177, v177
    v_add_f32 v23, v23, v176
    s_waitcnt lgkmcnt(2)
    v_mfma_f32_32x32x16_bf16 v[128:143], v[208:211], v[64:67], 0
    ds_read_b128 v[220:223], v17 offset:0
    s_mov_b32 m0, s89
    v_exp_f32 v178, v178
    v_add_f32_e64 v23, v23, v177
    v_cvt_pk_bf16_f32 v200, v176, v177
    v_mfma_f32_32x32x16_bf16 v[144:159], v[208:211], v[96:99], 0
    buffer_load_dwordx4 v2, s[24:27], s88 offen offset:0 lds
    v_exp_f32_e64 v179, v179
    v_add_f32 v23, v23, v178
    s_waitcnt lgkmcnt(2)
    v_mfma_f32_32x32x16_bf16 v[128:143], v[212:215], v[68:71], v[128:143]
    ds_read_b128 v[208:211], v18 offset:0
    v_exp_f32 v180, v180
    v_add_f32 v23, v23, v179
    v_cvt_pk_bf16_f32 v201, v178, v179
    v_xor_b32_e64 v39, 0, v59
    v_mfma_f32_32x32x16_bf16 v[144:159], v[212:215], v[100:103], v[144:159]
    ds_read_b64_tr_b16 a[64:65], v39
    v_exp_f32_e64 v181, v181
    v_add_f32 v23, v23, v180
    s_waitcnt lgkmcnt(3)
    v_mfma_f32_32x32x16_bf16 v[128:143], v[216:219], v[72:75], v[128:143]
    ds_read_b128 v[212:215], v19 offset:0
    v_exp_f32 v182, v182
    v_add_f32 v23, v23, v181
    v_cvt_pk_bf16_f32 v202, v180, v181
    v_mfma_f32_32x32x16_bf16 v[144:159], v[216:219], v[104:107], v[144:159]
    ds_read_b64_tr_b16 a[66:67], v39 offset:2048
    buffer_load_dwordx4 v3, s[24:27], s88 offen offset:1024 lds
    v_exp_f32_e64 v183, v183
    v_add_f32 v23, v23, v182
    s_waitcnt lgkmcnt(4)
    v_mfma_f32_32x32x16_bf16 v[128:143], v[220:223], v[76:79], v[128:143]
    ds_read_b128 v[216:219], v20 offset:0
    v_exp_f32 v168, v168
    v_add_f32 v23, v23, v183
    v_cvt_pk_bf16_f32 v203, v182, v183
    v_mfma_f32_32x32x16_bf16 v[144:159], v[220:223], v[108:111], v[144:159]
    v_exp_f32_e64 v169, v169
    v_add_f32 v22, v22, v168
    s_waitcnt lgkmcnt(4)
    v_mfma_f32_32x32x16_bf16 v[128:143], v[208:211], v[80:83], v[128:143]
    ds_read_b128 v[220:223], v21 offset:0
    v_exp_f32 v170, v170
    v_add_f32 v22, v22, v169
    v_cvt_pk_bf16_f32 v196, v168, v169
    v_mfma_f32_32x32x16_bf16 v[144:159], v[208:211], v[112:115], v[144:159]
    buffer_load_dwordx4 v4, s[24:27], s88 offen offset:2048 lds
    v_exp_f32_e64 v171, v171
    v_add_f32 v22, v22, v170
    s_waitcnt lgkmcnt(3)
    v_mfma_f32_32x32x16_bf16 v[128:143], v[212:215], v[84:87], v[128:143]
    ds_read_b64_tr_b16 v[208:209], v10 offset:8192
    v_exp_f32 v172, v172
    v_add_f32 v22, v22, v171
    v_cvt_pk_bf16_f32 v197, v170, v171
    v_mfma_f32_32x32x16_bf16 v[144:159], v[212:215], v[116:119], v[144:159]
    ds_read_b64_tr_b16 v[210:211], v10 offset:10240
    v_exp_f32_e64 v173, v173
    v_add_f32 v22, v22, v172
    s_waitcnt lgkmcnt(3)
    v_mfma_f32_32x32x16_bf16 v[128:143], v[216:219], v[88:91], v[128:143]
    ds_read_b64_tr_b16 v[212:213], v11 offset:8192
    v_exp_f32 v174, v174
    v_add_f32 v22, v22, v173
    v_cvt_pk_bf16_f32 v198, v172, v173
    v_mfma_f32_32x32x16_bf16 v[144:159], v[216:219], v[120:123], v[144:159]
    ds_read_b64_tr_b16 v[214:215], v11 offset:10240
    buffer_load_dwordx4 v5, s[24:27], s88 offen offset:3072 lds
    v_exp_f32_e64 v175, v175
    v_add_f32 v22, v22, v174
    s_waitcnt lgkmcnt(4)
    v_mfma_f32_32x32x16_bf16 v[128:143], v[220:223], v[92:95], v[128:143]
    ds_read_b64_tr_b16 v[216:217], v12 offset:8192
    v_exp_f32 v184, v184
    v_add_f32 v22, v22, v175
    v_cvt_pk_bf16_f32 v199, v174, v175
    v_mfma_f32_32x32x16_bf16 v[144:159], v[220:223], v[124:127], v[144:159]
    ds_read_b64_tr_b16 v[218:219], v12 offset:10240
    s_add_u32 m0, m0, 16384
    v_exp_f32_e64 v185, v185
    v_add_f32 v23, v23, v184
    s_waitcnt lgkmcnt(4)
    v_mfma_f32_32x32x16_bf16 a[128:143], v[208:211], v[192:195], a[128:143]
    ds_read_b64_tr_b16 v[220:221], v13 offset:8192
    v_exp_f32 v186, v186
    v_add_f32 v23, v23, v185
    v_cvt_pk_bf16_f32 v204, v184, v185
    v_mfma_f32_32x32x16_bf16 a[192:207], v[208:211], v[200:203], a[192:207]
    ds_read_b64_tr_b16 v[222:223], v13 offset:10240
    buffer_load_dwordx4 v6, s[28:31], s88 offen offset:0 lds
    v_exp_f32_e64 v187, v187
    v_add_f32 v23, v23, v186
    s_waitcnt lgkmcnt(4)
    v_mfma_f32_32x32x16_bf16 a[144:159], v[212:215], v[192:195], a[144:159]
    ds_read_b64_tr_b16 v[208:209], v10 offset:12288
    v_exp_f32 v188, v188
    v_add_f32 v23, v23, v187
    v_cvt_pk_bf16_f32 v205, v186, v187
    v_mfma_f32_32x32x16_bf16 a[208:223], v[212:215], v[200:203], a[208:223]
    ds_read_b64_tr_b16 v[210:211], v10 offset:14336
    buffer_store_dwordx4 a[64:67], v54, s[36:39], s5 offen offset:0 sc1
    v_exp_f32_e64 v189, v189
    v_add_f32 v23, v23, v188
    s_waitcnt lgkmcnt(4)
    v_mfma_f32_32x32x16_bf16 a[160:175], v[216:219], v[192:195], a[160:175]
    ds_read_b64_tr_b16 v[212:213], v11 offset:12288
    v_exp_f32 v190, v190
    v_add_f32 v23, v23, v189
    v_cvt_pk_bf16_f32 v206, v188, v189
    v_add_u32 v10, 0x8000, v10
    v_mfma_f32_32x32x16_bf16 a[224:239], v[216:219], v[200:203], a[224:239]
    ds_read_b64_tr_b16 v[214:215], v11 offset:14336
    buffer_load_dwordx4 v6, s[28:31], s88 offen offset:1024 lds
    v_exp_f32_e64 v191, v191
    v_add_f32 v23, v23, v190
    s_waitcnt lgkmcnt(4)
    v_mfma_f32_32x32x16_bf16 a[176:191], v[220:223], v[192:195], a[176:191]
    ds_read_b64_tr_b16 v[216:217], v12 offset:12288
    v_exp_f32 v128, v128
    v_add_f32 v23, v23, v191
    v_cvt_pk_bf16_f32 v207, v190, v191
    v_add_u32 v11, 0x8000, v11
    v_mfma_f32_32x32x16_bf16 a[240:255], v[220:223], v[200:203], a[240:255]
    ds_read_b64_tr_b16 v[218:219], v12 offset:14336
    v_exp_f32_e64 v129, v129
    v_add_f32 v22, v22, v128
    s_waitcnt lgkmcnt(4)
    v_mfma_f32_32x32x16_bf16 a[128:143], v[208:211], v[196:199], a[128:143]
    ds_read_b64_tr_b16 v[220:221], v13 offset:12288
    v_exp_f32 v130, v130
    v_add_f32 v22, v22, v129
    v_cvt_pk_bf16_f32 v192, v128, v129
    v_add_u32 v12, 0x8000, v12
    v_mfma_f32_32x32x16_bf16 a[192:207], v[208:211], v[204:207], a[192:207]
    ds_read_b64_tr_b16 v[222:223], v13 offset:14336
    buffer_load_dwordx4 v6, s[28:31], s88 offen offset:2048 lds
    v_exp_f32_e64 v131, v131
    v_add_f32 v22, v22, v130
    s_waitcnt lgkmcnt(4)
    v_mfma_f32_32x32x16_bf16 a[144:159], v[212:215], v[196:199], a[144:159]
    ds_read_b128 v[208:211], v14 offset:8192
    v_exp_f32 v132, v132
    v_add_f32 v22, v22, v131
    v_cvt_pk_bf16_f32 v193, v130, v131
    v_add_u32 v13, 0x8000, v13
    v_mfma_f32_32x32x16_bf16 a[208:223], v[212:215], v[204:207], a[208:223]
    s_add_u32 s89, s89, 32768
    v_exp_f32_e64 v133, v133
    v_add_f32 v22, v22, v132
    s_waitcnt lgkmcnt(3)
    v_mfma_f32_32x32x16_bf16 a[160:175], v[216:219], v[196:199], a[160:175]
    ds_read_b128 v[212:215], v15 offset:8192
    v_exp_f32 v134, v134
    v_add_f32 v22, v22, v133
    v_cvt_pk_bf16_f32 v194, v132, v133
    v_mfma_f32_32x32x16_bf16 a[224:239], v[216:219], v[204:207], a[224:239]
    buffer_load_dwordx4 v6, s[28:31], s88 offen offset:3072 lds
    v_exp_f32_e64 v135, v135
    v_add_f32 v22, v22, v134
    s_waitcnt lgkmcnt(2)
    v_mfma_f32_32x32x16_bf16 a[176:191], v[220:223], v[196:199], a[176:191]
    ds_read_b128 v[216:219], v16 offset:8192
    s_add_u32 s88, s88, 16384
    v_exp_f32 v144, v144
    v_add_f32 v22, v22, v135
    v_cvt_pk_bf16_f32 v195, v134, v135
    v_mfma_f32_32x32x16_bf16 a[240:255], v[220:223], v[204:207], a[240:255]
    v_exp_f32_e64 v145, v145
    v_add_f32 v23, v23, v144
    s_waitcnt lgkmcnt(2)
    v_mfma_f32_32x32x16_bf16 v[160:175], v[208:211], v[64:67], 0
    ds_read_b128 v[220:223], v17 offset:8192
    v_exp_f32 v146, v146
    v_add_f32 v23, v23, v145
    v_cvt_pk_bf16_f32 v200, v144, v145
    v_add_u32 v14, 0xfffe8000, v14
    v_xor_b32_e64 v39, 32, v59
    v_mfma_f32_32x32x16_bf16 v[176:191], v[208:211], v[96:99], 0
    ds_read_b64_tr_b16 a[68:69], v39
    v_exp_f32_e64 v147, v147
    v_add_f32 v23, v23, v146
    v_add_u32 v17, 0xfffe8000, v17
    s_waitcnt lgkmcnt(3)
    v_mfma_f32_32x32x16_bf16 v[160:175], v[212:215], v[68:71], v[160:175]
    ds_read_b128 v[208:211], v18 offset:8192
    v_exp_f32 v148, v148
    v_add_f32 v23, v23, v147
    v_cvt_pk_bf16_f32 v201, v146, v147
    v_add_u32 v15, 0xfffe8000, v15
    v_mfma_f32_32x32x16_bf16 v[176:191], v[212:215], v[100:103], v[176:191]
    ds_read_b64_tr_b16 a[70:71], v39 offset:2048
    v_exp_f32_e64 v149, v149
    v_add_f32 v23, v23, v148
    v_add_u32 v18, 0xfffe8000, v18
    s_waitcnt lgkmcnt(4)
    v_mfma_f32_32x32x16_bf16 v[160:175], v[216:219], v[72:75], v[160:175]
    ds_read_b128 v[212:215], v19 offset:8192
    v_exp_f32 v150, v150
    v_add_f32 v23, v23, v149
    v_cvt_pk_bf16_f32 v202, v148, v149
    v_add_u32 v16, 0xfffe8000, v16
    v_mfma_f32_32x32x16_bf16 v[176:191], v[216:219], v[104:107], v[176:191]
    v_exp_f32_e64 v151, v151
    v_add_f32 v23, v23, v150
    v_add_u32 v19, 0xfffe8000, v19
    s_waitcnt lgkmcnt(4)
    v_mfma_f32_32x32x16_bf16 v[160:175], v[220:223], v[76:79], v[160:175]
    ds_read_b128 v[216:219], v20 offset:8192
    v_exp_f32 v136, v136
    v_add_f32 v23, v23, v151
    v_cvt_pk_bf16_f32 v203, v150, v151
    v_xor_b32_e64 v39, 64, v59
    v_mfma_f32_32x32x16_bf16 v[176:191], v[220:223], v[108:111], v[176:191]
    ds_read_b64_tr_b16 a[72:73], v39
    v_exp_f32_e64 v137, v137
    v_add_f32 v22, v22, v136
    v_add_u32 v20, 0xfffe8000, v20
    s_waitcnt lgkmcnt(4)
    v_mfma_f32_32x32x16_bf16 v[160:175], v[208:211], v[80:83], v[160:175]
    ds_read_b128 v[220:223], v21 offset:8192
    v_exp_f32 v138, v138
    v_add_f32 v22, v22, v137
    v_cvt_pk_bf16_f32 v196, v136, v137
    v_mfma_f32_32x32x16_bf16 v[176:191], v[208:211], v[112:115], v[176:191]
    ds_read_b64_tr_b16 a[74:75], v39 offset:2048
    v_exp_f32_e64 v139, v139
    v_add_f32 v22, v22, v138
    v_add_u32 v21, 0xfffe8000, v21
    s_waitcnt lgkmcnt(4)
    v_mfma_f32_32x32x16_bf16 v[160:175], v[212:215], v[84:87], v[160:175]
    ds_read_b64_tr_b16 v[208:209], v10 offset:0
    v_exp_f32 v140, v140
    v_add_f32 v22, v22, v139
    v_cvt_pk_bf16_f32 v197, v138, v139
    v_mfma_f32_32x32x16_bf16 v[176:191], v[212:215], v[116:119], v[176:191]
    ds_read_b64_tr_b16 v[210:211], v10 offset:2048
    v_exp_f32_e64 v141, v141
    v_add_f32 v22, v22, v140
    s_waitcnt lgkmcnt(5)
    v_mfma_f32_32x32x16_bf16 v[160:175], v[216:219], v[88:91], v[160:175]
    ds_read_b64_tr_b16 v[212:213], v11 offset:0
    v_exp_f32 v142, v142
    v_add_f32 v22, v22, v141
    v_cvt_pk_bf16_f32 v198, v140, v141
    v_mfma_f32_32x32x16_bf16 v[176:191], v[216:219], v[120:123], v[176:191]
    ds_read_b64_tr_b16 v[214:215], v11 offset:2048
    buffer_store_dwordx4 a[68:71], v54, s[36:39], s5 offen offset:1024 sc1
    v_exp_f32_e64 v143, v143
    v_add_f32 v22, v22, v142
    s_waitcnt lgkmcnt(5)
    v_mfma_f32_32x32x16_bf16 v[160:175], v[220:223], v[92:95], v[160:175]
    ds_read_b64_tr_b16 v[216:217], v12 offset:0
    v_exp_f32 v152, v152
    v_add_f32 v22, v22, v143
    v_cvt_pk_bf16_f32 v199, v142, v143
    v_mfma_f32_32x32x16_bf16 v[176:191], v[220:223], v[124:127], v[176:191]
    ds_read_b64_tr_b16 v[218:219], v12 offset:2048
    v_exp_f32_e64 v153, v153
    v_add_f32 v23, v23, v152
    s_waitcnt lgkmcnt(4)
    v_mfma_f32_32x32x16_bf16 a[128:143], v[208:211], v[192:195], a[128:143]
    ds_read_b64_tr_b16 v[220:221], v13 offset:0
    v_exp_f32 v154, v154
    v_add_f32 v23, v23, v153
    v_cvt_pk_bf16_f32 v204, v152, v153
    v_mfma_f32_32x32x16_bf16 a[192:207], v[208:211], v[200:203], a[192:207]
    ds_read_b64_tr_b16 v[222:223], v13 offset:2048
    v_exp_f32_e64 v155, v155
    v_add_f32 v23, v23, v154
    s_waitcnt lgkmcnt(4)
    v_mfma_f32_32x32x16_bf16 a[144:159], v[212:215], v[192:195], a[144:159]
    ds_read_b64_tr_b16 v[208:209], v10 offset:4096
    v_exp_f32 v156, v156
    v_add_f32 v23, v23, v155
    v_cvt_pk_bf16_f32 v205, v154, v155
    v_mfma_f32_32x32x16_bf16 a[208:223], v[212:215], v[200:203], a[208:223]
    ds_read_b64_tr_b16 v[210:211], v10 offset:6144
    v_exp_f32_e64 v157, v157
    v_add_f32 v23, v23, v156
    s_waitcnt lgkmcnt(4)
    v_mfma_f32_32x32x16_bf16 a[160:175], v[216:219], v[192:195], a[160:175]
    ds_read_b64_tr_b16 v[212:213], v11 offset:4096
    v_exp_f32 v158, v158
    v_add_f32 v23, v23, v157
    v_cvt_pk_bf16_f32 v206, v156, v157
    v_mfma_f32_32x32x16_bf16 a[224:239], v[216:219], v[200:203], a[224:239]
    ds_read_b64_tr_b16 v[214:215], v11 offset:6144
    buffer_store_dwordx4 a[72:75], v54, s[36:39], s5 offen offset:2048 sc1
    v_exp_f32_e64 v159, v159
    v_add_f32 v23, v23, v158
    s_waitcnt lgkmcnt(4)
    v_mfma_f32_32x32x16_bf16 a[176:191], v[220:223], v[192:195], a[176:191]
    ds_read_b64_tr_b16 v[216:217], v12 offset:4096
    v_exp_f32 v160, v160
    v_add_f32 v23, v23, v159
    v_cvt_pk_bf16_f32 v207, v158, v159
    v_mfma_f32_32x32x16_bf16 a[240:255], v[220:223], v[200:203], a[240:255]
    ds_read_b64_tr_b16 v[218:219], v12 offset:6144
    v_exp_f32_e64 v161, v161
    v_add_f32 v22, v22, v160
    s_waitcnt lgkmcnt(4)
    v_mfma_f32_32x32x16_bf16 a[128:143], v[208:211], v[196:199], a[128:143]
    ds_read_b64_tr_b16 v[220:221], v13 offset:4096
    v_exp_f32 v162, v162
    v_add_f32 v22, v22, v161
    v_cvt_pk_bf16_f32 v192, v160, v161
    v_mfma_f32_32x32x16_bf16 a[192:207], v[208:211], v[204:207], a[192:207]
    ds_read_b64_tr_b16 v[222:223], v13 offset:6144
    v_exp_f32_e64 v163, v163
    v_add_f32 v22, v22, v162
    s_waitcnt lgkmcnt(4)
    v_mfma_f32_32x32x16_bf16 a[144:159], v[212:215], v[196:199], a[144:159]
    s_waitcnt vmcnt(13)
    s_barrier
    ds_read_b128 v[208:211], v14 offset:0
    v_exp_f32 v164, v164
    v_add_f32 v22, v22, v163
    v_cvt_pk_bf16_f32 v193, v162, v163
    v_mfma_f32_32x32x16_bf16 a[208:223], v[212:215], v[204:207], a[208:223]
    v_exp_f32_e64 v165, v165
    v_add_f32 v22, v22, v164
    s_waitcnt lgkmcnt(3)
    v_mfma_f32_32x32x16_bf16 a[160:175], v[216:219], v[196:199], a[160:175]
    ds_read_b128 v[212:215], v15 offset:0
    v_exp_f32 v166, v166
    v_add_f32 v22, v22, v165
    v_cvt_pk_bf16_f32 v194, v164, v165
    v_mfma_f32_32x32x16_bf16 a[224:239], v[216:219], v[204:207], a[224:239]
    v_exp_f32_e64 v167, v167
    v_add_f32 v22, v22, v166
    s_waitcnt lgkmcnt(2)
    v_mfma_f32_32x32x16_bf16 a[176:191], v[220:223], v[196:199], a[176:191]
    ds_read_b128 v[216:219], v16 offset:0
    v_exp_f32 v176, v176
    v_add_f32 v22, v22, v167
    v_cvt_pk_bf16_f32 v195, v166, v167
    v_mfma_f32_32x32x16_bf16 a[240:255], v[220:223], v[204:207], a[240:255]
    v_exp_f32_e64 v177, v177
    v_add_f32 v23, v23, v176
    s_waitcnt lgkmcnt(2)
    v_mfma_f32_32x32x16_bf16 v[128:143], v[208:211], v[64:67], 0
    ds_read_b128 v[220:223], v17 offset:0
    s_mov_b32 m0, s89
    v_exp_f32 v178, v178
    v_add_f32_e64 v23, v23, v177
    v_cvt_pk_bf16_f32 v200, v176, v177
    v_mfma_f32_32x32x16_bf16 v[144:159], v[208:211], v[96:99], 0
    buffer_load_dwordx4 v2, s[24:27], s88 offen offset:0 lds
    v_exp_f32_e64 v179, v179
    v_add_f32 v23, v23, v178
    s_waitcnt lgkmcnt(2)
    v_mfma_f32_32x32x16_bf16 v[128:143], v[212:215], v[68:71], v[128:143]
    ds_read_b128 v[208:211], v18 offset:0
    v_exp_f32 v180, v180
    v_add_f32 v23, v23, v179
    v_cvt_pk_bf16_f32 v201, v178, v179
    v_xor_b32 v39, 96, v59
    v_mfma_f32_32x32x16_bf16 v[144:159], v[212:215], v[100:103], v[144:159]
    ds_read_b64_tr_b16 a[64:65], v39
    v_exp_f32_e64 v181, v181
    v_add_f32 v23, v23, v180
    s_waitcnt lgkmcnt(3)
    v_mfma_f32_32x32x16_bf16 v[128:143], v[216:219], v[72:75], v[128:143]
    ds_read_b128 v[212:215], v19 offset:0
    v_exp_f32 v182, v182
    v_add_f32 v23, v23, v181
    v_cvt_pk_bf16_f32 v202, v180, v181
    v_mfma_f32_32x32x16_bf16 v[144:159], v[216:219], v[104:107], v[144:159]
    ds_read_b64_tr_b16 a[66:67], v39 offset:2048
    buffer_load_dwordx4 v3, s[24:27], s88 offen offset:1024 lds
    v_exp_f32_e64 v183, v183
    v_add_f32 v23, v23, v182
    s_waitcnt lgkmcnt(4)
    v_mfma_f32_32x32x16_bf16 v[128:143], v[220:223], v[76:79], v[128:143]
    ds_read_b128 v[216:219], v20 offset:0
    v_exp_f32 v168, v168
    v_add_f32 v23, v23, v183
    v_cvt_pk_bf16_f32 v203, v182, v183
    v_mfma_f32_32x32x16_bf16 v[144:159], v[220:223], v[108:111], v[144:159]
    v_exp_f32_e64 v169, v169
    v_add_f32 v22, v22, v168
    s_waitcnt lgkmcnt(4)
    v_mfma_f32_32x32x16_bf16 v[128:143], v[208:211], v[80:83], v[128:143]
    ds_read_b128 v[220:223], v21 offset:0
    v_exp_f32 v170, v170
    v_add_f32 v22, v22, v169
    v_cvt_pk_bf16_f32 v196, v168, v169
    v_mfma_f32_32x32x16_bf16 v[144:159], v[208:211], v[112:115], v[144:159]
    buffer_load_dwordx4 v4, s[24:27], s88 offen offset:2048 lds
    v_exp_f32_e64 v171, v171
    v_add_f32 v22, v22, v170
    s_waitcnt lgkmcnt(3)
    v_mfma_f32_32x32x16_bf16 v[128:143], v[212:215], v[84:87], v[128:143]
    ds_read_b64_tr_b16 v[208:209], v10 offset:8192
    v_exp_f32 v172, v172
    v_add_f32 v22, v22, v171
    v_cvt_pk_bf16_f32 v197, v170, v171
    v_mfma_f32_32x32x16_bf16 v[144:159], v[212:215], v[116:119], v[144:159]
    ds_read_b64_tr_b16 v[210:211], v10 offset:10240
    v_exp_f32_e64 v173, v173
    v_add_f32 v22, v22, v172
    s_waitcnt lgkmcnt(3)
    v_mfma_f32_32x32x16_bf16 v[128:143], v[216:219], v[88:91], v[128:143]
    ds_read_b64_tr_b16 v[212:213], v11 offset:8192
    v_exp_f32 v174, v174
    v_add_f32 v22, v22, v173
    v_cvt_pk_bf16_f32 v198, v172, v173
    v_mfma_f32_32x32x16_bf16 v[144:159], v[216:219], v[120:123], v[144:159]
    ds_read_b64_tr_b16 v[214:215], v11 offset:10240
    buffer_load_dwordx4 v5, s[24:27], s88 offen offset:3072 lds
    v_exp_f32_e64 v175, v175
    v_add_f32 v22, v22, v174
    s_waitcnt lgkmcnt(4)
    v_mfma_f32_32x32x16_bf16 v[128:143], v[220:223], v[92:95], v[128:143]
    ds_read_b64_tr_b16 v[216:217], v12 offset:8192
    v_exp_f32 v184, v184
    v_add_f32 v22, v22, v175
    v_cvt_pk_bf16_f32 v199, v174, v175
    v_mfma_f32_32x32x16_bf16 v[144:159], v[220:223], v[124:127], v[144:159]
    ds_read_b64_tr_b16 v[218:219], v12 offset:10240
    s_add_u32 m0, m0, 16384
    v_exp_f32_e64 v185, v185
    v_add_f32 v23, v23, v184
    s_waitcnt lgkmcnt(4)
    v_mfma_f32_32x32x16_bf16 a[128:143], v[208:211], v[192:195], a[128:143]
    ds_read_b64_tr_b16 v[220:221], v13 offset:8192
    v_exp_f32 v186, v186
    v_add_f32 v23, v23, v185
    v_cvt_pk_bf16_f32 v204, v184, v185
    v_mfma_f32_32x32x16_bf16 a[192:207], v[208:211], v[200:203], a[192:207]
    ds_read_b64_tr_b16 v[222:223], v13 offset:10240
    buffer_load_dwordx4 v6, s[28:31], s88 offen offset:0 lds
    v_exp_f32_e64 v187, v187
    v_add_f32 v23, v23, v186
    s_waitcnt lgkmcnt(4)
    v_mfma_f32_32x32x16_bf16 a[144:159], v[212:215], v[192:195], a[144:159]
    ds_read_b64_tr_b16 v[208:209], v10 offset:12288
    v_exp_f32 v188, v188
    v_add_f32 v23, v23, v187
    v_cvt_pk_bf16_f32 v205, v186, v187
    v_mfma_f32_32x32x16_bf16 a[208:223], v[212:215], v[200:203], a[208:223]
    ds_read_b64_tr_b16 v[210:211], v10 offset:14336
    buffer_store_dwordx4 a[64:67], v54, s[36:39], s5 offen offset:3072 sc1
    v_exp_f32_e64 v189, v189
    v_add_f32 v23, v23, v188
    s_waitcnt lgkmcnt(4)
    v_mfma_f32_32x32x16_bf16 a[160:175], v[216:219], v[192:195], a[160:175]
    ds_read_b64_tr_b16 v[212:213], v11 offset:12288
    v_exp_f32 v190, v190
    v_add_f32 v23, v23, v189
    v_cvt_pk_bf16_f32 v206, v188, v189
    v_add_u32 v10, 0xfffe8000, v10
    v_mfma_f32_32x32x16_bf16 a[224:239], v[216:219], v[200:203], a[224:239]
    ds_read_b64_tr_b16 v[214:215], v11 offset:14336
    buffer_load_dwordx4 v6, s[28:31], s88 offen offset:1024 lds
    v_exp_f32_e64 v191, v191
    v_add_f32 v23, v23, v190
    s_waitcnt lgkmcnt(4)
    v_mfma_f32_32x32x16_bf16 a[176:191], v[220:223], v[192:195], a[176:191]
    ds_read_b64_tr_b16 v[216:217], v12 offset:12288
    v_exp_f32 v128, v128
    v_add_f32 v23, v23, v191
    v_cvt_pk_bf16_f32 v207, v190, v191
    v_add_u32 v11, 0xfffe8000, v11
    v_mfma_f32_32x32x16_bf16 a[240:255], v[220:223], v[200:203], a[240:255]
    ds_read_b64_tr_b16 v[218:219], v12 offset:14336
    v_exp_f32_e64 v129, v129
    v_add_f32 v22, v22, v128
    s_waitcnt lgkmcnt(4)
    v_mfma_f32_32x32x16_bf16 a[128:143], v[208:211], v[196:199], a[128:143]
    ds_read_b64_tr_b16 v[220:221], v13 offset:12288
    v_exp_f32 v130, v130
    v_add_f32 v22, v22, v129
    v_cvt_pk_bf16_f32 v192, v128, v129
    v_add_u32 v12, 0xfffe8000, v12
    v_mfma_f32_32x32x16_bf16 a[192:207], v[208:211], v[204:207], a[192:207]
    ds_read_b64_tr_b16 v[222:223], v13 offset:14336
    buffer_load_dwordx4 v6, s[28:31], s88 offen offset:2048 lds
    v_exp_f32_e64 v131, v131
    v_add_f32 v22, v22, v130
    s_waitcnt lgkmcnt(4)
    v_mfma_f32_32x32x16_bf16 a[144:159], v[212:215], v[196:199], a[144:159]
    ds_read_b128 v[208:211], v14 offset:8192
    v_exp_f32 v132, v132
    v_add_f32 v22, v22, v131
    v_cvt_pk_bf16_f32 v193, v130, v131
    v_add_u32 v13, 0xfffe8000, v13
    v_mfma_f32_32x32x16_bf16 a[208:223], v[212:215], v[204:207], a[208:223]
    s_add_u32 s89, s89, 32768
    v_exp_f32_e64 v133, v133
    v_add_f32 v22, v22, v132
    s_waitcnt lgkmcnt(3)
    v_mfma_f32_32x32x16_bf16 a[160:175], v[216:219], v[196:199], a[160:175]
    ds_read_b128 v[212:215], v15 offset:8192
    v_exp_f32 v134, v134
    v_add_f32 v22, v22, v133
    v_cvt_pk_bf16_f32 v194, v132, v133
    v_mfma_f32_32x32x16_bf16 a[224:239], v[216:219], v[204:207], a[224:239]
    buffer_load_dwordx4 v6, s[28:31], s88 offen offset:3072 lds
    v_exp_f32_e64 v135, v135
    v_add_f32 v22, v22, v134
    s_waitcnt lgkmcnt(2)
    v_mfma_f32_32x32x16_bf16 a[176:191], v[220:223], v[196:199], a[176:191]
    ds_read_b128 v[216:219], v16 offset:8192
    s_add_u32 s88, s88, 16384
    v_exp_f32 v144, v144
    v_add_f32 v22, v22, v135
    v_cvt_pk_bf16_f32 v195, v134, v135
    v_mfma_f32_32x32x16_bf16 a[240:255], v[220:223], v[204:207], a[240:255]
    v_exp_f32_e64 v145, v145
    v_add_f32 v23, v23, v144
    s_waitcnt lgkmcnt(2)
    v_mfma_f32_32x32x16_bf16 v[160:175], v[208:211], v[64:67], 0
    ds_read_b128 v[220:223], v17 offset:8192
    v_exp_f32 v146, v146
    v_add_f32 v23, v23, v145
    v_cvt_pk_bf16_f32 v200, v144, v145
    v_add_u32 v14, 0x8000, v14
    v_xor_b32 v39, 4096, v59
    v_mfma_f32_32x32x16_bf16 v[176:191], v[208:211], v[96:99], 0
    ds_read_b64_tr_b16 a[68:69], v39
    v_exp_f32_e64 v147, v147
    v_add_f32 v23, v23, v146
    v_add_u32 v17, 0x8000, v17
    s_waitcnt lgkmcnt(3)
    v_mfma_f32_32x32x16_bf16 v[160:175], v[212:215], v[68:71], v[160:175]
    ds_read_b128 v[208:211], v18 offset:8192
    v_exp_f32 v148, v148
    v_add_f32 v23, v23, v147
    v_cvt_pk_bf16_f32 v201, v146, v147
    v_add_u32 v15, 0x8000, v15
    v_mfma_f32_32x32x16_bf16 v[176:191], v[212:215], v[100:103], v[176:191]
    ds_read_b64_tr_b16 a[70:71], v39 offset:2048
    v_exp_f32_e64 v149, v149
    v_add_f32 v23, v23, v148
    v_add_u32 v18, 0x8000, v18
    s_waitcnt lgkmcnt(4)
    v_mfma_f32_32x32x16_bf16 v[160:175], v[216:219], v[72:75], v[160:175]
    ds_read_b128 v[212:215], v19 offset:8192
    v_exp_f32 v150, v150
    v_add_f32 v23, v23, v149
    v_cvt_pk_bf16_f32 v202, v148, v149
    v_add_u32 v16, 0x8000, v16
    v_mfma_f32_32x32x16_bf16 v[176:191], v[216:219], v[104:107], v[176:191]
    v_exp_f32_e64 v151, v151
    v_add_f32 v23, v23, v150
    v_add_u32 v19, 0x8000, v19
    s_waitcnt lgkmcnt(4)
    v_mfma_f32_32x32x16_bf16 v[160:175], v[220:223], v[76:79], v[160:175]
    ds_read_b128 v[216:219], v20 offset:8192
    v_exp_f32 v136, v136
    v_add_f32 v23, v23, v151
    v_cvt_pk_bf16_f32 v203, v150, v151
    v_xor_b32 v39, 4128, v59
    v_mfma_f32_32x32x16_bf16 v[176:191], v[220:223], v[108:111], v[176:191]
    ds_read_b64_tr_b16 a[72:73], v39
    v_exp_f32_e64 v137, v137
    v_add_f32 v22, v22, v136
    v_add_u32 v20, 0x8000, v20
    s_waitcnt lgkmcnt(4)
    v_mfma_f32_32x32x16_bf16 v[160:175], v[208:211], v[80:83], v[160:175]
    ds_read_b128 v[220:223], v21 offset:8192
    v_exp_f32 v138, v138
    v_add_f32 v22, v22, v137
    v_cvt_pk_bf16_f32 v196, v136, v137
    v_mfma_f32_32x32x16_bf16 v[176:191], v[208:211], v[112:115], v[176:191]
    ds_read_b64_tr_b16 a[74:75], v39 offset:2048
    v_exp_f32_e64 v139, v139
    v_add_f32 v22, v22, v138
    v_add_u32 v21, 0x8000, v21
    s_waitcnt lgkmcnt(4)
    v_mfma_f32_32x32x16_bf16 v[160:175], v[212:215], v[84:87], v[160:175]
    ds_read_b64_tr_b16 v[208:209], v10 offset:0
    v_exp_f32 v140, v140
    v_add_f32 v22, v22, v139
    v_cvt_pk_bf16_f32 v197, v138, v139
    v_mfma_f32_32x32x16_bf16 v[176:191], v[212:215], v[116:119], v[176:191]
    ds_read_b64_tr_b16 v[210:211], v10 offset:2048
    v_exp_f32_e64 v141, v141
    v_add_f32 v22, v22, v140
    s_waitcnt lgkmcnt(5)
    v_mfma_f32_32x32x16_bf16 v[160:175], v[216:219], v[88:91], v[160:175]
    ds_read_b64_tr_b16 v[212:213], v11 offset:0
    v_exp_f32 v142, v142
    v_add_f32 v22, v22, v141
    v_cvt_pk_bf16_f32 v198, v140, v141
    v_mfma_f32_32x32x16_bf16 v[176:191], v[216:219], v[120:123], v[176:191]
    ds_read_b64_tr_b16 v[214:215], v11 offset:2048
    buffer_store_dwordx4 a[68:71], v55, s[36:39], s5 offen offset:0 sc1
    v_exp_f32_e64 v143, v143
    v_add_f32 v22, v22, v142
    s_waitcnt lgkmcnt(5)
    v_mfma_f32_32x32x16_bf16 v[160:175], v[220:223], v[92:95], v[160:175]
    ds_read_b64_tr_b16 v[216:217], v12 offset:0
    v_exp_f32 v152, v152
    v_add_f32 v22, v22, v143
    v_cvt_pk_bf16_f32 v199, v142, v143
    v_mfma_f32_32x32x16_bf16 v[176:191], v[220:223], v[124:127], v[176:191]
    ds_read_b64_tr_b16 v[218:219], v12 offset:2048
    v_exp_f32_e64 v153, v153
    v_add_f32 v23, v23, v152
    s_waitcnt lgkmcnt(4)
    v_mfma_f32_32x32x16_bf16 a[128:143], v[208:211], v[192:195], a[128:143]
    ds_read_b64_tr_b16 v[220:221], v13 offset:0
    v_exp_f32 v154, v154
    v_add_f32 v23, v23, v153
    v_cvt_pk_bf16_f32 v204, v152, v153
    v_mfma_f32_32x32x16_bf16 a[192:207], v[208:211], v[200:203], a[192:207]
    ds_read_b64_tr_b16 v[222:223], v13 offset:2048
    v_exp_f32_e64 v155, v155
    v_add_f32 v23, v23, v154
    s_waitcnt lgkmcnt(4)
    v_mfma_f32_32x32x16_bf16 a[144:159], v[212:215], v[192:195], a[144:159]
    ds_read_b64_tr_b16 v[208:209], v10 offset:4096
    v_exp_f32 v156, v156
    v_add_f32 v23, v23, v155
    v_cvt_pk_bf16_f32 v205, v154, v155
    v_mfma_f32_32x32x16_bf16 a[208:223], v[212:215], v[200:203], a[208:223]
    ds_read_b64_tr_b16 v[210:211], v10 offset:6144
    v_exp_f32_e64 v157, v157
    v_add_f32 v23, v23, v156
    s_waitcnt lgkmcnt(4)
    v_mfma_f32_32x32x16_bf16 a[160:175], v[216:219], v[192:195], a[160:175]
    ds_read_b64_tr_b16 v[212:213], v11 offset:4096
    v_exp_f32 v158, v158
    v_add_f32 v23, v23, v157
    v_cvt_pk_bf16_f32 v206, v156, v157
    v_mfma_f32_32x32x16_bf16 a[224:239], v[216:219], v[200:203], a[224:239]
    ds_read_b64_tr_b16 v[214:215], v11 offset:6144
    buffer_store_dwordx4 a[72:75], v55, s[36:39], s5 offen offset:1024 sc1
    v_exp_f32_e64 v159, v159
    v_add_f32 v23, v23, v158
    s_waitcnt lgkmcnt(4)
    v_mfma_f32_32x32x16_bf16 a[176:191], v[220:223], v[192:195], a[176:191]
    ds_read_b64_tr_b16 v[216:217], v12 offset:4096
    v_exp_f32 v160, v160
    v_add_f32 v23, v23, v159
    v_cvt_pk_bf16_f32 v207, v158, v159
    v_mfma_f32_32x32x16_bf16 a[240:255], v[220:223], v[200:203], a[240:255]
    ds_read_b64_tr_b16 v[218:219], v12 offset:6144
    v_exp_f32_e64 v161, v161
    v_add_f32 v22, v22, v160
    s_waitcnt lgkmcnt(4)
    v_mfma_f32_32x32x16_bf16 a[128:143], v[208:211], v[196:199], a[128:143]
    ds_read_b64_tr_b16 v[220:221], v13 offset:4096
    v_exp_f32 v162, v162
    v_add_f32 v22, v22, v161
    v_cvt_pk_bf16_f32 v192, v160, v161
    v_mfma_f32_32x32x16_bf16 a[192:207], v[208:211], v[204:207], a[192:207]
    ds_read_b64_tr_b16 v[222:223], v13 offset:6144
    v_exp_f32_e64 v163, v163
    v_add_f32 v22, v22, v162
    s_waitcnt lgkmcnt(4)
    v_mfma_f32_32x32x16_bf16 a[144:159], v[212:215], v[196:199], a[144:159]
    s_waitcnt vmcnt(13)
    s_barrier
    ds_read_b128 v[208:211], v14 offset:0
    v_exp_f32 v164, v164
    v_add_f32 v22, v22, v163
    v_cvt_pk_bf16_f32 v193, v162, v163
    v_mfma_f32_32x32x16_bf16 a[208:223], v[212:215], v[204:207], a[208:223]
    v_exp_f32_e64 v165, v165
    v_add_f32 v22, v22, v164
    s_waitcnt lgkmcnt(3)
    v_mfma_f32_32x32x16_bf16 a[160:175], v[216:219], v[196:199], a[160:175]
    ds_read_b128 v[212:215], v15 offset:0
    v_exp_f32 v166, v166
    v_add_f32 v22, v22, v165
    v_cvt_pk_bf16_f32 v194, v164, v165
    v_mfma_f32_32x32x16_bf16 a[224:239], v[216:219], v[204:207], a[224:239]
    v_exp_f32_e64 v167, v167
    v_add_f32 v22, v22, v166
    s_waitcnt lgkmcnt(2)
    v_mfma_f32_32x32x16_bf16 a[176:191], v[220:223], v[196:199], a[176:191]
    ds_read_b128 v[216:219], v16 offset:0
    v_exp_f32 v176, v176
    v_add_f32 v22, v22, v167
    v_cvt_pk_bf16_f32 v195, v166, v167
    v_mfma_f32_32x32x16_bf16 a[240:255], v[220:223], v[204:207], a[240:255]
    v_exp_f32_e64 v177, v177
    v_add_f32 v23, v23, v176
    s_waitcnt lgkmcnt(2)
    v_mfma_f32_32x32x16_bf16 v[128:143], v[208:211], v[64:67], 0
    ds_read_b128 v[220:223], v17 offset:0
    s_mov_b32 m0, s89
    v_exp_f32 v178, v178
    v_add_f32_e64 v23, v23, v177
    v_cvt_pk_bf16_f32 v200, v176, v177
    v_mfma_f32_32x32x16_bf16 v[144:159], v[208:211], v[96:99], 0
    buffer_load_dwordx4 v2, s[24:27], s88 offen offset:0 lds
    v_exp_f32_e64 v179, v179
    v_add_f32 v23, v23, v178
    s_waitcnt lgkmcnt(2)
    v_mfma_f32_32x32x16_bf16 v[128:143], v[212:215], v[68:71], v[128:143]
    ds_read_b128 v[208:211], v18 offset:0
    v_exp_f32 v180, v180
    v_add_f32 v23, v23, v179
    v_cvt_pk_bf16_f32 v201, v178, v179
    v_xor_b32 v39, 4160, v59
    v_mfma_f32_32x32x16_bf16 v[144:159], v[212:215], v[100:103], v[144:159]
    ds_read_b64_tr_b16 a[64:65], v39
    v_exp_f32_e64 v181, v181
    v_add_f32 v23, v23, v180
    s_waitcnt lgkmcnt(3)
    v_mfma_f32_32x32x16_bf16 v[128:143], v[216:219], v[72:75], v[128:143]
    ds_read_b128 v[212:215], v19 offset:0
    v_exp_f32 v182, v182
    v_add_f32 v23, v23, v181
    v_cvt_pk_bf16_f32 v202, v180, v181
    v_mfma_f32_32x32x16_bf16 v[144:159], v[216:219], v[104:107], v[144:159]
    ds_read_b64_tr_b16 a[66:67], v39 offset:2048
    buffer_load_dwordx4 v3, s[24:27], s88 offen offset:1024 lds
    v_exp_f32_e64 v183, v183
    v_add_f32 v23, v23, v182
    s_waitcnt lgkmcnt(4)
    v_mfma_f32_32x32x16_bf16 v[128:143], v[220:223], v[76:79], v[128:143]
    ds_read_b128 v[216:219], v20 offset:0
    v_exp_f32 v168, v168
    v_add_f32 v23, v23, v183
    v_cvt_pk_bf16_f32 v203, v182, v183
    v_mfma_f32_32x32x16_bf16 v[144:159], v[220:223], v[108:111], v[144:159]
    buffer_store_dwordx2 v[28:29], v25, s[16:19], s59 offen sc1
    v_exp_f32_e64 v169, v169
    v_add_f32 v22, v22, v168
    s_waitcnt lgkmcnt(4)
    v_mfma_f32_32x32x16_bf16 v[128:143], v[208:211], v[80:83], v[128:143]
    ds_read_b128 v[220:223], v21 offset:0
    v_exp_f32 v170, v170
    v_add_f32 v22, v22, v169
    v_cvt_pk_bf16_f32 v196, v168, v169
    v_mfma_f32_32x32x16_bf16 v[144:159], v[208:211], v[112:115], v[144:159]
    buffer_load_dwordx4 v4, s[24:27], s88 offen offset:2048 lds
    v_exp_f32_e64 v171, v171
    v_add_f32 v22, v22, v170
    s_waitcnt lgkmcnt(3)
    v_mfma_f32_32x32x16_bf16 v[128:143], v[212:215], v[84:87], v[128:143]
    ds_read_b64_tr_b16 v[208:209], v10 offset:8192
    v_exp_f32 v172, v172
    v_add_f32 v22, v22, v171
    v_cvt_pk_bf16_f32 v197, v170, v171
    v_mfma_f32_32x32x16_bf16 v[144:159], v[212:215], v[116:119], v[144:159]
    ds_read_b64_tr_b16 v[210:211], v10 offset:10240
    v_exp_f32_e64 v173, v173
    v_add_f32 v22, v22, v172
    s_waitcnt lgkmcnt(3)
    v_mfma_f32_32x32x16_bf16 v[128:143], v[216:219], v[88:91], v[128:143]
    ds_read_b64_tr_b16 v[212:213], v11 offset:8192
    v_exp_f32 v174, v174
    v_add_f32 v22, v22, v173
    v_cvt_pk_bf16_f32 v198, v172, v173
    v_mfma_f32_32x32x16_bf16 v[144:159], v[216:219], v[120:123], v[144:159]
    ds_read_b64_tr_b16 v[214:215], v11 offset:10240
    buffer_load_dwordx4 v5, s[24:27], s88 offen offset:3072 lds
    v_exp_f32_e64 v175, v175
    v_add_f32 v22, v22, v174
    s_waitcnt lgkmcnt(4)
    v_mfma_f32_32x32x16_bf16 v[128:143], v[220:223], v[92:95], v[128:143]
    ds_read_b64_tr_b16 v[216:217], v12 offset:8192
    v_exp_f32 v184, v184
    v_add_f32 v22, v22, v175
    v_cvt_pk_bf16_f32 v199, v174, v175
    v_mfma_f32_32x32x16_bf16 v[144:159], v[220:223], v[124:127], v[144:159]
    ds_read_b64_tr_b16 v[218:219], v12 offset:10240
    s_add_u32 m0, m0, 16384
    v_exp_f32_e64 v185, v185
    v_add_f32 v23, v23, v184
    s_waitcnt lgkmcnt(4)
    v_mfma_f32_32x32x16_bf16 a[128:143], v[208:211], v[192:195], a[128:143]
    ds_read_b64_tr_b16 v[220:221], v13 offset:8192
    v_exp_f32 v186, v186
    v_add_f32 v23, v23, v185
    v_cvt_pk_bf16_f32 v204, v184, v185
    v_mfma_f32_32x32x16_bf16 a[192:207], v[208:211], v[200:203], a[192:207]
    ds_read_b64_tr_b16 v[222:223], v13 offset:10240
    buffer_load_dwordx4 v6, s[28:31], s88 offen offset:0 lds
    v_exp_f32_e64 v187, v187
    v_add_f32 v23, v23, v186
    s_waitcnt lgkmcnt(4)
    v_mfma_f32_32x32x16_bf16 a[144:159], v[212:215], v[192:195], a[144:159]
    ds_read_b64_tr_b16 v[208:209], v10 offset:12288
    v_exp_f32 v188, v188
    v_add_f32 v23, v23, v187
    v_cvt_pk_bf16_f32 v205, v186, v187
    v_mfma_f32_32x32x16_bf16 a[208:223], v[212:215], v[200:203], a[208:223]
    ds_read_b64_tr_b16 v[210:211], v10 offset:14336
    buffer_store_dwordx4 a[64:67], v55, s[36:39], s5 offen offset:2048 sc1
    v_exp_f32_e64 v189, v189
    v_add_f32 v23, v23, v188
    s_waitcnt lgkmcnt(4)
    v_mfma_f32_32x32x16_bf16 a[160:175], v[216:219], v[192:195], a[160:175]
    ds_read_b64_tr_b16 v[212:213], v11 offset:12288
    v_exp_f32 v190, v190
    v_add_f32 v23, v23, v189
    v_cvt_pk_bf16_f32 v206, v188, v189
    v_add_u32 v10, 0x8000, v10
    v_mfma_f32_32x32x16_bf16 a[224:239], v[216:219], v[200:203], a[224:239]
    ds_read_b64_tr_b16 v[214:215], v11 offset:14336
    buffer_load_dwordx4 v6, s[28:31], s88 offen offset:1024 lds
    v_exp_f32_e64 v191, v191
    v_add_f32 v23, v23, v190
    s_waitcnt lgkmcnt(4)
    v_mfma_f32_32x32x16_bf16 a[176:191], v[220:223], v[192:195], a[176:191]
    ds_read_b64_tr_b16 v[216:217], v12 offset:12288
    v_exp_f32 v128, v128
    v_add_f32 v23, v23, v191
    v_cvt_pk_bf16_f32 v207, v190, v191
    v_add_u32 v11, 0x8000, v11
    v_mfma_f32_32x32x16_bf16 a[240:255], v[220:223], v[200:203], a[240:255]
    ds_read_b64_tr_b16 v[218:219], v12 offset:14336
    v_exp_f32_e64 v129, v129
    v_add_f32 v22, v22, v128
    s_waitcnt lgkmcnt(4)
    v_mfma_f32_32x32x16_bf16 a[128:143], v[208:211], v[196:199], a[128:143]
    ds_read_b64_tr_b16 v[220:221], v13 offset:12288
    v_exp_f32 v130, v130
    v_add_f32 v22, v22, v129
    v_cvt_pk_bf16_f32 v192, v128, v129
    v_add_u32 v12, 0x8000, v12
    v_mfma_f32_32x32x16_bf16 a[192:207], v[208:211], v[204:207], a[192:207]
    ds_read_b64_tr_b16 v[222:223], v13 offset:14336
    buffer_load_dwordx4 v6, s[28:31], s88 offen offset:2048 lds
    v_exp_f32_e64 v131, v131
    v_add_f32 v22, v22, v130
    s_waitcnt lgkmcnt(4)
    v_mfma_f32_32x32x16_bf16 a[144:159], v[212:215], v[196:199], a[144:159]
    ds_read_b128 v[208:211], v14 offset:8192
    v_exp_f32 v132, v132
    v_add_f32 v22, v22, v131
    v_cvt_pk_bf16_f32 v193, v130, v131
    v_add_u32 v13, 0x8000, v13
    v_mfma_f32_32x32x16_bf16 a[208:223], v[212:215], v[204:207], a[208:223]
    s_add_u32 s89, s89, 32768
    v_exp_f32_e64 v133, v133
    v_add_f32 v22, v22, v132
    s_waitcnt lgkmcnt(3)
    v_mfma_f32_32x32x16_bf16 a[160:175], v[216:219], v[196:199], a[160:175]
    ds_read_b128 v[212:215], v15 offset:8192
    v_exp_f32 v134, v134
    v_add_f32 v22, v22, v133
    v_cvt_pk_bf16_f32 v194, v132, v133
    v_mfma_f32_32x32x16_bf16 a[224:239], v[216:219], v[204:207], a[224:239]
    buffer_load_dwordx4 v6, s[28:31], s88 offen offset:3072 lds
    v_exp_f32_e64 v135, v135
    v_add_f32 v22, v22, v134
    s_waitcnt lgkmcnt(2)
    v_mfma_f32_32x32x16_bf16 a[176:191], v[220:223], v[196:199], a[176:191]
    ds_read_b128 v[216:219], v16 offset:8192
    s_add_u32 s88, s88, 16384
    v_exp_f32 v144, v144
    v_add_f32 v22, v22, v135
    v_cvt_pk_bf16_f32 v195, v134, v135
    v_mfma_f32_32x32x16_bf16 a[240:255], v[220:223], v[204:207], a[240:255]
    v_exp_f32_e64 v145, v145
    v_add_f32 v23, v23, v144
    s_waitcnt lgkmcnt(2)
    v_mfma_f32_32x32x16_bf16 v[160:175], v[208:211], v[64:67], 0
    ds_read_b128 v[220:223], v17 offset:8192
    v_exp_f32 v146, v146
    v_add_f32 v23, v23, v145
    v_cvt_pk_bf16_f32 v200, v144, v145
    v_add_u32 v14, 0x8000, v14
    v_xor_b32 v39, 4192, v59
    v_mfma_f32_32x32x16_bf16 v[176:191], v[208:211], v[96:99], 0
    ds_read_b64_tr_b16 a[68:69], v39
    v_exp_f32_e64 v147, v147
    v_add_f32 v23, v23, v146
    v_add_u32 v17, 0x8000, v17
    s_waitcnt lgkmcnt(3)
    v_mfma_f32_32x32x16_bf16 v[160:175], v[212:215], v[68:71], v[160:175]
    ds_read_b128 v[208:211], v18 offset:8192
    v_exp_f32 v148, v148
    v_add_f32 v23, v23, v147
    v_cvt_pk_bf16_f32 v201, v146, v147
    v_add_u32 v15, 0x8000, v15
    v_mfma_f32_32x32x16_bf16 v[176:191], v[212:215], v[100:103], v[176:191]
    ds_read_b64_tr_b16 a[70:71], v39 offset:2048
    v_exp_f32_e64 v149, v149
    v_add_f32 v23, v23, v148
    v_add_u32 v18, 0x8000, v18
    s_waitcnt lgkmcnt(4)
    v_mfma_f32_32x32x16_bf16 v[160:175], v[216:219], v[72:75], v[160:175]
    ds_read_b128 v[212:215], v19 offset:8192
    v_exp_f32 v150, v150
    v_add_f32 v23, v23, v149
    v_cvt_pk_bf16_f32 v202, v148, v149
    v_add_u32 v16, 0x8000, v16
    v_mfma_f32_32x32x16_bf16 v[176:191], v[216:219], v[104:107], v[176:191]
    v_exp_f32_e64 v151, v151
    v_add_f32 v23, v23, v150
    v_add_u32 v19, 0x8000, v19
    s_waitcnt lgkmcnt(4)
    v_mfma_f32_32x32x16_bf16 v[160:175], v[220:223], v[76:79], v[160:175]
    ds_read_b128 v[216:219], v20 offset:8192
    v_exp_f32 v136, v136
    v_add_f32 v23, v23, v151
    v_cvt_pk_bf16_f32 v203, v150, v151
    v_mfma_f32_32x32x16_bf16 v[176:191], v[220:223], v[108:111], v[176:191]
    v_exp_f32_e64 v137, v137
    v_add_f32 v22, v22, v136
    v_add_u32 v20, 0x8000, v20
    s_waitcnt lgkmcnt(3)
    v_mfma_f32_32x32x16_bf16 v[160:175], v[208:211], v[80:83], v[160:175]
    ds_read_b128 v[220:223], v21 offset:8192
    v_exp_f32 v138, v138
    v_add_f32 v22, v22, v137
    v_cvt_pk_bf16_f32 v196, v136, v137
    v_mfma_f32_32x32x16_bf16 v[176:191], v[208:211], v[112:115], v[176:191]
    v_exp_f32_e64 v139, v139
    v_add_f32 v22, v22, v138
    v_add_u32 v21, 0x8000, v21
    s_waitcnt lgkmcnt(2)
    v_mfma_f32_32x32x16_bf16 v[160:175], v[212:215], v[84:87], v[160:175]
    ds_read_b64_tr_b16 v[208:209], v10 offset:0
    v_exp_f32 v140, v140
    v_add_f32 v22, v22, v139
    v_cvt_pk_bf16_f32 v197, v138, v139
    s_lshl_b32 s6, s50, 5
    v_and_b32 v37, 3, v1
    v_mfma_f32_32x32x16_bf16 v[176:191], v[212:215], v[116:119], v[176:191]
    ds_read_b64_tr_b16 v[210:211], v10 offset:2048
    v_exp_f32 v141, v141
    v_add_f32 v22, v22, v140
    v_lshlrev_b32 v37, 2, v37
    s_waitcnt lgkmcnt(3)
    v_mfma_f32_32x32x16_bf16 v[160:175], v[216:219], v[88:91], v[160:175]
    ds_read_b64_tr_b16 v[212:213], v11 offset:0
    v_exp_f32_e64 v142, v142
    v_add_f32 v22, v22, v141
    v_cvt_pk_bf16_f32 v198, v140, v141
    s_and_b32 s7, s49, 0x13
    v_mfma_f32_32x32x16_bf16 v[176:191], v[216:219], v[120:123], v[176:191]
    ds_read_b64_tr_b16 v[214:215], v11 offset:2048
    buffer_store_dwordx4 a[68:71], v55, s[36:39], s5 offen offset:3072 sc1
    v_exp_f32 v143, v143
    v_add_f32 v22, v22, v142
    s_add_u32 s7, s7, s6
    s_waitcnt lgkmcnt(4)
    v_mfma_f32_32x32x16_bf16 v[160:175], v[220:223], v[92:95], v[160:175]
    ds_read_b64_tr_b16 v[216:217], v12 offset:0
    v_exp_f32 v152, v152
    v_add_f32 v22, v22, v143
    v_cvt_pk_bf16_f32 v199, v142, v143
    v_add_lshl_u32 v37, v37, s7, 7
    v_mfma_f32_32x32x16_bf16 v[176:191], v[220:223], v[124:127], v[176:191]
    ds_read_b64_tr_b16 v[218:219], v12 offset:2048
    v_exp_f32 v153, v153
    v_add_f32 v23, v23, v152
    s_lshr_b32 s7, s76, 1
    s_waitcnt lgkmcnt(4)
    v_mfma_f32_32x32x16_bf16 a[128:143], v[208:211], v[192:195], a[128:143]
    ds_read_b64_tr_b16 v[220:221], v13 offset:0
    v_exp_f32_e64 v154, v154
    v_add_f32 v23, v23, v153
    v_cvt_pk_bf16_f32 v204, v152, v153
    s_lshl_b32 s6, s7, 5
    v_mfma_f32_32x32x16_bf16 a[192:207], v[208:211], v[200:203], a[192:207]
    ds_read_b64_tr_b16 v[222:223], v13 offset:2048
    v_exp_f32 v155, v155
    v_add_f32 v23, v23, v154
    s_lshl_b32 s61, s48, 3
    s_waitcnt lgkmcnt(4)
    v_mfma_f32_32x32x16_bf16 a[144:159], v[212:215], v[192:195], a[144:159]
    ds_read_b64_tr_b16 v[208:209], v10 offset:4096
    v_exp_f32_e64 v156, v156
    v_add_f32 v23, v23, v155
    v_cvt_pk_bf16_f32 v205, v154, v155
    s_add_u32 s6, s6, s61
    v_mfma_f32_32x32x16_bf16 a[208:223], v[212:215], v[200:203], a[208:223]
    ds_read_b64_tr_b16 v[210:211], v10 offset:6144
    buffer_store_dwordx4 v[40:43], v54, s[44:47], s4 offen offset:0 sc1
    v_exp_f32 v157, v157
    v_add_f32 v23, v23, v156
    v_add_lshl_u32 v34, v1, s6, 7
    v_cmp_gt_u32 vcc, 8, v1
    s_waitcnt lgkmcnt(4)
    v_mfma_f32_32x32x16_bf16 a[160:175], v[216:219], v[192:195], a[160:175]
    ds_read_b64_tr_b16 v[212:213], v11 offset:4096
    v_exp_f32 v158, v158
    v_add_f32 v23, v23, v157
    v_cvt_pk_bf16_f32 v206, v156, v157
    v_and_b32_e64 v35, 15, v1
    v_mfma_f32_32x32x16_bf16 a[224:239], v[216:219], v[200:203], a[224:239]
    ds_read_b64_tr_b16 v[214:215], v11 offset:6144
    v_exp_f32 v159, v159
    v_add_f32 v23, v23, v158
    v_lshlrev_b32 v35, 2, v35
    s_waitcnt lgkmcnt(4)
    v_mfma_f32_32x32x16_bf16 a[176:191], v[220:223], v[192:195], a[176:191]
    ds_read_b64_tr_b16 v[216:217], v12 offset:4096
    v_exp_f32_e64 v160, v160
    v_add_f32 v23, v23, v159
    v_cvt_pk_bf16_f32 v207, v158, v159
    s_lshl_b32 s6, s48, 6
    v_mfma_f32_32x32x16_bf16 a[240:255], v[220:223], v[200:203], a[240:255]
    ds_read_b64_tr_b16 v[218:219], v12 offset:6144
    v_exp_f32 v161, v161
    v_add_f32 v22, v22, v160
    s_add_u32 s6, s6, 3
    s_waitcnt lgkmcnt(4)
    v_mfma_f32_32x32x16_bf16 a[128:143], v[208:211], v[196:199], a[128:143]
    ds_read_b64_tr_b16 v[220:221], v13 offset:4096
    v_exp_f32 v162, v162
    v_add_f32 v22, v22, v161
    v_cvt_pk_bf16_f32 v192, v160, v161
    v_add_lshl_u32 v35, v35, s6, 7
    v_mfma_f32_32x32x16_bf16 a[192:207], v[208:211], v[204:207], a[192:207]
    ds_read_b64_tr_b16 v[222:223], v13 offset:6144
    v_exp_f32 v163, v163
    v_add_f32 v22, v22, v162
    v_cndmask_b32 v34, v35, v34, vcc
    s_waitcnt lgkmcnt(4)
    v_mfma_f32_32x32x16_bf16 a[144:159], v[212:215], v[196:199], a[144:159]
    s_waitcnt vmcnt(13)
    s_barrier
    ds_read_b128 v[208:211], v14 offset:0
    v_exp_f32 v164, v164
    v_add_f32 v22, v22, v163
    v_cvt_pk_bf16_f32 v193, v162, v163
    v_mfma_f32_32x32x16_bf16 a[208:223], v[212:215], v[204:207], a[208:223]
    v_exp_f32_e64 v165, v165
    v_add_f32 v22, v22, v164
    v_bfe_u32 v36, v1, 4, 1
    s_waitcnt lgkmcnt(3)
    v_mfma_f32_32x32x16_bf16 a[160:175], v[216:219], v[196:199], a[160:175]
    ds_read_b128 v[212:215], v15 offset:0
    v_exp_f32 v166, v166
    v_add_f32 v22, v22, v165
    v_cvt_pk_bf16_f32 v194, v164, v165
    v_add_u32_e64 v36, s77, v36
    v_mfma_f32_32x32x16_bf16 a[224:239], v[216:219], v[204:207], a[224:239]
    v_exp_f32_e64 v167, v167
    v_add_f32 v22, v22, v166
    s_mul_i32 s6, s53, 21
    s_add_u32 s6, s6, 1
    s_waitcnt lgkmcnt(2)
    v_mfma_f32_32x32x16_bf16 a[176:191], v[220:223], v[196:199], a[176:191]
    ds_read_b128 v[216:219], v16 offset:0
    v_exp_f32 v176, v176
    v_add_f32 v22, v22, v167
    v_cvt_pk_bf16_f32 v195, v166, v167
    s_lshr_b32 s6, s6, 1
    v_mfma_f32_32x32x16_bf16 a[240:255], v[220:223], v[204:207], a[240:255]
    v_exp_f32 v177, v177
    v_add_f32_e64 v23, v23, v176
    v_and_b32 v32, 15, v1
    s_waitcnt lgkmcnt(2)
    v_mfma_f32_32x32x16_bf16 v[128:143], v[208:211], v[64:67], 0
    ds_read_b128 v[220:223], v17 offset:0
    v_exp_f32 v178, v178
    v_add_f32 v23, v23, v177
    v_cvt_pk_bf16_f32 v200, v176, v177
    v_min_u32_e64 v32, 10, v32
    v_mfma_f32_32x32x16_bf16 v[144:159], v[208:211], v[96:99], 0
    v_exp_f32 v179, v179
    v_add_f32 v23, v23, v178
    v_add_u32 v32, s6, v32
    s_waitcnt lgkmcnt(2)
    v_mfma_f32_32x32x16_bf16 v[128:143], v[212:215], v[68:71], v[128:143]
    ds_read_b128 v[208:211], v18 offset:0
    v_exp_f32 v180, v180
    v_add_f32 v23, v23, v179
    v_cvt_pk_bf16_f32 v201, v178, v179
    v_cmp_gt_u32_e64 vcc, 16, v1
    v_mfma_f32_32x32x16_bf16 v[144:159], v[212:215], v[100:103], v[144:159]
    v_exp_f32 v181, v181
    v_add_f32 v23, v23, v180
    s_lshl_b32 s7, s7, 5
    s_waitcnt lgkmcnt(2)
    v_mfma_f32_32x32x16_bf16 v[128:143], v[216:219], v[72:75], v[128:143]
    ds_read_b128 v[212:215], v19 offset:0
    v_exp_f32 v182, v182
    v_add_f32 v23, v23, v181
    v_cvt_pk_bf16_f32 v202, v180, v181
    v_lshl_add_u32 v36, v36, 5, v32
    v_mfma_f32_32x32x16_bf16 v[144:159], v[216:219], v[104:107], v[144:159]
    v_exp_f32 v183, v183
    v_add_f32 v23, v23, v182
    v_lshlrev_b32 v36, 7, v36
    s_waitcnt lgkmcnt(2)
    v_mfma_f32_32x32x16_bf16 v[128:143], v[220:223], v[76:79], v[128:143]
    ds_read_b128 v[216:219], v20 offset:0
    v_exp_f32 v168, v168
    v_add_f32 v23, v23, v183
    v_cvt_pk_bf16_f32 v203, v182, v183
    v_add_lshl_u32 v35, v32, s7, 7
    v_cndmask_b32_e64 v35, v37, v35, vcc
    v_mfma_f32_32x32x16_bf16 v[144:159], v[220:223], v[108:111], v[144:159]
    buffer_store_dwordx4 v[40:43], v54, s[44:47], s4 offen offset:2048 sc1
    v_exp_f32 v169, v169
    v_add_f32 v22, v22, v168
    v_and_b32 v9, 15, v1
    s_waitcnt lgkmcnt(2)
    v_mfma_f32_32x32x16_bf16 v[128:143], v[208:211], v[80:83], v[128:143]
    ds_read_b128 v[220:223], v21 offset:0
    v_exp_f32 v170, v170
    v_add_f32 v22, v22, v169
    v_cvt_pk_bf16_f32 v196, v168, v169
    v_mul_u32_u24 v9, 1280, v9
    v_mfma_f32_32x32x16_bf16 v[144:159], v[208:211], v[112:115], v[144:159]
    v_exp_f32 v171, v171
    v_add_f32 v22, v22, v170
    v_lshrrev_b32 v8, 4, v1
    s_waitcnt lgkmcnt(2)
    v_mfma_f32_32x32x16_bf16 v[128:143], v[212:215], v[84:87], v[128:143]
    ds_read_b64_tr_b16 v[208:209], v10 offset:8192
    v_exp_f32 v172, v172
    v_add_f32 v22, v22, v171
    v_cvt_pk_bf16_f32 v197, v170, v171
    v_lshl_add_u32 v8, v8, 3, v9
    v_mfma_f32_32x32x16_bf16 v[144:159], v[212:215], v[116:119], v[144:159]
    ds_read_b64_tr_b16 v[210:211], v10 offset:10240
    v_exp_f32 v173, v173
    v_add_f32 v22, v22, v172
    s_mov_b32 s20, s64
    s_waitcnt lgkmcnt(3)
    v_mfma_f32_32x32x16_bf16 v[128:143], v[216:219], v[88:91], v[128:143]
    ds_read_b64_tr_b16 v[212:213], v11 offset:8192
    v_exp_f32 v174, v174
    v_add_f32 v22, v22, v173
    v_cvt_pk_bf16_f32 v198, v172, v173
    s_and_b32 s21, s65, 0xffff
    v_mfma_f32_32x32x16_bf16 v[144:159], v[216:219], v[120:123], v[144:159]
    ds_read_b64_tr_b16 v[214:215], v11 offset:10240
    v_exp_f32_e64 v175, v175
    v_add_f32 v22, v22, v174
    s_mov_b32 s22, 2621440
    s_waitcnt lgkmcnt(4)
    v_mfma_f32_32x32x16_bf16 v[128:143], v[220:223], v[92:95], v[128:143]
    ds_read_b64_tr_b16 v[216:217], v12 offset:8192
    v_exp_f32 v184, v184
    v_add_f32 v22, v22, v175
    v_cvt_pk_bf16_f32 v199, v174, v175
    s_mov_b32 s23, 0x20000
    v_mfma_f32_32x32x16_bf16 v[144:159], v[220:223], v[124:127], v[144:159]
    ds_read_b64_tr_b16 v[218:219], v12 offset:10240
    s_lshl_b32 s6, s53, 3
    s_lshr_b32 s78, 0x402b1600, s6
    s_and_b32 s78, s78, 0xff
    v_exp_f32 v185, v185
    v_add_f32 v23, v23, v184
    s_waitcnt lgkmcnt(4)
    v_mfma_f32_32x32x16_bf16 a[128:143], v[208:211], v[192:195], a[128:143]
    ds_read_b64_tr_b16 v[220:221], v13 offset:8192
    s_lshr_b32 s79, 0x5b402b16, s6
    s_and_b32 s79, s79, 0xff
    v_exp_f32 v186, v186
    v_add_f32 v23, v23, v185
    v_cvt_pk_bf16_f32 v204, v184, v185
    v_mfma_f32_32x32x16_bf16 a[192:207], v[208:211], v[200:203], a[192:207]
    ds_read_b64_tr_b16 v[222:223], v13 offset:10240
    s_and_b32 s63, s48, 1
    s_lshl_b32 s6, s63, 11
    s_lshl_b32 s51, s78, 13
    v_exp_f32 v187, v187
    v_add_f32 v23, v23, v186
    s_waitcnt lgkmcnt(4)
    v_mfma_f32_32x32x16_bf16 a[144:159], v[212:215], v[192:195], a[144:159]
    ds_read_b64_tr_b16 v[208:209], v10 offset:12288
    s_add_u32 s51, s51, s6
    s_lshr_b32 s7, s48, 1
    s_lshl_b32 s6, s77, 1
    v_exp_f32 v188, v188
    v_add_f32_e64 v23, v23, v187
    v_cvt_pk_bf16_f32 v205, v186, v187
    v_mfma_f32_32x32x16_bf16 a[208:223], v[212:215], v[200:203], a[208:223]
    ds_read_b64_tr_b16 v[210:211], v10 offset:14336
    buffer_store_dwordx4 v[40:43], v54, s[44:47], s4 offen offset:1024 sc1
    v_exp_f32 v189, v189
    v_add_f32 v23, v23, v188
    s_waitcnt lgkmcnt(4)
    v_mfma_f32_32x32x16_bf16 a[160:175], v[216:219], v[192:195], a[160:175]
    ds_read_b64_tr_b16 v[212:213], v11 offset:12288
    s_add_u32 s6, s6, s7
    s_mul_i32 s6, s6, 5120
    s_mul_i32 s60, s78, 81920
    v_exp_f32 v190, v190
    v_add_f32 v23, v23, v189
    v_cvt_pk_bf16_f32 v206, v188, v189
    v_add_u32 v10, 0x8000, v10
    v_mfma_f32_32x32x16_bf16 a[224:239], v[216:219], v[200:203], a[224:239]
    ds_read_b64_tr_b16 v[214:215], v11 offset:14336
    s_add_u32 s60, s60, s6
    s_mul_i32 s6, s63, 40960
    s_add_u32 s60, s60, s6
    v_exp_f32_e64 v191, v191
    v_add_f32 v23, v23, v190
    s_waitcnt lgkmcnt(4)
    v_mfma_f32_32x32x16_bf16 a[176:191], v[220:223], v[192:195], a[176:191]
    ds_read_b64_tr_b16 v[216:217], v12 offset:12288
    s_lshl_b32 s74, s79, 13
    s_mul_i32 s75, s79, 81920
    s_mov_b32 s55, s51
    v_exp_f32 v128, v128
    v_add_f32 v23, v23, v191
    v_cvt_pk_bf16_f32 v207, v190, v191
    v_add_u32 v11, 0x8000, v11
    v_mfma_f32_32x32x16_bf16 a[240:255], v[220:223], v[200:203], a[240:255]
    ds_read_b64_tr_b16 v[218:219], v12 offset:14336
    s_mov_b32 s56, s60
    s_mul_i32 s57, s63, 10240
    s_mul_i32 s6, s7, 5120
    v_exp_f32 v129, v129
    v_add_f32 v22, v22, v128
    s_waitcnt lgkmcnt(4)
    v_mfma_f32_32x32x16_bf16 a[128:143], v[208:211], v[196:199], a[128:143]
    ds_read_b64_tr_b16 v[220:221], v13 offset:12288
    s_add_u32 s57, s57, s6
    s_lshl_b32 s6, s76, 1
    s_add_u32 s6, s6, s7
    v_exp_f32 v130, v130
    v_add_f32_e64 v22, v22, v129
    v_cvt_pk_bf16_f32 v192, v128, v129
    v_add_u32 v12, 0x8000, v12
    v_mfma_f32_32x32x16_bf16 a[192:207], v[208:211], v[204:207], a[192:207]
    ds_read_b64_tr_b16 v[222:223], v13 offset:14336
    s_mul_i32 s6, s6, 745472
    s_add_u32 s8, s86, s6
    s_addc_u32 s9, s87, 0
    v_exp_f32_e64 v131, v131
    v_add_f32 v22, v22, v130
    s_waitcnt lgkmcnt(4)
    v_mfma_f32_32x32x16_bf16 a[144:159], v[212:215], v[196:199], a[144:159]
    ds_read_b128 v[208:211], v14 offset:8192
    s_and_b32 s9, s9, 0xffff
    s_cmp_eq_u32 s53, 3
    s_cselect_b32 s10, s74, 0
    s_cselect_b32 s14, s75, 0
    s_mov_b32 s11, 0x20000
    v_exp_f32 v132, v132
    v_add_f32_e64 v22, v22, v131
    v_cvt_pk_bf16_f32 v193, v130, v131
    v_add_u32 v13, 0x8000, v13
    v_mfma_f32_32x32x16_bf16 a[208:223], v[212:215], v[204:207], a[208:223]
    s_mov_b32 s12, s36
    s_mov_b32 s13, s37
    s_mov_b32 s15, 0x20000
    v_exp_f32_e64 v133, v133
    v_add_f32 v22, v22, v132
    s_waitcnt lgkmcnt(3)
    v_mfma_f32_32x32x16_bf16 a[160:175], v[216:219], v[196:199], a[160:175]
    ds_read_b128 v[212:215], v15 offset:8192
    s_lshl2_add_u32 s6, s76, s53
    s_lshl_b32 s6, s6, 1
    s_add_u32 s6, s6, s7
    s_mul_i32 s94, s6, 20480
    v_exp_f32 v134, v134
    v_add_f32_e64 v22, v22, v133
    v_cvt_pk_bf16_f32 v194, v132, v133
    v_mfma_f32_32x32x16_bf16 a[224:239], v[216:219], v[204:207], a[224:239]
    s_lshl_b32 s6, s77, 1
    s_add_u32 s6, s6, s63
    s_mul_i32 s6, s6, 160
    s_add_u32 s94, s94, s6
    v_exp_f32 v135, v135
    v_add_f32 v22, v22, v134
    s_waitcnt lgkmcnt(2)
    v_mfma_f32_32x32x16_bf16 a[176:191], v[220:223], v[196:199], a[176:191]
    ds_read_b128 v[216:219], v16 offset:8192
    s_xor_b32 s78, s48, s53
    s_mul_i32 s79, s48, 3
    s_add_u32 s79, s79, s78
    s_sub_u32 s79, s79, 1
    v_exp_f32 v144, v144
    v_add_f32 v22, v22, v135
    v_cvt_pk_bf16_f32 v195, v134, v135
    v_mfma_f32_32x32x16_bf16 a[240:255], v[220:223], v[204:207], a[240:255]
    s_mul_i32 s79, s79, 10240
    s_cmp_eq_u32 s78, 0
    s_cselect_b32 s93, 0x100000, s79
    v_exp_f32 v145, v145
    v_add_f32 v23, v23, v144
    s_waitcnt lgkmcnt(2)
    v_mfma_f32_32x32x16_bf16 v[160:175], v[208:211], v[64:67], 0
    ds_read_b128 v[220:223], v17 offset:8192
    v_exp_f32 v146, v146
    v_add_f32 v23, v23, v145
    v_cvt_pk_bf16_f32 v200, v144, v145
    v_add_u32 v14, 0x8000, v14
    v_mfma_f32_32x32x16_bf16 v[176:191], v[208:211], v[96:99], 0
    global_load_dwordx2 v[30:31], v34, s[84:85] sc1
    v_exp_f32_e64 v147, v147
    v_add_f32 v23, v23, v146
    v_add_u32 v17, 0x8000, v17
    s_waitcnt lgkmcnt(2)
    v_mfma_f32_32x32x16_bf16 v[160:175], v[212:215], v[68:71], v[160:175]
    ds_read_b128 v[208:211], v18 offset:8192
    v_exp_f32 v148, v148
    v_add_f32 v23, v23, v147
    v_cvt_pk_bf16_f32 v201, v146, v147
    v_add_u32 v15, 0x8000, v15
    v_mfma_f32_32x32x16_bf16 v[176:191], v[212:215], v[100:103], v[176:191]
    buffer_store_dwordx4 v[40:43], v54, s[44:47], s4 offen offset:3072 sc1
    v_exp_f32_e64 v149, v149
    v_add_f32 v23, v23, v148
    v_add_u32 v18, 0x8000, v18
    s_waitcnt lgkmcnt(2)
    v_mfma_f32_32x32x16_bf16 v[160:175], v[216:219], v[72:75], v[160:175]
    ds_read_b128 v[212:215], v19 offset:8192
    v_exp_f32 v150, v150
    v_add_f32 v23, v23, v149
    v_cvt_pk_bf16_f32 v202, v148, v149
    v_add_u32 v16, 0x8000, v16
    v_mfma_f32_32x32x16_bf16 v[176:191], v[216:219], v[104:107], v[176:191]
    buffer_load_dwordx2 a[96:97], v8, s[20:23], s94 offen offset:0
    v_exp_f32_e64 v151, v151
    v_add_f32 v23, v23, v150
    v_add_u32 v19, 0x8000, v19
    s_waitcnt lgkmcnt(2)
    v_mfma_f32_32x32x16_bf16 v[160:175], v[220:223], v[76:79], v[160:175]
    ds_read_b128 v[216:219], v20 offset:8192
    v_exp_f32 v136, v136
    v_add_f32 v23, v23, v151
    v_cvt_pk_bf16_f32 v203, v150, v151
    v_mfma_f32_32x32x16_bf16 v[176:191], v[220:223], v[108:111], v[176:191]
    buffer_load_dwordx2 a[98:99], v8, s[20:23], s94 offen offset:32
    v_exp_f32_e64 v137, v137
    v_add_f32 v22, v22, v136
    v_add_u32 v20, 0x8000, v20
    s_waitcnt lgkmcnt(2)
    v_mfma_f32_32x32x16_bf16 v[160:175], v[208:211], v[80:83], v[160:175]
    ds_read_b128 v[220:223], v21 offset:8192
    v_exp_f32 v138, v138
    v_add_f32 v22, v22, v137
    v_cvt_pk_bf16_f32 v196, v136, v137
    v_mfma_f32_32x32x16_bf16 v[176:191], v[208:211], v[112:115], v[176:191]
    buffer_load_dwordx2 a[100:101], v8, s[20:23], s94 offen offset:64
    v_exp_f32_e64 v139, v139
    v_add_f32 v22, v22, v138
    v_add_u32 v21, 0x8000, v21
    s_waitcnt lgkmcnt(2)
    v_mfma_f32_32x32x16_bf16 v[160:175], v[212:215], v[84:87], v[160:175]
    ds_read_b64_tr_b16 v[208:209], v10 offset:0
    v_exp_f32 v140, v140
    v_add_f32 v22, v22, v139
    v_cvt_pk_bf16_f32 v197, v138, v139
    v_mfma_f32_32x32x16_bf16 v[176:191], v[212:215], v[116:119], v[176:191]
    ds_read_b64_tr_b16 v[210:211], v10 offset:2048
    v_exp_f32_e64 v141, v141
    v_add_f32 v22, v22, v140
    s_waitcnt lgkmcnt(3)
    v_mfma_f32_32x32x16_bf16 v[160:175], v[216:219], v[88:91], v[160:175]
    ds_read_b64_tr_b16 v[212:213], v11 offset:0
    v_exp_f32 v142, v142
    v_add_f32 v22, v22, v141
    v_cvt_pk_bf16_f32 v198, v140, v141
    v_mfma_f32_32x32x16_bf16 v[176:191], v[216:219], v[120:123], v[176:191]
    ds_read_b64_tr_b16 v[214:215], v11 offset:2048
    buffer_load_dwordx2 a[102:103], v8, s[20:23], s94 offen offset:96
    v_exp_f32_e64 v143, v143
    v_add_f32 v22, v22, v142
    s_waitcnt lgkmcnt(4)
    v_mfma_f32_32x32x16_bf16 v[160:175], v[220:223], v[92:95], v[160:175]
    ds_read_b64_tr_b16 v[216:217], v12 offset:0
    v_exp_f32 v152, v152
    v_add_f32 v22, v22, v143
    v_cvt_pk_bf16_f32 v199, v142, v143
    v_mfma_f32_32x32x16_bf16 v[176:191], v[220:223], v[124:127], v[176:191]
    ds_read_b64_tr_b16 v[218:219], v12 offset:2048
    v_exp_f32_e64 v153, v153
    v_add_f32 v23, v23, v152
    s_waitcnt lgkmcnt(4)
    v_mfma_f32_32x32x16_bf16 a[128:143], v[208:211], v[192:195], a[128:143]
    ds_read_b64_tr_b16 v[220:221], v13 offset:0
    v_exp_f32 v154, v154
    v_add_f32 v23, v23, v153
    v_cvt_pk_bf16_f32 v204, v152, v153
    v_mfma_f32_32x32x16_bf16 a[192:207], v[208:211], v[200:203], a[192:207]
    ds_read_b64_tr_b16 v[222:223], v13 offset:2048
    v_exp_f32_e64 v155, v155
    v_add_f32 v23, v23, v154
    s_waitcnt lgkmcnt(4)
    v_mfma_f32_32x32x16_bf16 a[144:159], v[212:215], v[192:195], a[144:159]
    ds_read_b64_tr_b16 v[208:209], v10 offset:4096
    v_exp_f32 v156, v156
    v_add_f32 v23, v23, v155
    v_cvt_pk_bf16_f32 v205, v154, v155
    v_mfma_f32_32x32x16_bf16 a[208:223], v[212:215], v[200:203], a[208:223]
    ds_read_b64_tr_b16 v[210:211], v10 offset:6144
    buffer_store_dwordx4 v[40:43], v55, s[44:47], s4 offen offset:0 sc1
    v_exp_f32_e64 v157, v157
    v_add_f32 v23, v23, v156
    s_waitcnt lgkmcnt(4)
    v_mfma_f32_32x32x16_bf16 a[160:175], v[216:219], v[192:195], a[160:175]
    ds_read_b64_tr_b16 v[212:213], v11 offset:4096
    v_exp_f32 v158, v158
    v_add_f32 v23, v23, v157
    v_cvt_pk_bf16_f32 v206, v156, v157
    v_mfma_f32_32x32x16_bf16 a[224:239], v[216:219], v[200:203], a[224:239]
    ds_read_b64_tr_b16 v[214:215], v11 offset:6144
    v_exp_f32_e64 v159, v159
    v_add_f32 v23, v23, v158
    s_waitcnt lgkmcnt(4)
    v_mfma_f32_32x32x16_bf16 a[176:191], v[220:223], v[192:195], a[176:191]
    ds_read_b64_tr_b16 v[216:217], v12 offset:4096
    v_exp_f32 v160, v160
    v_add_f32 v23, v23, v159
    v_cvt_pk_bf16_f32 v207, v158, v159
    v_mfma_f32_32x32x16_bf16 a[240:255], v[220:223], v[200:203], a[240:255]
    ds_read_b64_tr_b16 v[218:219], v12 offset:6144
    buffer_load_dwordx2 a[104:105], v8, s[20:23], s94 offen offset:128
    v_exp_f32_e64 v161, v161
    v_add_f32 v22, v22, v160
    s_waitcnt lgkmcnt(4)
    v_mfma_f32_32x32x16_bf16 a[128:143], v[208:211], v[196:199], a[128:143]
    ds_read_b64_tr_b16 v[220:221], v13 offset:4096
    v_exp_f32 v162, v162
    v_add_f32 v22, v22, v161
    v_cvt_pk_bf16_f32 v192, v160, v161
    v_mfma_f32_32x32x16_bf16 a[192:207], v[208:211], v[204:207], a[192:207]
    ds_read_b64_tr_b16 v[222:223], v13 offset:6144
    v_exp_f32_e64 v163, v163
    v_add_f32 v22, v22, v162
    s_waitcnt lgkmcnt(4)
    v_mfma_f32_32x32x16_bf16 a[144:159], v[212:215], v[196:199], a[144:159]
    s_waitcnt vmcnt(7)
    s_cmp_lg_u32 s53, 3
    s_cbranch_scc1 p1_w1r
    s_add_u32 s61, s100, 1
    s_mov_b32 s62, 0
p1_w1c:
    v_subrev_u32 v30, s61, v30
    v_cmp_ne_u32 s[96:97], s101, v31
    v_cmp_lt_u32_e64 vcc, 2, v30
    s_nop 3
    s_or_b64 s[96:97], s[96:97], vcc
    s_cbranch_scc0 p1_w1r
    s_add_u32 s62, s62, 1
    s_cmp_ge_u32 s62, 0x40000
    s_cbranch_scc1 p1_w1r
    global_load_dwordx2 v[30:31], v34, s[84:85] sc1
    s_waitcnt vmcnt(0)
    s_branch p1_w1c
p1_w1r:
    s_barrier
    ds_read_b128 v[208:211], v14 offset:0
    v_exp_f32 v164, v164
    v_add_f32 v22, v22, v163
    v_cvt_pk_bf16_f32 v193, v162, v163
    v_mfma_f32_32x32x16_bf16 a[208:223], v[212:215], v[204:207], a[208:223]
    v_exp_f32_e64 v165, v165
    v_add_f32 v22, v22, v164
    s_waitcnt lgkmcnt(3)
    v_mfma_f32_32x32x16_bf16 a[160:175], v[216:219], v[196:199], a[160:175]
    ds_read_b128 v[212:215], v15 offset:0
    v_exp_f32 v166, v166
    v_add_f32 v22, v22, v165
    v_cvt_pk_bf16_f32 v194, v164, v165
    v_mfma_f32_32x32x16_bf16 a[224:239], v[216:219], v[204:207], a[224:239]
    v_exp_f32_e64 v167, v167
    v_add_f32 v22, v22, v166
    s_waitcnt lgkmcnt(2)
    v_mfma_f32_32x32x16_bf16 a[176:191], v[220:223], v[196:199], a[176:191]
    ds_read_b128 v[216:219], v16 offset:0
    v_exp_f32 v176, v176
    v_add_f32 v22, v22, v167
    v_cvt_pk_bf16_f32 v195, v166, v167
    v_mfma_f32_32x32x16_bf16 a[240:255], v[220:223], v[204:207], a[240:255]
    s_add_u32 m0, s57, 0
    s_nop 0
    buffer_load_dwordx4 v54, s[12:15], s56 offen offset:0 sc1 lds
    v_exp_f32_e64 v177, v177
    v_add_f32 v23, v23, v176
    s_waitcnt lgkmcnt(2)
    v_mfma_f32_32x32x16_bf16 v[128:143], v[208:211], v[64:67], 0
    ds_read_b128 v[220:223], v17 offset:0
    v_exp_f32 v178, v178
    v_add_f32 v23, v23, v177
    v_cvt_pk_bf16_f32 v200, v176, v177
    v_mfma_f32_32x32x16_bf16 v[144:159], v[208:211], v[96:99], 0
    buffer_load_dwordx4 v54, s[12:15], s56 offen offset:1024 sc1 lds
    v_exp_f32_e64 v179, v179
    v_add_f32 v23, v23, v178
    s_waitcnt lgkmcnt(2)
    v_mfma_f32_32x32x16_bf16 v[128:143], v[212:215], v[68:71], v[128:143]
    ds_read_b128 v[208:211], v18 offset:0
    v_exp_f32 v180, v180
    v_add_f32 v23, v23, v179
    v_cvt_pk_bf16_f32 v201, v178, v179
    v_mfma_f32_32x32x16_bf16 v[144:159], v[212:215], v[100:103], v[144:159]
    buffer_load_dwordx4 v54, s[12:15], s56 offen offset:2048 sc1 lds
    v_exp_f32_e64 v181, v181
    v_add_f32 v23, v23, v180
    s_waitcnt lgkmcnt(2)
    v_mfma_f32_32x32x16_bf16 v[128:143], v[216:219], v[72:75], v[128:143]
    ds_read_b128 v[212:215], v19 offset:0
    v_exp_f32 v182, v182
    v_add_f32 v23, v23, v181
    v_cvt_pk_bf16_f32 v202, v180, v181
    v_mfma_f32_32x32x16_bf16 v[144:159], v[216:219], v[104:107], v[144:159]
    buffer_load_dwordx4 v54, s[12:15], s56 offen offset:3072 sc1 lds
    v_exp_f32_e64 v183, v183
    v_add_f32 v23, v23, v182
    s_waitcnt lgkmcnt(2)
    v_mfma_f32_32x32x16_bf16 v[128:143], v[220:223], v[76:79], v[128:143]
    ds_read_b128 v[216:219], v20 offset:0
    v_exp_f32 v168, v168
    v_add_f32 v23, v23, v183
    v_cvt_pk_bf16_f32 v203, v182, v183
    v_mfma_f32_32x32x16_bf16 v[144:159], v[220:223], v[108:111], v[144:159]
    s_add_u32 m0, s57, 4096
    v_exp_f32_e64 v169, v169
    v_add_f32 v22, v22, v168
    s_waitcnt lgkmcnt(2)
    v_mfma_f32_32x32x16_bf16 v[128:143], v[208:211], v[80:83], v[128:143]
    ds_read_b128 v[220:223], v21 offset:0
    v_exp_f32 v170, v170
    v_add_f32 v22, v22, v169
    v_cvt_pk_bf16_f32 v196, v168, v169
    v_mfma_f32_32x32x16_bf16 v[144:159], v[208:211], v[112:115], v[144:159]
    buffer_load_dwordx4 v55, s[12:15], s56 offen sc1 lds
    v_exp_f32_e64 v171, v171
    v_add_f32 v22, v22, v170
    s_waitcnt lgkmcnt(2)
    v_mfma_f32_32x32x16_bf16 v[128:143], v[212:215], v[84:87], v[128:143]
    ds_read_b64_tr_b16 v[208:209], v10 offset:8192
    v_exp_f32 v172, v172
    v_add_f32 v22, v22, v171
    v_cvt_pk_bf16_f32 v197, v170, v171
    v_mfma_f32_32x32x16_bf16 v[144:159], v[212:215], v[116:119], v[144:159]
    ds_read_b64_tr_b16 v[210:211], v10 offset:10240
    buffer_load_dwordx4 a[0:3], v54, s[8:11], s55 offen offset:0 sc1
    v_exp_f32_e64 v173, v173
    v_add_f32 v22, v22, v172
    s_waitcnt lgkmcnt(3)
    v_mfma_f32_32x32x16_bf16 v[128:143], v[216:219], v[88:91], v[128:143]
    ds_read_b64_tr_b16 v[212:213], v11 offset:8192
    v_exp_f32 v174, v174
    v_add_f32 v22, v22, v173
    v_cvt_pk_bf16_f32 v198, v172, v173
    v_mfma_f32_32x32x16_bf16 v[144:159], v[216:219], v[120:123], v[144:159]
    ds_read_b64_tr_b16 v[214:215], v11 offset:10240
    buffer_load_dwordx4 a[4:7], v54, s[8:11], s55 offen offset:1024 sc1
    v_exp_f32_e64 v175, v175
    v_add_f32 v22, v22, v174
    s_waitcnt lgkmcnt(4)
    v_mfma_f32_32x32x16_bf16 v[128:143], v[220:223], v[92:95], v[128:143]
    ds_read_b64_tr_b16 v[216:217], v12 offset:8192
    v_exp_f32 v184, v184
    v_add_f32 v22, v22, v175
    v_cvt_pk_bf16_f32 v199, v174, v175
    v_mfma_f32_32x32x16_bf16 v[144:159], v[220:223], v[124:127], v[144:159]
    ds_read_b64_tr_b16 v[218:219], v12 offset:10240
    buffer_load_dwordx4 a[8:11], v55, s[8:11], s55 offen offset:0 sc1
    buffer_load_dwordx4 a[12:15], v55, s[8:11], s55 offen offset:1024 sc1
    v_exp_f32_e64 v185, v185
    v_add_f32 v23, v23, v184
    s_waitcnt lgkmcnt(4)
    v_mfma_f32_32x32x16_bf16 a[128:143], v[208:211], v[192:195], a[128:143]
    ds_read_b64_tr_b16 v[220:221], v13 offset:8192
    v_exp_f32 v186, v186
    v_add_f32 v23, v23, v185
    v_cvt_pk_bf16_f32 v204, v184, v185
    v_mfma_f32_32x32x16_bf16 a[192:207], v[208:211], v[200:203], a[192:207]
    ds_read_b64_tr_b16 v[222:223], v13 offset:10240
    s_add_u32 s56, s56, 81920
    s_add_u32 s55, s55, 8192
    v_exp_f32_e64 v187, v187
    v_add_f32 v23, v23, v186
    s_waitcnt lgkmcnt(4)
    v_mfma_f32_32x32x16_bf16 a[144:159], v[212:215], v[192:195], a[144:159]
    ds_read_b64_tr_b16 v[208:209], v10 offset:12288
    v_exp_f32 v188, v188
    v_add_f32 v23, v23, v187
    v_cvt_pk_bf16_f32 v205, v186, v187
    v_mfma_f32_32x32x16_bf16 a[208:223], v[212:215], v[200:203], a[208:223]
    ds_read_b64_tr_b16 v[210:211], v10 offset:14336
    buffer_store_dwordx4 v[40:43], v55, s[44:47], s4 offen offset:1024 sc1
    v_exp_f32_e64 v189, v189
    v_add_f32 v23, v23, v188
    s_waitcnt lgkmcnt(4)
    v_mfma_f32_32x32x16_bf16 a[160:175], v[216:219], v[192:195], a[160:175]
    ds_read_b64_tr_b16 v[212:213], v11 offset:12288
    v_exp_f32 v190, v190
    v_add_f32 v23, v23, v189
    v_cvt_pk_bf16_f32 v206, v188, v189
    v_add_u32 v10, 0x8000, v10
    v_mfma_f32_32x32x16_bf16 a[224:239], v[216:219], v[200:203], a[224:239]
    ds_read_b64_tr_b16 v[214:215], v11 offset:14336
    s_add_u32 m0, s57, 20480
    v_exp_f32_e64 v191, v191
    v_add_f32 v23, v23, v190
    s_waitcnt lgkmcnt(4)
    v_mfma_f32_32x32x16_bf16 a[176:191], v[220:223], v[192:195], a[176:191]
    ds_read_b64_tr_b16 v[216:217], v12 offset:12288
    v_exp_f32 v128, v128
    v_add_f32 v23, v23, v191
    v_cvt_pk_bf16_f32 v207, v190, v191
    v_add_u32 v11, 0x8000, v11
    v_mfma_f32_32x32x16_bf16 a[240:255], v[220:223], v[200:203], a[240:255]
    ds_read_b64_tr_b16 v[218:219], v12 offset:14336
    buffer_load_dwordx4 v54, s[12:15], s56 offen offset:0 sc1 lds
    v_exp_f32_e64 v129, v129
    v_add_f32 v22, v22, v128
    s_waitcnt lgkmcnt(4)
    v_mfma_f32_32x32x16_bf16 a[128:143], v[208:211], v[196:199], a[128:143]
    ds_read_b64_tr_b16 v[220:221], v13 offset:12288
    v_exp_f32 v130, v130
    v_add_f32 v22, v22, v129
    v_cvt_pk_bf16_f32 v192, v128, v129
    v_add_u32 v12, 0x8000, v12
    v_mfma_f32_32x32x16_bf16 a[192:207], v[208:211], v[204:207], a[192:207]
    ds_read_b64_tr_b16 v[222:223], v13 offset:14336
    buffer_load_dwordx4 v54, s[12:15], s56 offen offset:1024 sc1 lds
    v_exp_f32_e64 v131, v131
    v_add_f32 v22, v22, v130
    s_waitcnt lgkmcnt(4)
    v_mfma_f32_32x32x16_bf16 a[144:159], v[212:215], v[196:199], a[144:159]
    ds_read_b128 v[208:211], v14 offset:8192
    v_exp_f32 v132, v132
    v_add_f32 v22, v22, v131
    v_cvt_pk_bf16_f32 v193, v130, v131
    v_add_u32 v13, 0x8000, v13
    v_mfma_f32_32x32x16_bf16 a[208:223], v[212:215], v[204:207], a[208:223]
    buffer_load_dwordx4 v54, s[12:15], s56 offen offset:2048 sc1 lds
    v_exp_f32_e64 v133, v133
    v_add_f32 v22, v22, v132
    s_waitcnt lgkmcnt(3)
    v_mfma_f32_32x32x16_bf16 a[160:175], v[216:219], v[196:199], a[160:175]
    ds_read_b128 v[212:215], v15 offset:8192
    v_exp_f32 v134, v134
    v_add_f32 v22, v22, v133
    v_cvt_pk_bf16_f32 v194, v132, v133
    v_mfma_f32_32x32x16_bf16 a[224:239], v[216:219], v[204:207], a[224:239]
    buffer_load_dwordx4 v54, s[12:15], s56 offen offset:3072 sc1 lds
    v_exp_f32_e64 v135, v135
    v_add_f32 v22, v22, v134
    s_waitcnt lgkmcnt(2)
    v_mfma_f32_32x32x16_bf16 a[176:191], v[220:223], v[196:199], a[176:191]
    ds_read_b128 v[216:219], v16 offset:8192
    v_exp_f32 v144, v144
    v_add_f32 v22, v22, v135
    v_cvt_pk_bf16_f32 v195, v134, v135
    v_mfma_f32_32x32x16_bf16 a[240:255], v[220:223], v[204:207], a[240:255]
    s_add_u32 m0, s57, 24576
    v_exp_f32_e64 v145, v145
    v_add_f32 v23, v23, v144
    s_waitcnt lgkmcnt(2)
    v_mfma_f32_32x32x16_bf16 v[160:175], v[208:211], v[64:67], 0
    ds_read_b128 v[220:223], v17 offset:8192
    v_exp_f32 v146, v146
    v_add_f32 v23, v23, v145
    v_cvt_pk_bf16_f32 v200, v144, v145
    v_mfma_f32_32x32x16_bf16 v[176:191], v[208:211], v[96:99], 0
    buffer_load_dwordx4 v55, s[12:15], s56 offen sc1 lds
    v_exp_f32_e64 v147, v147
    v_add_f32 v23, v23, v146
    s_waitcnt lgkmcnt(2)
    v_mfma_f32_32x32x16_bf16 v[160:175], v[212:215], v[68:71], v[160:175]
    ds_read_b128 v[208:211], v18 offset:8192
    v_exp_f32 v148, v148
    v_add_f32 v23, v23, v147
    v_cvt_pk_bf16_f32 v201, v146, v147
    v_mfma_f32_32x32x16_bf16 v[176:191], v[212:215], v[100:103], v[176:191]
    buffer_store_dwordx4 v[40:43], v55, s[44:47], s4 offen offset:2048 sc1
    v_exp_f32_e64 v149, v149
    v_add_f32 v23, v23, v148
    s_waitcnt lgkmcnt(2)
    v_mfma_f32_32x32x16_bf16 v[160:175], v[216:219], v[72:75], v[160:175]
    ds_read_b128 v[212:215], v19 offset:8192
    v_exp_f32 v150, v150
    v_add_f32 v23, v23, v149
    v_cvt_pk_bf16_f32 v202, v148, v149
    v_mfma_f32_32x32x16_bf16 v[176:191], v[216:219], v[104:107], v[176:191]
    buffer_load_dwordx4 a[16:19], v54, s[8:11], s55 offen offset:0 sc1
    v_exp_f32_e64 v151, v151
    v_add_f32 v23, v23, v150
    s_waitcnt lgkmcnt(2)
    v_mfma_f32_32x32x16_bf16 v[160:175], v[220:223], v[76:79], v[160:175]
    ds_read_b128 v[216:219], v20 offset:8192
    v_exp_f32 v136, v136
    v_add_f32 v23, v23, v151
    v_cvt_pk_bf16_f32 v203, v150, v151
    v_mfma_f32_32x32x16_bf16 v[176:191], v[220:223], v[108:111], v[176:191]
    buffer_load_dwordx4 a[20:23], v54, s[8:11], s55 offen offset:1024 sc1
    v_exp_f32_e64 v137, v137
    v_add_f32 v22, v22, v136
    s_waitcnt lgkmcnt(2)
    v_mfma_f32_32x32x16_bf16 v[160:175], v[208:211], v[80:83], v[160:175]
    ds_read_b128 v[220:223], v21 offset:8192
    v_exp_f32 v138, v138
    v_add_f32 v22, v22, v137
    v_cvt_pk_bf16_f32 v196, v136, v137
    v_mfma_f32_32x32x16_bf16 v[176:191], v[208:211], v[112:115], v[176:191]
    buffer_load_dwordx4 a[24:27], v55, s[8:11], s55 offen offset:0 sc1
    v_exp_f32_e64 v139, v139
    v_add_f32 v22, v22, v138
    s_waitcnt lgkmcnt(2)
    v_mfma_f32_32x32x16_bf16 v[160:175], v[212:215], v[84:87], v[160:175]
    ds_read_b64_tr_b16 v[208:209], v10 offset:0
    v_exp_f32 v140, v140
    v_add_f32 v22, v22, v139
    v_cvt_pk_bf16_f32 v197, v138, v139
    v_mfma_f32_32x32x16_bf16 v[176:191], v[212:215], v[116:119], v[176:191]
    ds_read_b64_tr_b16 v[210:211], v10 offset:2048
    buffer_load_dwordx4 a[28:31], v55, s[8:11], s55 offen offset:1024 sc1
    v_exp_f32_e64 v141, v141
    v_add_f32 v22, v22, v140
    s_waitcnt lgkmcnt(3)
    v_mfma_f32_32x32x16_bf16 v[160:175], v[216:219], v[88:91], v[160:175]
    ds_read_b64_tr_b16 v[212:213], v11 offset:0
    v_exp_f32 v142, v142
    v_add_f32 v22, v22, v141
    v_cvt_pk_bf16_f32 v198, v140, v141
    v_mfma_f32_32x32x16_bf16 v[176:191], v[216:219], v[120:123], v[176:191]
    ds_read_b64_tr_b16 v[214:215], v11 offset:2048
    s_add_u32 s56, s56, 81920
    s_add_u32 s55, s55, 8192
    v_exp_f32_e64 v143, v143
    v_add_f32 v22, v22, v142
    s_waitcnt lgkmcnt(4)
    v_mfma_f32_32x32x16_bf16 v[160:175], v[220:223], v[92:95], v[160:175]
    ds_read_b64_tr_b16 v[216:217], v12 offset:0
    v_exp_f32 v152, v152
    v_add_f32 v22, v22, v143
    v_cvt_pk_bf16_f32 v199, v142, v143
    v_mfma_f32_32x32x16_bf16 v[176:191], v[220:223], v[124:127], v[176:191]
    ds_read_b64_tr_b16 v[218:219], v12 offset:2048
    s_add_u32 m0, s57, 40960
    v_exp_f32_e64 v153, v153
    v_add_f32 v23, v23, v152
    s_waitcnt lgkmcnt(4)
    v_mfma_f32_32x32x16_bf16 a[128:143], v[208:211], v[192:195], a[128:143]
    ds_read_b64_tr_b16 v[220:221], v13 offset:0
    v_exp_f32 v154, v154
    v_add_f32 v23, v23, v153
    v_cvt_pk_bf16_f32 v204, v152, v153
    v_mfma_f32_32x32x16_bf16 a[192:207], v[208:211], v[200:203], a[192:207]
    ds_read_b64_tr_b16 v[222:223], v13 offset:2048
    buffer_load_dwordx4 v54, s[12:15], s56 offen offset:0 sc1 lds
    v_exp_f32_e64 v155, v155
    v_add_f32 v23, v23, v154
    s_waitcnt lgkmcnt(4)
    v_mfma_f32_32x32x16_bf16 a[144:159], v[212:215], v[192:195], a[144:159]
    ds_read_b64_tr_b16 v[208:209], v10 offset:4096
    v_exp_f32 v156, v156
    v_add_f32 v23, v23, v155
    v_cvt_pk_bf16_f32 v205, v154, v155
    v_mfma_f32_32x32x16_bf16 a[208:223], v[212:215], v[200:203], a[208:223]
    ds_read_b64_tr_b16 v[210:211], v10 offset:6144
    buffer_store_dwordx4 v[40:43], v55, s[44:47], s4 offen offset:3072 sc1
    v_exp_f32_e64 v157, v157
    v_add_f32 v23, v23, v156
    s_waitcnt lgkmcnt(4)
    v_mfma_f32_32x32x16_bf16 a[160:175], v[216:219], v[192:195], a[160:175]
    ds_read_b64_tr_b16 v[212:213], v11 offset:4096
    v_exp_f32 v158, v158
    v_add_f32 v23, v23, v157
    v_cvt_pk_bf16_f32 v206, v156, v157
    v_mfma_f32_32x32x16_bf16 a[224:239], v[216:219], v[200:203], a[224:239]
    ds_read_b64_tr_b16 v[214:215], v11 offset:6144
    buffer_load_dwordx4 v54, s[12:15], s56 offen offset:1024 sc1 lds
    v_exp_f32_e64 v159, v159
    v_add_f32 v23, v23, v158
    s_waitcnt lgkmcnt(4)
    v_mfma_f32_32x32x16_bf16 a[176:191], v[220:223], v[192:195], a[176:191]
    ds_read_b64_tr_b16 v[216:217], v12 offset:4096
    v_exp_f32 v160, v160
    v_add_f32 v23, v23, v159
    v_cvt_pk_bf16_f32 v207, v158, v159
    v_mfma_f32_32x32x16_bf16 a[240:255], v[220:223], v[200:203], a[240:255]
    ds_read_b64_tr_b16 v[218:219], v12 offset:6144
    buffer_load_dwordx4 v54, s[12:15], s56 offen offset:2048 sc1 lds
    v_exp_f32_e64 v161, v161
    v_add_f32 v22, v22, v160
    s_waitcnt lgkmcnt(4)
    v_mfma_f32_32x32x16_bf16 a[128:143], v[208:211], v[196:199], a[128:143]
    ds_read_b64_tr_b16 v[220:221], v13 offset:4096
    v_exp_f32 v162, v162
    v_add_f32 v22, v22, v161
    v_cvt_pk_bf16_f32 v192, v160, v161
    v_add_u32_e64 v28, 1, v28
    v_mfma_f32_32x32x16_bf16 a[192:207], v[208:211], v[204:207], a[192:207]
    ds_read_b64_tr_b16 v[222:223], v13 offset:6144
    buffer_load_dwordx4 v54, s[12:15], s56 offen offset:3072 sc1 lds
    v_exp_f32_e64 v163, v163
    v_add_f32 v22, v22, v162
    s_waitcnt lgkmcnt(4)
    v_mfma_f32_32x32x16_bf16 a[144:159], v[212:215], v[196:199], a[144:159]
    s_waitcnt vmcnt(30)
    s_barrier
    v_exp_f32 v164, v164
    v_add_f32 v22, v22, v163
    v_cvt_pk_bf16_f32 v193, v162, v163
    v_mfma_f32_32x32x16_bf16 a[208:223], v[212:215], v[204:207], a[208:223]
    s_add_u32 m0, s57, 45056
    v_exp_f32_e64 v165, v165
    v_add_f32 v22, v22, v164
    s_waitcnt lgkmcnt(2)
    v_mfma_f32_32x32x16_bf16 a[160:175], v[216:219], v[196:199], a[160:175]
    buffer_store_dwordx2 v[28:29], v25, s[16:19], s59 offen sc1
    v_exp_f32 v166, v166
    v_add_f32 v22, v22, v165
    v_cvt_pk_bf16_f32 v194, v164, v165
    v_mfma_f32_32x32x16_bf16 a[224:239], v[216:219], v[204:207], a[224:239]
    buffer_load_dwordx4 v55, s[12:15], s56 offen sc1 lds
    v_exp_f32_e64 v167, v167
    v_add_f32 v22, v22, v166
    s_waitcnt lgkmcnt(0)
    v_mfma_f32_32x32x16_bf16 a[176:191], v[220:223], v[196:199], a[176:191]
    v_exp_f32 v176, v176
    v_add_f32 v22, v22, v167
    v_cvt_pk_bf16_f32 v195, v166, v167
    v_mfma_f32_32x32x16_bf16 a[240:255], v[220:223], v[204:207], a[240:255]
    v_exp_f32 v177, v177
    v_add_f32 v23, v23, v176
    ds_read_b64_tr_b16 v[208:209], v10 offset:8192
    ds_read_b64_tr_b16 v[210:211], v10 offset:10240
    ds_read_b64_tr_b16 v[212:213], v10 offset:12288
    ds_read_b64_tr_b16 v[214:215], v10 offset:14336
    ds_read_b64_tr_b16 v[216:217], v11 offset:8192
    ds_read_b64_tr_b16 v[218:219], v11 offset:10240
    v_exp_f32 v178, v178
    v_add_f32 v23, v23, v177
    v_cvt_pk_bf16_f32 v200, v176, v177
    buffer_load_dwordx4 a[32:35], v54, s[8:11], s55 offen offset:0 sc1
    v_exp_f32 v179, v179
    v_add_f32 v23, v23, v178
    v_exp_f32 v180, v180
    v_add_f32 v23, v23, v179
    v_cvt_pk_bf16_f32 v201, v178, v179
    v_exp_f32 v181, v181
    v_add_f32 v23, v23, v180
    buffer_load_dwordx4 a[36:39], v54, s[8:11], s55 offen offset:1024 sc1
    v_exp_f32 v182, v182
    v_add_f32 v23, v23, v181
    v_cvt_pk_bf16_f32 v202, v180, v181
    v_exp_f32 v183, v183
    v_add_f32 v23, v23, v182
    v_exp_f32 v168, v168
    v_add_f32 v23, v23, v183
    v_cvt_pk_bf16_f32 v203, v182, v183
    buffer_load_dwordx4 a[40:43], v55, s[8:11], s55 offen offset:0 sc1
    v_exp_f32 v169, v169
    v_add_f32 v22, v22, v168
    v_exp_f32 v170, v170
    v_add_f32 v22, v22, v169
    v_cvt_pk_bf16_f32 v196, v168, v169
    v_exp_f32 v171, v171
    v_add_f32 v22, v22, v170
    buffer_load_dwordx4 a[44:47], v55, s[8:11], s55 offen offset:1024 sc1
    v_exp_f32 v172, v172
    v_add_f32 v22, v22, v171
    v_cvt_pk_bf16_f32 v197, v170, v171
    v_exp_f32 v173, v173
    v_add_f32 v22, v22, v172
    v_exp_f32 v174, v174
    v_add_f32 v22, v22, v173
    v_cvt_pk_bf16_f32 v198, v172, v173
    s_add_u32 s56, s56, 81920
    s_add_u32 s55, s55, 8192
    v_exp_f32 v175, v175
    v_add_f32 v22, v22, v174
    v_exp_f32 v184, v184
    v_add_f32 v22, v22, v175
    v_cvt_pk_bf16_f32 v199, v174, v175
    v_exp_f32 v185, v185
    v_add_f32 v23, v23, v184
    v_exp_f32 v186, v186
    v_add_f32 v23, v23, v185
    v_cvt_pk_bf16_f32 v204, v184, v185
    v_exp_f32 v187, v187
    v_add_f32 v23, v23, v186
    v_exp_f32 v188, v188
    v_add_f32 v23, v23, v187
    v_cvt_pk_bf16_f32 v205, v186, v187
    v_exp_f32 v189, v189
    v_add_f32 v23, v23, v188
    v_exp_f32 v190, v190
    v_add_f32 v23, v23, v189
    v_cvt_pk_bf16_f32 v206, v188, v189
    v_exp_f32 v191, v191
    v_add_f32 v23, v23, v190
    v_bfe_u32 v46, v1, 4, 1
    v_add_f32 v23, v23, v191
    v_cvt_pk_bf16_f32 v207, v190, v191
    s_waitcnt lgkmcnt(4)
    v_mfma_f32_32x32x16_bf16 a[128:143], v[208:211], v[192:195], a[128:143]
    ds_read_b64_tr_b16 v[220:221], v11 offset:12288
    v_mov_b32 v44, v22
    v_mov_b32 v45, v23
    v_lshrrev_b32 v47, 5, v1
    v_lshlrev_b32 v47, 8, v47
    v_mfma_f32_32x32x16_bf16 a[192:207], v[208:211], v[200:203], a[192:207]
    ds_read_b64_tr_b16 v[222:223], v11 offset:14336
    v_permlane32_swap_b32_e64 v44, v22
    v_permlane32_swap_b32 v45, v23
    v_lshl_add_u32 v47, v46, 10, v47
    s_waitcnt lgkmcnt(4)
    v_mfma_f32_32x32x16_bf16 a[128:143], v[212:215], v[196:199], a[128:143]
    ds_read_b64_tr_b16 v[208:209], v12 offset:8192
    v_add_f32 v22, v22, v44
    v_add_f32 v23, v23, v45
    v_mov_b32 v52, 0x2b800000
    v_mov_b32 v53, 0x53800000
    v_mfma_f32_32x32x16_bf16 a[192:207], v[212:215], v[204:207], a[192:207]
    ds_read_b64_tr_b16 v[210:211], v12 offset:10240
    v_cmp_gt_f32 s[96:97], v22, v52
    v_cmp_lt_f32 s[98:99], v22, v53
    v_and_b32 v46, 15, v1
    s_waitcnt lgkmcnt(4)
    v_mfma_f32_32x32x16_bf16 a[144:159], v[216:219], v[192:195], a[144:159]
    ds_read_b64_tr_b16 v[212:213], v12 offset:12288
    v_cmp_gt_f32 s[4:5], v23, v52
    v_cmp_lt_f32 s[6:7], v23, v53
    v_rcp_f32_e64 v44, v22
    v_lshl_add_u32 v24, v46, 4, v47
    v_mfma_f32_32x32x16_bf16 a[208:223], v[216:219], v[200:203], a[208:223]
    ds_read_b64_tr_b16 v[214:215], v12 offset:14336
    v_rcp_f32 v45, v23
    s_lshl_b32 s89, s49, 14
    s_and_b64 s[96:97], s[96:97], s[98:99]
    s_and_b64 s[4:5], s[4:5], s[6:7]
    s_and_b64 s[4:5], s[4:5], s[96:97]
    s_cmp_eq_u64 s[4:5], exec
    s_cbranch_scc0 p1_slow
    s_waitcnt lgkmcnt(4)
    v_mfma_f32_32x32x16_bf16 a[144:159], v[220:223], v[196:199], a[144:159]
    ds_read_b64_tr_b16 v[216:217], v13 offset:8192
    v_accvgpr_read_b32 v128, a128
    v_accvgpr_read_b32 v129, a129
    v_accvgpr_read_b32 v130, a130
    v_accvgpr_read_b32 v131, a131
    v_mfma_f32_32x32x16_bf16 a[208:223], v[220:223], v[204:207], a[208:223]
    ds_read_b64_tr_b16 v[218:219], v13 offset:10240
    v_accvgpr_read_b32 v132, a132
    v_accvgpr_read_b32 v133, a133
    v_accvgpr_read_b32 v134, a134
    v_accvgpr_read_b32 v135, a135
    s_waitcnt lgkmcnt(4)
    v_mfma_f32_32x32x16_bf16 a[160:175], v[208:211], v[192:195], a[160:175]
    ds_read_b64_tr_b16 v[220:221], v13 offset:12288
    v_accvgpr_read_b32 v136, a136
    v_accvgpr_read_b32 v137, a137
    v_accvgpr_read_b32 v138, a138
    v_accvgpr_read_b32 v139, a139
    v_mfma_f32_32x32x16_bf16 a[224:239], v[208:211], v[200:203], a[224:239]
    ds_read_b64_tr_b16 v[222:223], v13 offset:14336
    v_accvgpr_read_b32 v140, a140
    v_accvgpr_read_b32 v141, a141
    v_accvgpr_read_b32 v142, a142
    v_accvgpr_read_b32 v143, a143
    s_waitcnt lgkmcnt(4)
    v_mfma_f32_32x32x16_bf16 a[160:175], v[212:215], v[196:199], a[160:175]
    v_mul_f32 v128, v44, v128
    v_mul_f32 v129, v44, v129
    v_mul_f32 v130, v44, v130
    v_mul_f32 v131, v44, v131
    v_mul_f32_e64 v132, v44, v132
    v_mfma_f32_32x32x16_bf16 a[224:239], v[212:215], v[204:207], a[224:239]
    v_mul_f32 v133, v44, v133
    v_mul_f32 v134, v44, v134
    v_mul_f32 v135, v44, v135
    v_mul_f32 v136, v44, v136
    v_mul_f32 v137, v44, v137
    s_waitcnt lgkmcnt(2)
    v_mfma_f32_32x32x16_bf16 a[176:191], v[216:219], v[192:195], a[176:191]
    v_mul_f32 v138, v44, v138
    v_mul_f32 v139, v44, v139
    v_mul_f32 v140, v44, v140
    v_mul_f32 v141, v44, v141
    v_mul_f32_e64 v142, v44, v142
    v_mfma_f32_32x32x16_bf16 a[240:255], v[216:219], v[200:203], a[240:255]
    v_mul_f32 v143, v44, v143
    v_cvt_pk_bf16_f32 v224, v128, v129
    v_cvt_pk_bf16_f32 v225, v130, v131
    v_cvt_pk_bf16_f32 v226, v132, v133
    v_cvt_pk_bf16_f32 v227, v134, v135
    s_waitcnt lgkmcnt(0)
    v_mfma_f32_32x32x16_bf16 a[176:191], v[220:223], v[196:199], a[176:191]
    v_cvt_pk_bf16_f32 v228, v136, v137
    v_cvt_pk_bf16_f32 v229, v138, v139
    v_cvt_pk_bf16_f32 v230, v140, v141
    v_cvt_pk_bf16_f32 v231, v142, v143
    buffer_store_dwordx4 v[224:227], v24, s[32:35], s89 offen offset:0 sc1
    v_mfma_f32_32x32x16_bf16 a[240:255], v[220:223], v[204:207], a[240:255]
    buffer_store_dwordx4 v[228:231], v24, s[32:35], s89 offen offset:512 sc1
    v_accvgpr_read_b32 v144, a192
    v_accvgpr_read_b32 v145, a193
    v_accvgpr_read_b32 v146, a194
    v_accvgpr_read_b32 v147, a195
    v_accvgpr_read_b32 v148, a196
    v_accvgpr_read_b32 v149, a197
    v_accvgpr_read_b32 v150, a198
    v_accvgpr_read_b32 v151, a199
    v_accvgpr_read_b32 v152, a200
    v_accvgpr_read_b32 v153, a201
    v_accvgpr_read_b32 v154, a202
    v_accvgpr_read_b32 v155, a203
    v_accvgpr_read_b32 v156, a204
    v_accvgpr_read_b32 v157, a205
    v_accvgpr_read_b32 v158, a206
    v_accvgpr_read_b32 v159, a207
    v_mul_f32 v144, v45, v144
    v_mul_f32 v145, v45, v145
    v_mul_f32 v146, v45, v146
    v_mul_f32 v147, v45, v147
    v_mul_f32 v148, v45, v148
    v_mul_f32 v149, v45, v149
    v_mul_f32 v150, v45, v150
    v_mul_f32 v151, v45, v151
    v_mul_f32 v152, v45, v152
    v_mul_f32 v153, v45, v153
    v_mul_f32 v154, v45, v154
    v_mul_f32 v155, v45, v155
    v_mul_f32 v156, v45, v156
    v_mul_f32 v157, v45, v157
    v_mul_f32 v158, v45, v158
    v_mul_f32 v159, v45, v159
    v_cvt_pk_bf16_f32 v232, v144, v145
    v_cvt_pk_bf16_f32 v233, v146, v147
    v_cvt_pk_bf16_f32 v234, v148, v149
    v_cvt_pk_bf16_f32 v235, v150, v151
    v_cvt_pk_bf16_f32 v236, v152, v153
    v_cvt_pk_bf16_f32 v237, v154, v155
    v_cvt_pk_bf16_f32 v238, v156, v157
    v_cvt_pk_bf16_f32 v239, v158, v159
    buffer_store_dwordx4 v[232:235], v24, s[32:35], s89 offen offset:2048 sc1
    buffer_store_dwordx4 v[236:239], v24, s[32:35], s89 offen offset:2560 sc1
    s_add_u32 s89, s89, 4096
    v_accvgpr_read_b32 v160, a144
    v_accvgpr_read_b32 v161, a145
    v_accvgpr_read_b32 v162, a146
    v_accvgpr_read_b32 v163, a147
    v_accvgpr_read_b32 v164, a148
    v_accvgpr_read_b32 v165, a149
    v_accvgpr_read_b32 v166, a150
    v_accvgpr_read_b32 v167, a151
    v_accvgpr_read_b32 v168, a152
    v_accvgpr_read_b32 v169, a153
    v_accvgpr_read_b32 v170, a154
    v_accvgpr_read_b32 v171, a155
    v_accvgpr_read_b32 v172, a156
    v_accvgpr_read_b32 v173, a157
    v_accvgpr_read_b32 v174, a158
    v_accvgpr_read_b32 v175, a159
    v_pk_mul_f32 v[160:161], v[160:161], v[44:45] op_sel_hi:[1,0]
    v_pk_mul_f32 v[162:163], v[162:163], v[44:45] op_sel_hi:[1,0]
    v_pk_mul_f32 v[164:165], v[164:165], v[44:45] op_sel_hi:[1,0]
    v_pk_mul_f32 v[166:167], v[166:167], v[44:45] op_sel_hi:[1,0]
    v_pk_mul_f32 v[168:169], v[168:169], v[44:45] op_sel_hi:[1,0]
    v_pk_mul_f32 v[170:171], v[170:171], v[44:45] op_sel_hi:[1,0]
    v_pk_mul_f32 v[172:173], v[172:173], v[44:45] op_sel_hi:[1,0]
    v_pk_mul_f32 v[174:175], v[174:175], v[44:45] op_sel_hi:[1,0]
    v_cvt_pk_bf16_f32 v240, v160, v161
    v_cvt_pk_bf16_f32 v241, v162, v163
    v_cvt_pk_bf16_f32 v242, v164, v165
    v_cvt_pk_bf16_f32 v243, v166, v167
    v_cvt_pk_bf16_f32 v244, v168, v169
    v_cvt_pk_bf16_f32 v245, v170, v171
    v_cvt_pk_bf16_f32 v246, v172, v173
    v_cvt_pk_bf16_f32 v247, v174, v175
    buffer_store_dwordx4 v[240:243], v24, s[32:35], s89 offen offset:0 sc1
    buffer_store_dwordx4 v[244:247], v24, s[32:35], s89 offen offset:512 sc1
    v_accvgpr_read_b32 v176, a208
    v_accvgpr_read_b32 v177, a209
    v_accvgpr_read_b32 v178, a210
    v_accvgpr_read_b32 v179, a211
    v_accvgpr_read_b32 v180, a212
    v_accvgpr_read_b32 v181, a213
    v_accvgpr_read_b32 v182, a214
    v_accvgpr_read_b32 v183, a215
    v_accvgpr_read_b32 v184, a216
    v_accvgpr_read_b32 v185, a217
    v_accvgpr_read_b32 v186, a218
    v_accvgpr_read_b32 v187, a219
    v_accvgpr_read_b32 v188, a220
    v_accvgpr_read_b32 v189, a221
    v_accvgpr_read_b32 v190, a222
    v_accvgpr_read_b32 v191, a223
    v_pk_mul_f32 v[176:177], v[176:177], v[44:45] op_sel:[0,1]
    v_pk_mul_f32 v[178:179], v[178:179], v[44:45] op_sel:[0,1]
    v_pk_mul_f32 v[180:181], v[180:181], v[44:45] op_sel:[0,1]
    v_pk_mul_f32 v[182:183], v[182:183], v[44:45] op_sel:[0,1]
    v_pk_mul_f32 v[184:185], v[184:185], v[44:45] op_sel:[0,1]
    v_pk_mul_f32 v[186:187], v[186:187], v[44:45] op_sel:[0,1]
    v_pk_mul_f32 v[188:189], v[188:189], v[44:45] op_sel:[0,1]
    v_pk_mul_f32 v[190:191], v[190:191], v[44:45] op_sel:[0,1]
    v_cvt_pk_bf16_f32 v248, v176, v177
    v_cvt_pk_bf16_f32 v249, v178, v179
    v_cvt_pk_bf16_f32 v250, v180, v181
    v_cvt_pk_bf16_f32 v251, v182, v183
    v_cvt_pk_bf16_f32 v252, v184, v185
    v_cvt_pk_bf16_f32 v253, v186, v187
    v_cvt_pk_bf16_f32 v254, v188, v189
    v_cvt_pk_bf16_f32 v255, v190, v191
    buffer_store_dwordx4 v[248:251], v24, s[32:35], s89 offen offset:2048 sc1
    buffer_store_dwordx4 v[252:255], v24, s[32:35], s89 offen offset:2560 sc1
    s_add_u32 s89, s89, 4096
    v_accvgpr_read_b32 v128, a160
    v_accvgpr_read_b32 v129, a161
    v_accvgpr_read_b32 v130, a162
    v_accvgpr_read_b32 v131, a163
    v_accvgpr_read_b32 v132, a164
    v_accvgpr_read_b32 v133, a165
    v_accvgpr_read_b32 v134, a166
    v_accvgpr_read_b32 v135, a167
    v_accvgpr_read_b32 v136, a168
    v_accvgpr_read_b32 v137, a169
    v_accvgpr_read_b32 v138, a170
    v_accvgpr_read_b32 v139, a171
    v_accvgpr_read_b32 v140, a172
    v_accvgpr_read_b32 v141, a173
    v_accvgpr_read_b32 v142, a174
    v_accvgpr_read_b32 v143, a175
    v_pk_mul_f32 v[128:129], v[128:129], v[44:45] op_sel_hi:[1,0]
    v_pk_mul_f32 v[130:131], v[130:131], v[44:45] op_sel_hi:[1,0]
    v_pk_mul_f32 v[132:133], v[132:133], v[44:45] op_sel_hi:[1,0]
    v_pk_mul_f32 v[134:135], v[134:135], v[44:45] op_sel_hi:[1,0]
    v_pk_mul_f32 v[136:137], v[136:137], v[44:45] op_sel_hi:[1,0]
    v_pk_mul_f32 v[138:139], v[138:139], v[44:45] op_sel_hi:[1,0]
    v_pk_mul_f32 v[140:141], v[140:141], v[44:45] op_sel_hi:[1,0]
    v_pk_mul_f32 v[142:143], v[142:143], v[44:45] op_sel_hi:[1,0]
    v_cvt_pk_bf16_f32 v224, v128, v129
    v_cvt_pk_bf16_f32 v225, v130, v131
    v_cvt_pk_bf16_f32 v226, v132, v133
    v_cvt_pk_bf16_f32 v227, v134, v135
    v_cvt_pk_bf16_f32 v228, v136, v137
    v_cvt_pk_bf16_f32 v229, v138, v139
    v_cvt_pk_bf16_f32 v230, v140, v141
    v_cvt_pk_bf16_f32 v231, v142, v143
    buffer_store_dwordx4 v[224:227], v24, s[32:35], s89 offen offset:0 sc1
    buffer_store_dwordx4 v[228:231], v24, s[32:35], s89 offen offset:512 sc1
    v_accvgpr_read_b32 v144, a224
    v_accvgpr_read_b32 v145, a225
    v_accvgpr_read_b32 v146, a226
    v_accvgpr_read_b32 v147, a227
    v_accvgpr_read_b32 v148, a228
    v_accvgpr_read_b32 v149, a229
    v_accvgpr_read_b32 v150, a230
    v_accvgpr_read_b32 v151, a231
    v_accvgpr_read_b32 v152, a232
    v_accvgpr_read_b32 v153, a233
    v_accvgpr_read_b32 v154, a234
    v_accvgpr_read_b32 v155, a235
    v_accvgpr_read_b32 v156, a236
    v_accvgpr_read_b32 v157, a237
    v_accvgpr_read_b32 v158, a238
    v_accvgpr_read_b32 v159, a239
    v_pk_mul_f32 v[144:145], v[144:145], v[44:45] op_sel:[0,1]
    v_pk_mul_f32 v[146:147], v[146:147], v[44:45] op_sel:[0,1]
    v_pk_mul_f32 v[148:149], v[148:149], v[44:45] op_sel:[0,1]
    v_pk_mul_f32 v[150:151], v[150:151], v[44:45] op_sel:[0,1]
    v_pk_mul_f32 v[152:153], v[152:153], v[44:45] op_sel:[0,1]
    v_pk_mul_f32 v[154:155], v[154:155], v[44:45] op_sel:[0,1]
    v_pk_mul_f32 v[156:157], v[156:157], v[44:45] op_sel:[0,1]
    v_pk_mul_f32 v[158:159], v[158:159], v[44:45] op_sel:[0,1]
    v_cvt_pk_bf16_f32 v232, v144, v145
    v_cvt_pk_bf16_f32 v233, v146, v147
    v_cvt_pk_bf16_f32 v234, v148, v149
    v_cvt_pk_bf16_f32 v235, v150, v151
    v_cvt_pk_bf16_f32 v236, v152, v153
    v_cvt_pk_bf16_f32 v237, v154, v155
    v_cvt_pk_bf16_f32 v238, v156, v157
    v_cvt_pk_bf16_f32 v239, v158, v159
    buffer_store_dwordx4 v[232:235], v24, s[32:35], s89 offen offset:2048 sc1
    buffer_store_dwordx4 v[236:239], v24, s[32:35], s89 offen offset:2560 sc1
    s_add_u32 s89, s89, 4096
    v_accvgpr_read_b32 v160, a176
    v_accvgpr_read_b32 v161, a177
    v_accvgpr_read_b32 v162, a178
    v_accvgpr_read_b32 v163, a179
    v_accvgpr_read_b32 v164, a180
    v_accvgpr_read_b32 v165, a181
    v_accvgpr_read_b32 v166, a182
    v_accvgpr_read_b32 v167, a183
    v_accvgpr_read_b32 v168, a184
    v_accvgpr_read_b32 v169, a185
    v_accvgpr_read_b32 v170, a186
    v_accvgpr_read_b32 v171, a187
    v_accvgpr_read_b32 v172, a188
    v_accvgpr_read_b32 v173, a189
    v_accvgpr_read_b32 v174, a190
    v_accvgpr_read_b32 v175, a191
    v_pk_mul_f32 v[160:161], v[160:161], v[44:45] op_sel_hi:[1,0]
    v_pk_mul_f32 v[162:163], v[162:163], v[44:45] op_sel_hi:[1,0]
    v_pk_mul_f32 v[164:165], v[164:165], v[44:45] op_sel_hi:[1,0]
    v_pk_mul_f32 v[166:167], v[166:167], v[44:45] op_sel_hi:[1,0]
    v_pk_mul_f32 v[168:169], v[168:169], v[44:45] op_sel_hi:[1,0]
    v_pk_mul_f32 v[170:171], v[170:171], v[44:45] op_sel_hi:[1,0]
    v_pk_mul_f32 v[172:173], v[172:173], v[44:45] op_sel_hi:[1,0]
    v_pk_mul_f32 v[174:175], v[174:175], v[44:45] op_sel_hi:[1,0]
    v_cvt_pk_bf16_f32 v240, v160, v161
    v_cvt_pk_bf16_f32 v241, v162, v163
    v_cvt_pk_bf16_f32 v242, v164, v165
    v_cvt_pk_bf16_f32 v243, v166, v167
    v_cvt_pk_bf16_f32 v244, v168, v169
    v_cvt_pk_bf16_f32 v245, v170, v171
    v_cvt_pk_bf16_f32 v246, v172, v173
    v_cvt_pk_bf16_f32 v247, v174, v175
    buffer_store_dwordx4 v[240:243], v24, s[32:35], s89 offen offset:0 sc1
    buffer_store_dwordx4 v[244:247], v24, s[32:35], s89 offen offset:512 sc1
    v_accvgpr_read_b32 v176, a240
    v_accvgpr_read_b32 v177, a241
    v_accvgpr_read_b32 v178, a242
    v_accvgpr_read_b32 v179, a243
    v_accvgpr_read_b32 v180, a244
    v_accvgpr_read_b32 v181, a245
    v_accvgpr_read_b32 v182, a246
    v_accvgpr_read_b32 v183, a247
    v_accvgpr_read_b32 v184, a248
    v_accvgpr_read_b32 v185, a249
    v_accvgpr_read_b32 v186, a250
    v_accvgpr_read_b32 v187, a251
    v_accvgpr_read_b32 v188, a252
    v_accvgpr_read_b32 v189, a253
    v_accvgpr_read_b32 v190, a254
    v_accvgpr_read_b32 v191, a255
    v_pk_mul_f32 v[176:177], v[176:177], v[44:45] op_sel:[0,1]
    v_pk_mul_f32 v[178:179], v[178:179], v[44:45] op_sel:[0,1]
    v_pk_mul_f32 v[180:181], v[180:181], v[44:45] op_sel:[0,1]
    v_pk_mul_f32 v[182:183], v[182:183], v[44:45] op_sel:[0,1]
    v_pk_mul_f32 v[184:185], v[184:185], v[44:45] op_sel:[0,1]
    v_pk_mul_f32 v[186:187], v[186:187], v[44:45] op_sel:[0,1]
    v_pk_mul_f32 v[188:189], v[188:189], v[44:45] op_sel:[0,1]
    v_pk_mul_f32 v[190:191], v[190:191], v[44:45] op_sel:[0,1]
    v_cvt_pk_bf16_f32 v248, v176, v177
    v_cvt_pk_bf16_f32 v249, v178, v179
    v_cvt_pk_bf16_f32 v250, v180, v181
    v_cvt_pk_bf16_f32 v251, v182, v183
    v_cvt_pk_bf16_f32 v252, v184, v185
    v_cvt_pk_bf16_f32 v253, v186, v187
    v_cvt_pk_bf16_f32 v254, v188, v189
    v_cvt_pk_bf16_f32 v255, v190, v191
    buffer_store_dwordx4 v[248:251], v24, s[32:35], s89 offen offset:2048 sc1
    buffer_store_dwordx4 v[252:255], v24, s[32:35], s89 offen offset:2560 sc1
p1_oed:
    s_mov_b32 s20, s82
    s_and_b32 s21, s83, 0xffff
    s_mov_b32 s22, 2621440
    s_mov_b32 s23, 0x20000
    v_mov_b32 v180, 0
    v_mov_b32 v181, 0
    v_mov_b32 v182, 0
    v_mov_b32 v183, 0
    s_nop 1
    v_mfma_f32_32x32x16_bf16 v[64:79], v[180:183], v[180:183], 0
    v_mfma_f32_32x32x16_bf16 v[80:95], v[180:183], v[180:183], 0
    v_mfma_f32_32x32x16_bf16 v[96:111], v[180:183], v[180:183], 0
    v_mfma_f32_32x32x16_bf16 v[112:127], v[180:183], v[180:183], 0
    v_mfma_f32_32x32x16_bf16 v[128:143], v[180:183], v[180:183], 0
    v_mov_b32_e64 v2, v54
    v_add_u32 v3, 40960, v54
    v_lshlrev_b32_e64 v5, 3, v1
    v_add_u32 v6, 81920, v54
    s_mov_b32 s58, 0
    s_cmp_eq_u32 s53, 3
    s_cselect_b32 s78, 18, 99
    s_cselect_b32 s3, 24, 19
    s_cbranch_scc1 p1_qh
    global_load_dwordx2 v[30:31], v36, s[84:85] sc1
    s_waitcnt vmcnt(0)
    s_barrier
    s_cmp_lg_u32 s48, 0
    s_cbranch_scc1 p1_f2
    s_add_u32 s6, s100, 3
    v_mov_b32 v28, s6
    v_mov_b32 v29, s101
    s_mov_b64 exec, 1
    global_store_dwordx2 v25, v[28:29], s[84:85] sc1
    s_mov_b64 exec, -1
p1_f2:
    s_mov_b32 s10, s74
    s_mov_b32 s14, s75
    s_mov_b32 s55, s51
    s_mov_b32 s56, s60
    s_add_u32 s61, s100, 2
    s_mov_b32 s62, 0
p1_w2c:
    v_subrev_u32 v30, s61, v30
    v_cmp_ne_u32 s[96:97], s101, v31
    v_cmp_lt_u32_e64 vcc, 1, v30
    s_nop 3
    s_or_b64 s[96:97], s[96:97], vcc
    s_cbranch_scc0 p1_w2r
    s_add_u32 s62, s62, 1
    s_cmp_ge_u32 s62, 0x40000
    s_cbranch_scc1 p1_w2r
    global_load_dwordx2 v[30:31], v36, s[84:85] sc1
    s_waitcnt vmcnt(0)
    s_branch p1_w2c
p1_w2r:
    global_load_dwordx2 v[32:33], v35, s[84:85] sc1
    s_cmp_lg_u32 s53, 0
    s_cbranch_scc1 p1_qb
    s_add_u32 m0, s57, 20480
    s_nop 0
    buffer_load_dwordx4 v54, s[12:15], s56 offen offset:0 sc1 lds
    buffer_load_dwordx4 v54, s[12:15], s56 offen offset:1024 sc1 lds
    buffer_load_dwordx4 v54, s[12:15], s56 offen offset:2048 sc1 lds
    buffer_load_dwordx4 v54, s[12:15], s56 offen offset:3072 sc1 lds
    s_add_u32 m0, s57, 24576
    s_nop 0
    buffer_load_dwordx4 v55, s[12:15], s56 offen sc1 lds
    s_add_u32 s56, s56, 81920
    s_add_u32 m0, s57, 40960
    s_nop 0
    buffer_load_dwordx4 v54, s[12:15], s56 offen offset:0 sc1 lds
    buffer_load_dwordx4 v54, s[12:15], s56 offen offset:1024 sc1 lds
    buffer_load_dwordx4 v54, s[12:15], s56 offen offset:2048 sc1 lds
    buffer_load_dwordx4 v54, s[12:15], s56 offen offset:3072 sc1 lds
    s_add_u32 m0, s57, 45056
    s_nop 0
    buffer_load_dwordx4 v55, s[12:15], s56 offen sc1 lds
    s_add_u32 s56, s56, 81920
    s_waitcnt vmcnt(10)
    s_cmp_lg_u32 s48, 0
    s_cbranch_scc1 p1_w41r
    s_add_u32 s61, s100, 3
    s_mov_b32 s62, 0
p1_w41c:
    v_subrev_u32_e64 v32, s61, v32
    v_cmp_ne_u32 s[96:97], s101, v33
    v_cmp_lt_u32 vcc, 0, v32
    s_nop 3
    s_or_b64 s[96:97], s[96:97], vcc
    s_cbranch_scc0 p1_w41r
    s_add_u32 s62, s62, 1
    s_cmp_ge_u32 s62, 0x40000
    s_cbranch_scc1 p1_w41r
    global_load_dwordx2 v[32:33], v35, s[84:85] sc1
    s_waitcnt vmcnt(0)
    s_branch p1_w41c
p1_w41r:
    s_waitcnt vmcnt(0)
    s_barrier
    buffer_load_dwordx4 a[16:19], v54, s[8:11], s55 offen offset:0 sc1
    buffer_load_dwordx4 a[20:23], v54, s[8:11], s55 offen offset:1024 sc1
    buffer_load_dwordx4 a[24:27], v55, s[8:11], s55 offen offset:0 sc1
    buffer_load_dwordx4 a[28:31], v55, s[8:11], s55 offen offset:1024 sc1
    s_add_u32 s55, s55, 8192
    buffer_load_dwordx4 a[32:35], v54, s[8:11], s55 offen offset:0 sc1
    buffer_load_dwordx4 a[36:39], v54, s[8:11], s55 offen offset:1024 sc1
    buffer_load_dwordx4 a[40:43], v55, s[8:11], s55 offen offset:0 sc1
    buffer_load_dwordx4 a[44:47], v55, s[8:11], s55 offen offset:1024 sc1
    s_add_u32 s55, s55, 8192
    s_add_u32 m0, s57, 61440
    s_nop 0
    buffer_load_dwordx4 v54, s[12:15], s56 offen offset:0 sc1 lds
    buffer_load_dwordx4 v54, s[12:15], s56 offen offset:1024 sc1 lds
    buffer_load_dwordx4 v54, s[12:15], s56 offen offset:2048 sc1 lds
    buffer_load_dwordx4 v54, s[12:15], s56 offen offset:3072 sc1 lds
    s_add_u32 m0, s57, 65536
    s_nop 0
    buffer_load_dwordx4 v55, s[12:15], s56 offen sc1 lds
    s_add_u32 s56, s56, 81920
    buffer_load_dwordx4 a[48:51], v54, s[8:11], s55 offen offset:0 sc1
    buffer_load_dwordx4 a[52:55], v54, s[8:11], s55 offen offset:1024 sc1
    buffer_load_dwordx4 a[56:59], v55, s[8:11], s55 offen offset:0 sc1
    buffer_load_dwordx4 a[60:63], v55, s[8:11], s55 offen offset:1024 sc1
    s_add_u32 s55, s55, 8192
    ds_read_b128 a[64:67], v2 offset:20480
    ds_read_b128 a[68:71], v2 offset:21504
    ds_read_b128 a[72:75], v2 offset:22528
    s_waitcnt vmcnt(13)
    s_branch p1_q1
p1_qb:
    s_mov_b32 s3, 18
    s_add_u32 m0, s57, 40960
    s_nop 0
    buffer_load_dwordx4 v54, s[12:15], s56 offen offset:0 sc1 lds
    buffer_load_dwordx4 v54, s[12:15], s56 offen offset:1024 sc1 lds
    buffer_load_dwordx4 v54, s[12:15], s56 offen offset:2048 sc1 lds
    buffer_load_dwordx4 v54, s[12:15], s56 offen offset:3072 sc1 lds
    s_add_u32 m0, s57, 45056
    s_nop 0
    buffer_load_dwordx4 v55, s[12:15], s56 offen sc1 lds
    s_add_u32 s56, s56, 81920
    s_add_u32 m0, s57, 61440
    s_nop 0
    buffer_load_dwordx4 v54, s[12:15], s56 offen offset:0 sc1 lds
    buffer_load_dwordx4 v54, s[12:15], s56 offen offset:1024 sc1 lds
    buffer_load_dwordx4 v54, s[12:15], s56 offen offset:2048 sc1 lds
    buffer_load_dwordx4 v54, s[12:15], s56 offen offset:3072 sc1 lds
    s_add_u32 m0, s57, 65536
    s_nop 0
    buffer_load_dwordx4 v55, s[12:15], s56 offen sc1 lds
    s_add_u32 s56, s56, 81920
    s_waitcnt vmcnt(10)
    s_cmp_lg_u32 s48, 0
    s_cbranch_scc1 p1_w42r
    s_add_u32 s61, s100, 3
    s_mov_b32 s62, 0
p1_w42c:
    v_subrev_u32_e64 v32, s61, v32
    v_cmp_ne_u32 s[96:97], s101, v33
    v_cmp_lt_u32 vcc, 0, v32
    s_nop 3
    s_or_b64 s[96:97], s[96:97], vcc
    s_cbranch_scc0 p1_w42r
    s_add_u32 s62, s62, 1
    s_cmp_ge_u32 s62, 0x40000
    s_cbranch_scc1 p1_w42r
    global_load_dwordx2 v[32:33], v35, s[84:85] sc1
    s_waitcnt vmcnt(0)
    s_branch p1_w42c
p1_w42r:
    s_waitcnt vmcnt(0)
    s_barrier
    buffer_load_dwordx4 a[32:35], v54, s[8:11], s55 offen offset:0 sc1
    buffer_load_dwordx4 a[36:39], v54, s[8:11], s55 offen offset:1024 sc1
    buffer_load_dwordx4 a[40:43], v55, s[8:11], s55 offen offset:0 sc1
    buffer_load_dwordx4 a[44:47], v55, s[8:11], s55 offen offset:1024 sc1
    s_add_u32 s55, s55, 8192
    buffer_load_dwordx4 a[48:51], v54, s[8:11], s55 offen offset:0 sc1
    buffer_load_dwordx4 a[52:55], v54, s[8:11], s55 offen offset:1024 sc1
    buffer_load_dwordx4 a[56:59], v55, s[8:11], s55 offen offset:0 sc1
    buffer_load_dwordx4 a[60:63], v55, s[8:11], s55 offen offset:1024 sc1
    s_add_u32 s55, s55, 8192
    s_add_u32 m0, s57, 0
    s_nop 0
    buffer_load_dwordx4 v54, s[12:15], s56 offen offset:0 sc1 lds
    buffer_load_dwordx4 v54, s[12:15], s56 offen offset:1024 sc1 lds
    buffer_load_dwordx4 v54, s[12:15], s56 offen offset:2048 sc1 lds
    buffer_load_dwordx4 v54, s[12:15], s56 offen offset:3072 sc1 lds
    s_add_u32 m0, s57, 4096
    s_nop 0
    buffer_load_dwordx4 v55, s[12:15], s56 offen sc1 lds
    s_add_u32 s56, s56, 81920
    buffer_load_dwordx4 a[0:3], v54, s[8:11], s55 offen offset:0 sc1
    buffer_load_dwordx4 a[4:7], v54, s[8:11], s55 offen offset:1024 sc1
    buffer_load_dwordx4 a[8:11], v55, s[8:11], s55 offen offset:0 sc1
    buffer_load_dwordx4 a[12:15], v55, s[8:11], s55 offen offset:1024 sc1
    s_add_u32 s55, s55, 8192
    ds_read_b128 a[64:67], v3 offset:0
    ds_read_b128 a[68:71], v3 offset:1024
    ds_read_b128 a[72:75], v3 offset:2048
    s_waitcnt vmcnt(13)
    s_branch p1_q2
p1_qh:
    s_waitcnt vmcnt(0)
    s_barrier
    s_cmp_lg_u32 s48, 0
    s_cbranch_scc1 p1_f3
    s_add_u32 s6, s100, 3
    v_mov_b32 v28, s6
    v_mov_b32 v29, s101
    s_mov_b64 exec, 1
    global_store_dwordx2 v25, v[28:29], s[84:85] sc1
    s_mov_b64 exec, -1
p1_f3:
    ds_read_b128 a[64:67], v2 offset:0
    ds_read_b128 a[68:71], v2 offset:1024
    ds_read_b128 a[72:75], v2 offset:2048
.p2align 6
p1_q:
    s_waitcnt lgkmcnt(2)
    v_mfma_f32_16x16x32_bf16 v[64:67], a[64:67], a[0:3], v[64:67]
    ds_read_b128 a[76:79], v2 offset:3072
    v_mfma_f32_16x16x32_bf16 v[104:107], a[64:67], a[4:7], v[104:107]
    s_add_u32 m0, s57, 61440
    s_waitcnt lgkmcnt(2)
    v_mfma_f32_16x16x32_bf16 v[108:111], a[68:71], a[4:7], v[108:111]
    ds_read_b128 a[64:67], v2 offset:4096
    v_mfma_f32_16x16x32_bf16 v[68:71], a[68:71], a[0:3], v[68:71]
    buffer_load_dwordx4 v54, s[12:15], s56 offen offset:0 sc1 lds
    s_waitcnt lgkmcnt(2)
    v_mfma_f32_16x16x32_bf16 v[72:75], a[72:75], a[0:3], v[72:75]
    ds_read_b128 a[68:71], v2 offset:5120
    v_mfma_f32_16x16x32_bf16 v[112:115], a[72:75], a[4:7], v[112:115]
    buffer_load_dwordx4 v54, s[12:15], s56 offen offset:1024 sc1 lds
    s_waitcnt lgkmcnt(2)
    v_mfma_f32_16x16x32_bf16 v[116:119], a[76:79], a[4:7], v[116:119]
    ds_read_b128 a[72:75], v2 offset:6144
    v_mfma_f32_16x16x32_bf16 v[76:79], a[76:79], a[0:3], v[76:79]
    s_waitcnt lgkmcnt(2)
    v_mfma_f32_16x16x32_bf16 v[80:83], a[64:67], a[0:3], v[80:83]
    ds_read_b128 a[76:79], v2 offset:7168
    v_mfma_f32_16x16x32_bf16 v[120:123], a[64:67], a[4:7], v[120:123]
    buffer_load_dwordx4 v54, s[12:15], s56 offen offset:2048 sc1 lds
    s_waitcnt lgkmcnt(2)
    v_mfma_f32_16x16x32_bf16 v[124:127], a[68:71], a[4:7], v[124:127]
    ds_read_b128 a[64:67], v2 offset:8192
    v_mfma_f32_16x16x32_bf16 v[84:87], a[68:71], a[0:3], v[84:87]
    buffer_load_dwordx4 v54, s[12:15], s56 offen offset:3072 sc1 lds
    s_waitcnt lgkmcnt(2)
    v_mfma_f32_16x16x32_bf16 v[88:91], a[72:75], a[0:3], v[88:91]
    ds_read_b128 a[68:71], v2 offset:9216
    v_mfma_f32_16x16x32_bf16 v[128:131], a[72:75], a[4:7], v[128:131]
    s_add_u32 m0, s57, 65536
    s_waitcnt lgkmcnt(2)
    v_mfma_f32_16x16x32_bf16 v[132:135], a[76:79], a[4:7], v[132:135]
    ds_read_b128 a[72:75], v2 offset:10240
    v_mfma_f32_16x16x32_bf16 v[92:95], a[76:79], a[0:3], v[92:95]
    s_waitcnt lgkmcnt(2)
    v_mfma_f32_16x16x32_bf16 v[96:99], a[64:67], a[0:3], v[96:99]
    ds_read_b128 a[76:79], v2 offset:11264
    v_mfma_f32_16x16x32_bf16 v[136:139], a[64:67], a[4:7], v[136:139]
    buffer_load_dwordx4 v55, s[12:15], s56 offen sc1 lds
    s_waitcnt lgkmcnt(2)
    v_mfma_f32_16x16x32_bf16 v[140:143], a[68:71], a[4:7], v[140:143]
    ds_read_b128 a[64:67], v2 offset:12288
    v_mfma_f32_16x16x32_bf16 v[100:103], a[68:71], a[0:3], v[100:103]
    buffer_load_dwordx4 a[48:51], v54, s[8:11], s55 offen offset:0 sc1
    s_waitcnt lgkmcnt(2)
    v_mfma_f32_16x16x32_bf16 v[64:67], a[72:75], a[8:11], v[64:67]
    ds_read_b128 a[68:71], v2 offset:13312
    v_mfma_f32_16x16x32_bf16 v[104:107], a[72:75], a[12:15], v[104:107]
    buffer_load_dwordx4 a[52:55], v54, s[8:11], s55 offen offset:1024 sc1
    s_waitcnt lgkmcnt(2)
    v_mfma_f32_16x16x32_bf16 v[108:111], a[76:79], a[12:15], v[108:111]
    ds_read_b128 a[72:75], v2 offset:14336
    v_mfma_f32_16x16x32_bf16 v[68:71], a[76:79], a[8:11], v[68:71]
    s_waitcnt lgkmcnt(2)
    v_mfma_f32_16x16x32_bf16 v[72:75], a[64:67], a[8:11], v[72:75]
    ds_read_b128 a[76:79], v2 offset:15360
    v_mfma_f32_16x16x32_bf16 v[112:115], a[64:67], a[12:15], v[112:115]
    buffer_load_dwordx4 a[56:59], v55, s[8:11], s55 offen offset:0 sc1
    s_waitcnt lgkmcnt(2)
    v_mfma_f32_16x16x32_bf16 v[116:119], a[68:71], a[12:15], v[116:119]
    ds_read_b128 a[64:67], v2 offset:16384
    v_mfma_f32_16x16x32_bf16 v[76:79], a[68:71], a[8:11], v[76:79]
    buffer_load_dwordx4 a[60:63], v55, s[8:11], s55 offen offset:1024 sc1
    s_waitcnt lgkmcnt(2)
    v_mfma_f32_16x16x32_bf16 v[80:83], a[72:75], a[8:11], v[80:83]
    ds_read_b128 a[68:71], v2 offset:17408
    v_mfma_f32_16x16x32_bf16 v[120:123], a[72:75], a[12:15], v[120:123]
    s_add_u32 s56, s56, 81920
    s_add_u32 s55, s55, 8192
    s_waitcnt lgkmcnt(2)
    v_mfma_f32_16x16x32_bf16 v[124:127], a[76:79], a[12:15], v[124:127]
    ds_read_b128 a[72:75], v2 offset:18432
    v_mfma_f32_16x16x32_bf16 v[84:87], a[76:79], a[8:11], v[84:87]
    s_waitcnt lgkmcnt(2)
    v_mfma_f32_16x16x32_bf16 v[88:91], a[64:67], a[8:11], v[88:91]
    ds_read_b128 a[76:79], v2 offset:19456
    v_mfma_f32_16x16x32_bf16 v[128:131], a[64:67], a[12:15], v[128:131]
    s_waitcnt lgkmcnt(2)
    v_mfma_f32_16x16x32_bf16 v[132:135], a[68:71], a[12:15], v[132:135]
    v_mfma_f32_16x16x32_bf16 v[92:95], a[68:71], a[8:11], v[92:95]
    s_waitcnt vmcnt(18) lgkmcnt(0)
    s_barrier
    v_mfma_f32_16x16x32_bf16 v[96:99], a[72:75], a[8:11], v[96:99]
    ds_read_b128 a[64:67], v2 offset:20480
    v_mfma_f32_16x16x32_bf16 v[136:139], a[72:75], a[12:15], v[136:139]
    ds_read_b128 a[68:71], v2 offset:21504
    v_mfma_f32_16x16x32_bf16 v[140:143], a[76:79], a[12:15], v[140:143]
    ds_read_b128 a[72:75], v2 offset:22528
    v_mfma_f32_16x16x32_bf16 v[100:103], a[76:79], a[8:11], v[100:103]
    s_add_u32 s58, s58, 1
p1_q1:
    s_waitcnt lgkmcnt(2)
    v_mfma_f32_16x16x32_bf16 v[64:67], a[64:67], a[16:19], v[64:67]
    ds_read_b128 a[76:79], v2 offset:23552
    v_mfma_f32_16x16x32_bf16 v[104:107], a[64:67], a[20:23], v[104:107]
    s_add_u32 m0, s57, 0
    s_waitcnt lgkmcnt(2)
    v_mfma_f32_16x16x32_bf16 v[108:111], a[68:71], a[20:23], v[108:111]
    ds_read_b128 a[64:67], v2 offset:24576
    v_mfma_f32_16x16x32_bf16 v[68:71], a[68:71], a[16:19], v[68:71]
    buffer_load_dwordx4 v54, s[12:15], s56 offen offset:0 sc1 lds
    s_waitcnt lgkmcnt(2)
    v_mfma_f32_16x16x32_bf16 v[72:75], a[72:75], a[16:19], v[72:75]
    ds_read_b128 a[68:71], v2 offset:25600
    v_mfma_f32_16x16x32_bf16 v[112:115], a[72:75], a[20:23], v[112:115]
    buffer_load_dwordx4 v54, s[12:15], s56 offen offset:1024 sc1 lds
    s_waitcnt lgkmcnt(2)
    v_mfma_f32_16x16x32_bf16 v[116:119], a[76:79], a[20:23], v[116:119]
    ds_read_b128 a[72:75], v2 offset:26624
    v_mfma_f32_16x16x32_bf16 v[76:79], a[76:79], a[16:19], v[76:79]
    s_waitcnt lgkmcnt(2)
    v_mfma_f32_16x16x32_bf16 v[80:83], a[64:67], a[16:19], v[80:83]
    ds_read_b128 a[76:79], v2 offset:27648
    v_mfma_f32_16x16x32_bf16 v[120:123], a[64:67], a[20:23], v[120:123]
    buffer_load_dwordx4 v54, s[12:15], s56 offen offset:2048 sc1 lds
    s_waitcnt lgkmcnt(2)
    v_mfma_f32_16x16x32_bf16 v[124:127], a[68:71], a[20:23], v[124:127]
    ds_read_b128 a[64:67], v2 offset:28672
    v_mfma_f32_16x16x32_bf16 v[84:87], a[68:71], a[16:19], v[84:87]
    buffer_load_dwordx4 v54, s[12:15], s56 offen offset:3072 sc1 lds
    s_waitcnt lgkmcnt(2)
    v_mfma_f32_16x16x32_bf16 v[88:91], a[72:75], a[16:19], v[88:91]
    ds_read_b128 a[68:71], v2 offset:29696
    v_mfma_f32_16x16x32_bf16 v[128:131], a[72:75], a[20:23], v[128:131]
    s_add_u32 m0, s57, 4096
    s_waitcnt lgkmcnt(2)
    v_mfma_f32_16x16x32_bf16 v[132:135], a[76:79], a[20:23], v[132:135]
    ds_read_b128 a[72:75], v2 offset:30720
    v_mfma_f32_16x16x32_bf16 v[92:95], a[76:79], a[16:19], v[92:95]
    s_waitcnt lgkmcnt(2)
    v_mfma_f32_16x16x32_bf16 v[96:99], a[64:67], a[16:19], v[96:99]
    ds_read_b128 a[76:79], v2 offset:31744
    v_mfma_f32_16x16x32_bf16 v[136:139], a[64:67], a[20:23], v[136:139]
    buffer_load_dwordx4 v55, s[12:15], s56 offen sc1 lds
    s_waitcnt lgkmcnt(2)
    v_mfma_f32_16x16x32_bf16 v[140:143], a[68:71], a[20:23], v[140:143]
    ds_read_b128 a[64:67], v2 offset:32768
    v_mfma_f32_16x16x32_bf16 v[100:103], a[68:71], a[16:19], v[100:103]
    buffer_load_dwordx4 a[0:3], v54, s[8:11], s55 offen offset:0 sc1
    s_waitcnt lgkmcnt(2)
    v_mfma_f32_16x16x32_bf16 v[64:67], a[72:75], a[24:27], v[64:67]
    ds_read_b128 a[68:71], v2 offset:33792
    v_mfma_f32_16x16x32_bf16 v[104:107], a[72:75], a[28:31], v[104:107]
    buffer_load_dwordx4 a[4:7], v54, s[8:11], s55 offen offset:1024 sc1
    s_waitcnt lgkmcnt(2)
    v_mfma_f32_16x16x32_bf16 v[108:111], a[76:79], a[28:31], v[108:111]
    ds_read_b128 a[72:75], v2 offset:34816
    v_mfma_f32_16x16x32_bf16 v[68:71], a[76:79], a[24:27], v[68:71]
    s_waitcnt lgkmcnt(2)
    v_mfma_f32_16x16x32_bf16 v[72:75], a[64:67], a[24:27], v[72:75]
    ds_read_b128 a[76:79], v2 offset:35840
    v_mfma_f32_16x16x32_bf16 v[112:115], a[64:67], a[28:31], v[112:115]
    buffer_load_dwordx4 a[8:11], v55, s[8:11], s55 offen offset:0 sc1
    s_waitcnt lgkmcnt(2)
    v_mfma_f32_16x16x32_bf16 v[116:119], a[68:71], a[28:31], v[116:119]
    ds_read_b128 a[64:67], v2 offset:36864
    v_mfma_f32_16x16x32_bf16 v[76:79], a[68:71], a[24:27], v[76:79]
    buffer_load_dwordx4 a[12:15], v55, s[8:11], s55 offen offset:1024 sc1
    s_waitcnt lgkmcnt(2)
    v_mfma_f32_16x16x32_bf16 v[80:83], a[72:75], a[24:27], v[80:83]
    ds_read_b128 a[68:71], v2 offset:37888
    v_mfma_f32_16x16x32_bf16 v[120:123], a[72:75], a[28:31], v[120:123]
    s_add_u32 s56, s56, 81920
    s_add_u32 s55, s55, 8192
    s_waitcnt lgkmcnt(2)
    v_mfma_f32_16x16x32_bf16 v[124:127], a[76:79], a[28:31], v[124:127]
    ds_read_b128 a[72:75], v2 offset:38912
    v_mfma_f32_16x16x32_bf16 v[84:87], a[76:79], a[24:27], v[84:87]
    s_waitcnt lgkmcnt(2)
    v_mfma_f32_16x16x32_bf16 v[88:91], a[64:67], a[24:27], v[88:91]
    ds_read_b128 a[76:79], v2 offset:39936
    v_mfma_f32_16x16x32_bf16 v[128:131], a[64:67], a[28:31], v[128:131]
    s_waitcnt lgkmcnt(2)
    v_mfma_f32_16x16x32_bf16 v[132:135], a[68:71], a[28:31], v[132:135]
    v_mfma_f32_16x16x32_bf16 v[92:95], a[68:71], a[24:27], v[92:95]
    s_waitcnt vmcnt(18) lgkmcnt(0)
    s_barrier
    v_mfma_f32_16x16x32_bf16 v[96:99], a[72:75], a[24:27], v[96:99]
    ds_read_b128 a[64:67], v3 offset:0
    v_mfma_f32_16x16x32_bf16 v[136:139], a[72:75], a[28:31], v[136:139]
    ds_read_b128 a[68:71], v3 offset:1024
    v_mfma_f32_16x16x32_bf16 v[140:143], a[76:79], a[28:31], v[140:143]
    ds_read_b128 a[72:75], v3 offset:2048
    v_mfma_f32_16x16x32_bf16 v[100:103], a[76:79], a[24:27], v[100:103]
    s_add_u32 s58, s58, 1
    s_cmp_eq_u32 s78, s58
    s_cbranch_scc1 p1_qe1
p1_qr1:
p1_q2:
    s_waitcnt lgkmcnt(2)
    v_mfma_f32_16x16x32_bf16 v[64:67], a[64:67], a[32:35], v[64:67]
    ds_read_b128 a[76:79], v3 offset:3072
    v_mfma_f32_16x16x32_bf16 v[104:107], a[64:67], a[36:39], v[104:107]
    s_add_u32 m0, s57, 20480
    s_waitcnt lgkmcnt(2)
    v_mfma_f32_16x16x32_bf16 v[108:111], a[68:71], a[36:39], v[108:111]
    ds_read_b128 a[64:67], v3 offset:4096
    v_mfma_f32_16x16x32_bf16 v[68:71], a[68:71], a[32:35], v[68:71]
    buffer_load_dwordx4 v54, s[12:15], s56 offen offset:0 sc1 lds
    s_waitcnt lgkmcnt(2)
    v_mfma_f32_16x16x32_bf16 v[72:75], a[72:75], a[32:35], v[72:75]
    ds_read_b128 a[68:71], v3 offset:5120
    v_mfma_f32_16x16x32_bf16 v[112:115], a[72:75], a[36:39], v[112:115]
    buffer_load_dwordx4 v54, s[12:15], s56 offen offset:1024 sc1 lds
    s_waitcnt lgkmcnt(2)
    v_mfma_f32_16x16x32_bf16 v[116:119], a[76:79], a[36:39], v[116:119]
    ds_read_b128 a[72:75], v3 offset:6144
    v_mfma_f32_16x16x32_bf16 v[76:79], a[76:79], a[32:35], v[76:79]
    s_waitcnt lgkmcnt(2)
    v_mfma_f32_16x16x32_bf16 v[80:83], a[64:67], a[32:35], v[80:83]
    ds_read_b128 a[76:79], v3 offset:7168
    v_mfma_f32_16x16x32_bf16 v[120:123], a[64:67], a[36:39], v[120:123]
    buffer_load_dwordx4 v54, s[12:15], s56 offen offset:2048 sc1 lds
    s_waitcnt lgkmcnt(2)
    v_mfma_f32_16x16x32_bf16 v[124:127], a[68:71], a[36:39], v[124:127]
    ds_read_b128 a[64:67], v3 offset:8192
    v_mfma_f32_16x16x32_bf16 v[84:87], a[68:71], a[32:35], v[84:87]
    buffer_load_dwordx4 v54, s[12:15], s56 offen offset:3072 sc1 lds
    s_waitcnt lgkmcnt(2)
    v_mfma_f32_16x16x32_bf16 v[88:91], a[72:75], a[32:35], v[88:91]
    ds_read_b128 a[68:71], v3 offset:9216
    v_mfma_f32_16x16x32_bf16 v[128:131], a[72:75], a[36:39], v[128:131]
    s_add_u32 m0, s57, 24576
    s_waitcnt lgkmcnt(2)
    v_mfma_f32_16x16x32_bf16 v[132:135], a[76:79], a[36:39], v[132:135]
    ds_read_b128 a[72:75], v3 offset:10240
    v_mfma_f32_16x16x32_bf16 v[92:95], a[76:79], a[32:35], v[92:95]
    s_waitcnt lgkmcnt(2)
    v_mfma_f32_16x16x32_bf16 v[96:99], a[64:67], a[32:35], v[96:99]
    ds_read_b128 a[76:79], v3 offset:11264
    v_mfma_f32_16x16x32_bf16 v[136:139], a[64:67], a[36:39], v[136:139]
    buffer_load_dwordx4 v55, s[12:15], s56 offen sc1 lds
    s_waitcnt lgkmcnt(2)
    v_mfma_f32_16x16x32_bf16 v[140:143], a[68:71], a[36:39], v[140:143]
    ds_read_b128 a[64:67], v3 offset:12288
    v_mfma_f32_16x16x32_bf16 v[100:103], a[68:71], a[32:35], v[100:103]
    buffer_load_dwordx4 a[16:19], v54, s[8:11], s55 offen offset:0 sc1
    s_waitcnt lgkmcnt(2)
    v_mfma_f32_16x16x32_bf16 v[64:67], a[72:75], a[40:43], v[64:67]
    ds_read_b128 a[68:71], v3 offset:13312
    v_mfma_f32_16x16x32_bf16 v[104:107], a[72:75], a[44:47], v[104:107]
    buffer_load_dwordx4 a[20:23], v54, s[8:11], s55 offen offset:1024 sc1
    s_waitcnt lgkmcnt(2)
    v_mfma_f32_16x16x32_bf16 v[108:111], a[76:79], a[44:47], v[108:111]
    ds_read_b128 a[72:75], v3 offset:14336
    v_mfma_f32_16x16x32_bf16 v[68:71], a[76:79], a[40:43], v[68:71]
    s_waitcnt lgkmcnt(2)
    v_mfma_f32_16x16x32_bf16 v[72:75], a[64:67], a[40:43], v[72:75]
    ds_read_b128 a[76:79], v3 offset:15360
    v_mfma_f32_16x16x32_bf16 v[112:115], a[64:67], a[44:47], v[112:115]
    buffer_load_dwordx4 a[24:27], v55, s[8:11], s55 offen offset:0 sc1
    s_waitcnt lgkmcnt(2)
    v_mfma_f32_16x16x32_bf16 v[116:119], a[68:71], a[44:47], v[116:119]
    ds_read_b128 a[64:67], v3 offset:16384
    v_mfma_f32_16x16x32_bf16 v[76:79], a[68:71], a[40:43], v[76:79]
    buffer_load_dwordx4 a[28:31], v55, s[8:11], s55 offen offset:1024 sc1
    s_waitcnt lgkmcnt(2)
    v_mfma_f32_16x16x32_bf16 v[80:83], a[72:75], a[40:43], v[80:83]
    ds_read_b128 a[68:71], v3 offset:17408
    v_mfma_f32_16x16x32_bf16 v[120:123], a[72:75], a[44:47], v[120:123]
    s_add_u32 s56, s56, 81920
    s_add_u32 s55, s55, 8192
    s_waitcnt lgkmcnt(2)
    v_mfma_f32_16x16x32_bf16 v[124:127], a[76:79], a[44:47], v[124:127]
    ds_read_b128 a[72:75], v3 offset:18432
    v_mfma_f32_16x16x32_bf16 v[84:87], a[76:79], a[40:43], v[84:87]
    s_waitcnt lgkmcnt(2)
    v_mfma_f32_16x16x32_bf16 v[88:91], a[64:67], a[40:43], v[88:91]
    ds_read_b128 a[76:79], v3 offset:19456
    v_mfma_f32_16x16x32_bf16 v[128:131], a[64:67], a[44:47], v[128:131]
    s_waitcnt lgkmcnt(2)
    v_mfma_f32_16x16x32_bf16 v[132:135], a[68:71], a[44:47], v[132:135]
    v_mfma_f32_16x16x32_bf16 v[92:95], a[68:71], a[40:43], v[92:95]
    s_waitcnt vmcnt(18) lgkmcnt(0)
    s_barrier
    v_mfma_f32_16x16x32_bf16 v[96:99], a[72:75], a[40:43], v[96:99]
    ds_read_b128 a[64:67], v3 offset:20480
    v_mfma_f32_16x16x32_bf16 v[136:139], a[72:75], a[44:47], v[136:139]
    ds_read_b128 a[68:71], v3 offset:21504
    v_mfma_f32_16x16x32_bf16 v[140:143], a[76:79], a[44:47], v[140:143]
    ds_read_b128 a[72:75], v3 offset:22528
    v_mfma_f32_16x16x32_bf16 v[100:103], a[76:79], a[40:43], v[100:103]
    s_add_u32 s58, s58, 1
    s_waitcnt lgkmcnt(2)
    v_mfma_f32_16x16x32_bf16 v[64:67], a[64:67], a[48:51], v[64:67]
    ds_read_b128 a[76:79], v3 offset:23552
    v_mfma_f32_16x16x32_bf16 v[104:107], a[64:67], a[52:55], v[104:107]
    s_add_u32 m0, s57, 40960
    s_waitcnt lgkmcnt(2)
    v_mfma_f32_16x16x32_bf16 v[108:111], a[68:71], a[52:55], v[108:111]
    ds_read_b128 a[64:67], v3 offset:24576
    v_mfma_f32_16x16x32_bf16 v[68:71], a[68:71], a[48:51], v[68:71]
    buffer_load_dwordx4 v54, s[12:15], s56 offen offset:0 sc1 lds
    s_waitcnt lgkmcnt(2)
    v_mfma_f32_16x16x32_bf16 v[72:75], a[72:75], a[48:51], v[72:75]
    ds_read_b128 a[68:71], v3 offset:25600
    v_mfma_f32_16x16x32_bf16 v[112:115], a[72:75], a[52:55], v[112:115]
    buffer_load_dwordx4 v54, s[12:15], s56 offen offset:1024 sc1 lds
    s_waitcnt lgkmcnt(2)
    v_mfma_f32_16x16x32_bf16 v[116:119], a[76:79], a[52:55], v[116:119]
    ds_read_b128 a[72:75], v3 offset:26624
    v_mfma_f32_16x16x32_bf16 v[76:79], a[76:79], a[48:51], v[76:79]
    s_waitcnt lgkmcnt(2)
    v_mfma_f32_16x16x32_bf16 v[80:83], a[64:67], a[48:51], v[80:83]
    ds_read_b128 a[76:79], v3 offset:27648
    v_mfma_f32_16x16x32_bf16 v[120:123], a[64:67], a[52:55], v[120:123]
    buffer_load_dwordx4 v54, s[12:15], s56 offen offset:2048 sc1 lds
    s_waitcnt lgkmcnt(2)
    v_mfma_f32_16x16x32_bf16 v[124:127], a[68:71], a[52:55], v[124:127]
    ds_read_b128 a[64:67], v3 offset:28672
    v_mfma_f32_16x16x32_bf16 v[84:87], a[68:71], a[48:51], v[84:87]
    buffer_load_dwordx4 v54, s[12:15], s56 offen offset:3072 sc1 lds
    s_waitcnt lgkmcnt(2)
    v_mfma_f32_16x16x32_bf16 v[88:91], a[72:75], a[48:51], v[88:91]
    ds_read_b128 a[68:71], v3 offset:29696
    v_mfma_f32_16x16x32_bf16 v[128:131], a[72:75], a[52:55], v[128:131]
    s_add_u32 m0, s57, 45056
    s_waitcnt lgkmcnt(2)
    v_mfma_f32_16x16x32_bf16 v[132:135], a[76:79], a[52:55], v[132:135]
    ds_read_b128 a[72:75], v3 offset:30720
    v_mfma_f32_16x16x32_bf16 v[92:95], a[76:79], a[48:51], v[92:95]
    s_waitcnt lgkmcnt(2)
    v_mfma_f32_16x16x32_bf16 v[96:99], a[64:67], a[48:51], v[96:99]
    ds_read_b128 a[76:79], v3 offset:31744
    v_mfma_f32_16x16x32_bf16 v[136:139], a[64:67], a[52:55], v[136:139]
    buffer_load_dwordx4 v55, s[12:15], s56 offen sc1 lds
    s_waitcnt lgkmcnt(2)
    v_mfma_f32_16x16x32_bf16 v[140:143], a[68:71], a[52:55], v[140:143]
    ds_read_b128 a[64:67], v3 offset:32768
    v_mfma_f32_16x16x32_bf16 v[100:103], a[68:71], a[48:51], v[100:103]
    buffer_load_dwordx4 a[32:35], v54, s[8:11], s55 offen offset:0 sc1
    s_waitcnt lgkmcnt(2)
    v_mfma_f32_16x16x32_bf16 v[64:67], a[72:75], a[56:59], v[64:67]
    ds_read_b128 a[68:71], v3 offset:33792
    v_mfma_f32_16x16x32_bf16 v[104:107], a[72:75], a[60:63], v[104:107]
    buffer_load_dwordx4 a[36:39], v54, s[8:11], s55 offen offset:1024 sc1
    s_waitcnt lgkmcnt(2)
    v_mfma_f32_16x16x32_bf16 v[108:111], a[76:79], a[60:63], v[108:111]
    ds_read_b128 a[72:75], v3 offset:34816
    v_mfma_f32_16x16x32_bf16 v[68:71], a[76:79], a[56:59], v[68:71]
    s_waitcnt lgkmcnt(2)
    v_mfma_f32_16x16x32_bf16 v[72:75], a[64:67], a[56:59], v[72:75]
    ds_read_b128 a[76:79], v3 offset:35840
    v_mfma_f32_16x16x32_bf16 v[112:115], a[64:67], a[60:63], v[112:115]
    buffer_load_dwordx4 a[40:43], v55, s[8:11], s55 offen offset:0 sc1
    s_waitcnt lgkmcnt(2)
    v_mfma_f32_16x16x32_bf16 v[116:119], a[68:71], a[60:63], v[116:119]
    ds_read_b128 a[64:67], v3 offset:36864
    v_mfma_f32_16x16x32_bf16 v[76:79], a[68:71], a[56:59], v[76:79]
    buffer_load_dwordx4 a[44:47], v55, s[8:11], s55 offen offset:1024 sc1
    s_waitcnt lgkmcnt(2)
    v_mfma_f32_16x16x32_bf16 v[80:83], a[72:75], a[56:59], v[80:83]
    ds_read_b128 a[68:71], v3 offset:37888
    v_mfma_f32_16x16x32_bf16 v[120:123], a[72:75], a[60:63], v[120:123]
    s_add_u32 s56, s56, 81920
    s_add_u32 s55, s55, 8192
    s_waitcnt lgkmcnt(2)
    v_mfma_f32_16x16x32_bf16 v[124:127], a[76:79], a[60:63], v[124:127]
    ds_read_b128 a[72:75], v3 offset:38912
    v_mfma_f32_16x16x32_bf16 v[84:87], a[76:79], a[56:59], v[84:87]
    s_waitcnt lgkmcnt(2)
    v_mfma_f32_16x16x32_bf16 v[88:91], a[64:67], a[56:59], v[88:91]
    ds_read_b128 a[76:79], v3 offset:39936
    v_mfma_f32_16x16x32_bf16 v[128:131], a[64:67], a[60:63], v[128:131]
    s_waitcnt lgkmcnt(2)
    v_mfma_f32_16x16x32_bf16 v[132:135], a[68:71], a[60:63], v[132:135]
    v_mfma_f32_16x16x32_bf16 v[92:95], a[68:71], a[56:59], v[92:95]
    s_waitcnt vmcnt(18) lgkmcnt(0)
    s_barrier
    v_mfma_f32_16x16x32_bf16 v[96:99], a[72:75], a[56:59], v[96:99]
    ds_read_b128 a[64:67], v2 offset:0
    v_mfma_f32_16x16x32_bf16 v[136:139], a[72:75], a[60:63], v[136:139]
    ds_read_b128 a[68:71], v2 offset:1024
    v_mfma_f32_16x16x32_bf16 v[140:143], a[76:79], a[60:63], v[140:143]
    ds_read_b128 a[72:75], v2 offset:2048
    v_mfma_f32_16x16x32_bf16 v[100:103], a[76:79], a[56:59], v[100:103]
    s_add_u32 s58, s58, 1
    s_cmp_lg_u32 s3, s58
    s_cbranch_scc1 p1_q
    s_cmp_lg_u32 s53, 3
    s_cbranch_scc1 p1_qy
    s_add_u32 s61, s100, 3
    s_mov_b32 s62, 0
p1_w3c:
    v_subrev_u32 v32, s61, v32
    v_cmp_ne_u32 s[96:97], s101, v33
    v_cmp_lt_u32_e64 vcc, 0, v32
    s_nop 3
    s_or_b64 s[96:97], s[96:97], vcc
    s_cbranch_scc0 p1_w3r
    s_add_u32 s62, s62, 1
    s_cmp_ge_u32 s62, 0x40000
    s_cbranch_scc1 p1_w3r
    global_load_dwordx2 v[32:33], v37, s[84:85] sc1
    s_waitcnt vmcnt(0)
    s_branch p1_w3c
p1_w3r:
p1_qy:
    s_waitcnt lgkmcnt(2)
    v_mfma_f32_16x16x32_bf16 v[64:67], a[64:67], a[0:3], v[64:67]
    ds_read_b128 a[76:79], v2 offset:3072
    v_mfma_f32_16x16x32_bf16 v[104:107], a[64:67], a[4:7], v[104:107]
    s_add_u32 s61, s93, 5120
    s_add_u32 s62, s93, 2560
    s_add_u32 s63, s93, 7680
    s_waitcnt lgkmcnt(2)
    v_mfma_f32_16x16x32_bf16 v[108:111], a[68:71], a[4:7], v[108:111]
    ds_read_b128 a[64:67], v2 offset:4096
    v_mfma_f32_16x16x32_bf16 v[68:71], a[68:71], a[0:3], v[68:71]
    s_waitcnt lgkmcnt(2)
    v_mfma_f32_16x16x32_bf16 v[72:75], a[72:75], a[0:3], v[72:75]
    ds_read_b128 a[68:71], v2 offset:10240
    v_mfma_f32_16x16x32_bf16 v[112:115], a[72:75], a[4:7], v[112:115]
    s_waitcnt lgkmcnt(2)
    v_mfma_f32_16x16x32_bf16 v[116:119], a[76:79], a[4:7], v[116:119]
    ds_read_b128 a[72:75], v2 offset:11264
    v_mfma_f32_16x16x32_bf16 v[76:79], a[76:79], a[0:3], v[76:79]
    s_waitcnt lgkmcnt(2)
    v_mfma_f32_16x16x32_bf16 v[80:83], a[64:67], a[0:3], v[80:83]
    ds_read_b128 a[76:79], v2 offset:12288
    v_mfma_f32_16x16x32_bf16 v[120:123], a[64:67], a[4:7], v[120:123]
    s_waitcnt lgkmcnt(2)
    v_mfma_f32_16x16x32_bf16 v[104:107], a[68:71], a[12:15], v[104:107]
    ds_read_b128 a[64:67], v2 offset:13312
    v_mfma_f32_16x16x32_bf16 v[64:67], a[68:71], a[8:11], v[64:67]
    s_waitcnt lgkmcnt(2)
    v_mfma_f32_16x16x32_bf16 v[68:71], a[72:75], a[8:11], v[68:71]
    ds_read_b128 a[68:71], v2 offset:14336
    v_mfma_f32_16x16x32_bf16 v[108:111], a[72:75], a[12:15], v[108:111]
    s_waitcnt lgkmcnt(2)
    v_mfma_f32_16x16x32_bf16 v[112:115], a[76:79], a[12:15], v[112:115]
    v_mfma_f32_16x16x32_bf16 v[72:75], a[76:79], a[8:11], v[72:75]
    s_waitcnt vmcnt(9)
    s_barrier
    s_waitcnt lgkmcnt(1)
    v_mfma_f32_16x16x32_bf16 v[76:79], a[64:67], a[8:11], v[76:79]
    ds_read_b128 a[72:75], v2 offset:20480
    v_mfma_f32_16x16x32_bf16 v[116:119], a[64:67], a[12:15], v[116:119]
    ds_read_b128 a[76:79], v2 offset:21504
    s_waitcnt lgkmcnt(2)
    v_mfma_f32_16x16x32_bf16 v[120:123], a[68:71], a[12:15], v[120:123]
    ds_read_b128 a[64:67], v2 offset:22528
    v_mfma_f32_16x16x32_bf16 v[80:83], a[68:71], a[8:11], v[80:83]
    s_waitcnt lgkmcnt(2)
    v_mfma_f32_16x16x32_bf16 v[64:67], a[72:75], a[16:19], v[64:67]
    ds_read_b128 a[68:71], v2 offset:23552
    v_mfma_f32_16x16x32_bf16 v[104:107], a[72:75], a[20:23], v[104:107]
    s_waitcnt lgkmcnt(2)
    v_mfma_f32_16x16x32_bf16 v[108:111], a[76:79], a[20:23], v[108:111]
    ds_read_b128 a[72:75], v2 offset:24576
    v_mfma_f32_16x16x32_bf16 v[68:71], a[76:79], a[16:19], v[68:71]
    s_waitcnt lgkmcnt(2)
    v_mfma_f32_16x16x32_bf16 v[72:75], a[64:67], a[16:19], v[72:75]
    ds_read_b128 a[76:79], v2 offset:30720
    v_mfma_f32_16x16x32_bf16 v[112:115], a[64:67], a[20:23], v[112:115]
    s_waitcnt lgkmcnt(2)
    v_mfma_f32_16x16x32_bf16 v[116:119], a[68:71], a[20:23], v[116:119]
    ds_read_b128 a[64:67], v2 offset:31744
    v_mfma_f32_16x16x32_bf16 v[76:79], a[68:71], a[16:19], v[76:79]
    s_waitcnt lgkmcnt(2)
    v_mfma_f32_16x16x32_bf16 v[80:83], a[72:75], a[16:19], v[80:83]
    ds_read_b128 a[68:71], v2 offset:32768
    v_mfma_f32_16x16x32_bf16 v[120:123], a[72:75], a[20:23], v[120:123]
    s_waitcnt lgkmcnt(2)
    v_mfma_f32_16x16x32_bf16 v[104:107], a[76:79], a[28:31], v[104:107]
    ds_read_b128 a[72:75], v2 offset:33792
    v_mfma_f32_16x16x32_bf16 v[64:67], a[76:79], a[24:27], v[64:67]
    s_waitcnt lgkmcnt(2)
    v_mfma_f32_16x16x32_bf16 v[68:71], a[64:67], a[24:27], v[68:71]
    ds_read_b128 a[76:79], v2 offset:34816
    v_mfma_f32_16x16x32_bf16 v[108:111], a[64:67], a[28:31], v[108:111]
    s_waitcnt lgkmcnt(2)
    v_mfma_f32_16x16x32_bf16 v[112:115], a[68:71], a[28:31], v[112:115]
    v_mfma_f32_16x16x32_bf16 v[72:75], a[68:71], a[24:27], v[72:75]
    s_waitcnt vmcnt(0)
    s_barrier
    s_waitcnt lgkmcnt(1)
    v_mfma_f32_16x16x32_bf16 v[76:79], a[72:75], a[24:27], v[76:79]
    ds_read_b128 a[64:67], v3 offset:0
    v_mfma_f32_16x16x32_bf16 v[116:119], a[72:75], a[28:31], v[116:119]
    ds_read_b128 a[68:71], v3 offset:1024
    s_waitcnt lgkmcnt(2)
    v_mfma_f32_16x16x32_bf16 v[120:123], a[76:79], a[28:31], v[120:123]
    ds_read_b128 a[72:75], v3 offset:2048
    v_mfma_f32_16x16x32_bf16 v[80:83], a[76:79], a[24:27], v[80:83]
    s_waitcnt lgkmcnt(2)
    v_mfma_f32_16x16x32_bf16 v[64:67], a[64:67], a[32:35], v[64:67]
    ds_read_b128 a[76:79], v3 offset:3072
    v_mfma_f32_16x16x32_bf16 v[104:107], a[64:67], a[36:39], v[104:107]
    s_waitcnt lgkmcnt(2)
    v_mfma_f32_16x16x32_bf16 v[108:111], a[68:71], a[36:39], v[108:111]
    ds_read_b128 a[64:67], v3 offset:4096
    v_mfma_f32_16x16x32_bf16 v[68:71], a[68:71], a[32:35], v[68:71]
    s_waitcnt lgkmcnt(2)
    v_mfma_f32_16x16x32_bf16 v[72:75], a[72:75], a[32:35], v[72:75]
    ds_read_b128 a[68:71], v3 offset:10240
    v_mfma_f32_16x16x32_bf16 v[112:115], a[72:75], a[36:39], v[112:115]
    s_waitcnt lgkmcnt(2)
    v_mfma_f32_16x16x32_bf16 v[116:119], a[76:79], a[36:39], v[116:119]
    ds_read_b128 a[72:75], v3 offset:11264
    v_mfma_f32_16x16x32_bf16 v[76:79], a[76:79], a[32:35], v[76:79]
    s_waitcnt lgkmcnt(2)
    v_mfma_f32_16x16x32_bf16 v[80:83], a[64:67], a[32:35], v[80:83]
    ds_read_b128 a[76:79], v3 offset:12288
    v_mfma_f32_16x16x32_bf16 v[120:123], a[64:67], a[36:39], v[120:123]
    s_waitcnt lgkmcnt(2)
    v_mfma_f32_16x16x32_bf16 v[104:107], a[68:71], a[44:47], v[104:107]
    ds_read_b128 a[64:67], v3 offset:13312
    v_mfma_f32_16x16x32_bf16 v[64:67], a[68:71], a[40:43], v[64:67]
    s_waitcnt lgkmcnt(2)
    v_mfma_f32_16x16x32_bf16 v[68:71], a[72:75], a[40:43], v[68:71]
    ds_read_b128 a[68:71], v3 offset:14336
    v_mfma_f32_16x16x32_bf16 v[108:111], a[72:75], a[44:47], v[108:111]
    s_waitcnt lgkmcnt(2)
    v_mfma_f32_16x16x32_bf16 v[112:115], a[76:79], a[44:47], v[112:115]
    ds_read_b128 a[72:75], v2 offset:5120
    v_mfma_f32_16x16x32_bf16 v[72:75], a[76:79], a[40:43], v[72:75]
    s_waitcnt lgkmcnt(2)
    v_mfma_f32_16x16x32_bf16 v[76:79], a[64:67], a[40:43], v[76:79]
    ds_read_b128 a[76:79], v2 offset:6144
    v_mfma_f32_16x16x32_bf16 v[116:119], a[64:67], a[44:47], v[116:119]
    s_waitcnt lgkmcnt(2)
    v_mfma_f32_16x16x32_bf16 v[120:123], a[68:71], a[44:47], v[120:123]
    ds_read_b128 a[64:67], v2 offset:7168
    v_mfma_f32_16x16x32_bf16 v[80:83], a[68:71], a[40:43], v[80:83]
    s_waitcnt lgkmcnt(2)
    v_mfma_f32_16x16x32_bf16 v[84:87], a[72:75], a[0:3], v[84:87]
    ds_read_b128 a[68:71], v2 offset:8192
    v_mfma_f32_16x16x32_bf16 v[124:127], a[72:75], a[4:7], v[124:127]
    s_waitcnt lgkmcnt(2)
    v_mfma_f32_16x16x32_bf16 v[128:131], a[76:79], a[4:7], v[128:131]
    ds_read_b128 a[72:75], v2 offset:9216
    v_mfma_f32_16x16x32_bf16 v[88:91], a[76:79], a[0:3], v[88:91]
    v_cvt_pk_bf16_f32 v144, v64, v65
    v_cvt_pk_bf16_f32 v145, v66, v67
    s_waitcnt lgkmcnt(2)
    v_mfma_f32_16x16x32_bf16 v[92:95], a[64:67], a[0:3], v[92:95]
    ds_read_b128 a[76:79], v2 offset:15360
    v_cvt_pk_bf16_f32 v146, v68, v69
    v_cvt_pk_bf16_f32 v147, v70, v71
    v_mfma_f32_16x16x32_bf16 v[132:135], a[64:67], a[4:7], v[132:135]
    v_cvt_pk_bf16_f32 v148, v72, v73
    s_waitcnt lgkmcnt(2)
    v_mfma_f32_16x16x32_bf16 v[136:139], a[68:71], a[4:7], v[136:139]
    ds_read_b128 a[64:67], v2 offset:16384
    v_cvt_pk_bf16_f32 v149, v74, v75
    v_cvt_pk_bf16_f32 v150, v76, v77
    v_mfma_f32_16x16x32_bf16 v[96:99], a[68:71], a[0:3], v[96:99]
    v_cvt_pk_bf16_f32 v151, v78, v79
    s_waitcnt lgkmcnt(2)
    v_mfma_f32_16x16x32_bf16 v[100:103], a[72:75], a[0:3], v[100:103]
    ds_read_b128 a[68:71], v2 offset:17408
    v_cvt_pk_bf16_f32 v152, v80, v81
    v_cvt_pk_bf16_f32 v153, v82, v83
    v_mfma_f32_16x16x32_bf16 v[140:143], a[72:75], a[4:7], v[140:143]
    v_min_u32 v144, -2, v144
    s_waitcnt lgkmcnt(2)
    v_mfma_f32_16x16x32_bf16 v[124:127], a[76:79], a[12:15], v[124:127]
    ds_read_b128 a[72:75], v2 offset:18432
    v_min_u32 v145, -2, v145
    v_min_u32 v146, -2, v146
    v_mfma_f32_16x16x32_bf16 v[84:87], a[76:79], a[8:11], v[84:87]
    v_min_u32 v147, -2, v147
    s_waitcnt lgkmcnt(2)
    v_mfma_f32_16x16x32_bf16 v[88:91], a[64:67], a[8:11], v[88:91]
    ds_read_b128 a[76:79], v2 offset:19456
    v_min_u32 v148, -2, v148
    v_min_u32 v149, -2, v149
    v_mfma_f32_16x16x32_bf16 v[128:131], a[64:67], a[12:15], v[128:131]
    v_min_u32 v150, -2, v150
    s_waitcnt lgkmcnt(2)
    v_mfma_f32_16x16x32_bf16 v[132:135], a[68:71], a[12:15], v[132:135]
    ds_read_b128 a[64:67], v2 offset:25600
    v_min_u32 v151, -2, v151
    v_min_u32 v152, -2, v152
    v_mfma_f32_16x16x32_bf16 v[92:95], a[68:71], a[8:11], v[92:95]
    v_min_u32 v153, -2, v153
    s_waitcnt lgkmcnt(2)
    v_mfma_f32_16x16x32_bf16 v[96:99], a[72:75], a[8:11], v[96:99]
    ds_read_b128 a[68:71], v2 offset:26624
    buffer_store_dwordx4 v[144:147], v54, s[44:47], s93 offen sc1
    buffer_store_dwordx4 v[148:151], v54, s[44:47], s93 offen offset:1024 sc1
    v_mfma_f32_16x16x32_bf16 v[136:139], a[72:75], a[12:15], v[136:139]
    buffer_store_dwordx2 v[152:153], v5, s[44:47], s93 offen offset:2048 sc1
    s_waitcnt lgkmcnt(2)
    v_mfma_f32_16x16x32_bf16 v[140:143], a[76:79], a[12:15], v[140:143]
    ds_read_b128 a[72:75], v2 offset:27648
    v_cvt_pk_bf16_f32 v156, v104, v105
    v_cvt_pk_bf16_f32 v157, v106, v107
    v_mfma_f32_16x16x32_bf16 v[100:103], a[76:79], a[8:11], v[100:103]
    v_cvt_pk_bf16_f32 v158, v108, v109
    v_cvt_pk_bf16_f32 v159, v110, v111
    s_waitcnt lgkmcnt(2)
    v_mfma_f32_16x16x32_bf16 v[84:87], a[64:67], a[16:19], v[84:87]
    ds_read_b128 a[76:79], v2 offset:28672
    v_cvt_pk_bf16_f32 v160, v112, v113
    v_mfma_f32_16x16x32_bf16 v[124:127], a[64:67], a[20:23], v[124:127]
    v_cvt_pk_bf16_f32 v161, v114, v115
    v_cvt_pk_bf16_f32 v162, v116, v117
    s_waitcnt lgkmcnt(2)
    v_mfma_f32_16x16x32_bf16 v[128:131], a[68:71], a[20:23], v[128:131]
    ds_read_b128 a[64:67], v2 offset:29696
    v_cvt_pk_bf16_f32 v163, v118, v119
    v_mfma_f32_16x16x32_bf16 v[88:91], a[68:71], a[16:19], v[88:91]
    v_cvt_pk_bf16_f32 v164, v120, v121
    v_cvt_pk_bf16_f32 v165, v122, v123
    s_waitcnt lgkmcnt(2)
    v_mfma_f32_16x16x32_bf16 v[92:95], a[72:75], a[16:19], v[92:95]
    ds_read_b128 a[68:71], v2 offset:35840
    v_min_u32_e64 v156, -2, v156
    v_mfma_f32_16x16x32_bf16 v[132:135], a[72:75], a[20:23], v[132:135]
    v_min_u32_e64 v157, -2, v157
    v_min_u32 v158, -2, v158
    s_waitcnt lgkmcnt(2)
    v_mfma_f32_16x16x32_bf16 v[136:139], a[76:79], a[20:23], v[136:139]
    ds_read_b128 a[72:75], v2 offset:36864
    v_min_u32_e64 v159, -2, v159
    v_mfma_f32_16x16x32_bf16 v[96:99], a[76:79], a[16:19], v[96:99]
    v_min_u32_e64 v160, -2, v160
    v_min_u32 v161, -2, v161
    s_waitcnt lgkmcnt(2)
    v_mfma_f32_16x16x32_bf16 v[100:103], a[64:67], a[16:19], v[100:103]
    ds_read_b128 a[76:79], v2 offset:37888
    v_min_u32_e64 v162, -2, v162
    v_mfma_f32_16x16x32_bf16 v[140:143], a[64:67], a[20:23], v[140:143]
    v_min_u32_e64 v163, -2, v163
    v_min_u32 v164, -2, v164
    s_waitcnt lgkmcnt(2)
    v_mfma_f32_16x16x32_bf16 v[124:127], a[68:71], a[28:31], v[124:127]
    ds_read_b128 a[64:67], v2 offset:38912
    v_min_u32 v165, -2, v165
    v_mfma_f32_16x16x32_bf16 v[84:87], a[68:71], a[24:27], v[84:87]
    buffer_store_dwordx4 v[156:159], v54, s[44:47], s61 offen sc1
    buffer_store_dwordx4 v[160:163], v54, s[44:47], s61 offen offset:1024 sc1
    s_waitcnt lgkmcnt(2)
    v_mfma_f32_16x16x32_bf16 v[88:91], a[72:75], a[24:27], v[88:91]
    ds_read_b128 a[68:71], v2 offset:39936
    buffer_store_dwordx2 v[164:165], v5, s[44:47], s61 offen offset:2048 sc1
    v_mfma_f32_16x16x32_bf16 v[128:131], a[72:75], a[28:31], v[128:131]
    s_waitcnt lgkmcnt(2)
    v_mfma_f32_16x16x32_bf16 v[132:135], a[76:79], a[28:31], v[132:135]
    ds_read_b128 a[72:75], v3 offset:5120
    v_mfma_f32_16x16x32_bf16 v[92:95], a[76:79], a[24:27], v[92:95]
    s_waitcnt lgkmcnt(2)
    v_mfma_f32_16x16x32_bf16 v[96:99], a[64:67], a[24:27], v[96:99]
    ds_read_b128 a[76:79], v3 offset:6144
    v_mfma_f32_16x16x32_bf16 v[136:139], a[64:67], a[28:31], v[136:139]
    s_waitcnt lgkmcnt(2)
    v_mfma_f32_16x16x32_bf16 v[140:143], a[68:71], a[28:31], v[140:143]
    ds_read_b128 a[64:67], v3 offset:7168
    v_mfma_f32_16x16x32_bf16 v[100:103], a[68:71], a[24:27], v[100:103]
    s_waitcnt lgkmcnt(2)
    v_mfma_f32_16x16x32_bf16 v[84:87], a[72:75], a[32:35], v[84:87]
    ds_read_b128 a[68:71], v3 offset:8192
    v_mfma_f32_16x16x32_bf16 v[124:127], a[72:75], a[36:39], v[124:127]
    s_waitcnt lgkmcnt(2)
    v_mfma_f32_16x16x32_bf16 v[128:131], a[76:79], a[36:39], v[128:131]
    ds_read_b128 a[72:75], v3 offset:9216
    v_mfma_f32_16x16x32_bf16 v[88:91], a[76:79], a[32:35], v[88:91]
    s_waitcnt lgkmcnt(2)
    v_mfma_f32_16x16x32_bf16 v[92:95], a[64:67], a[32:35], v[92:95]
    ds_read_b128 a[76:79], v3 offset:15360
    v_mfma_f32_16x16x32_bf16 v[132:135], a[64:67], a[36:39], v[132:135]
    s_waitcnt lgkmcnt(2)
    v_mfma_f32_16x16x32_bf16 v[136:139], a[68:71], a[36:39], v[136:139]
    ds_read_b128 a[64:67], v3 offset:16384
    v_mfma_f32_16x16x32_bf16 v[96:99], a[68:71], a[32:35], v[96:99]
    s_waitcnt lgkmcnt(2)
    v_mfma_f32_16x16x32_bf16 v[100:103], a[72:75], a[32:35], v[100:103]
    ds_read_b128 a[68:71], v3 offset:17408
    v_mfma_f32_16x16x32_bf16 v[140:143], a[72:75], a[36:39], v[140:143]
    s_waitcnt lgkmcnt(2)
    v_mfma_f32_16x16x32_bf16 v[124:127], a[76:79], a[44:47], v[124:127]
    ds_read_b128 a[72:75], v3 offset:18432
    v_mfma_f32_16x16x32_bf16 v[84:87], a[76:79], a[40:43], v[84:87]
    s_waitcnt lgkmcnt(2)
    v_mfma_f32_16x16x32_bf16 v[88:91], a[64:67], a[40:43], v[88:91]
    ds_read_b128 a[76:79], v3 offset:19456
    v_mfma_f32_16x16x32_bf16 v[128:131], a[64:67], a[44:47], v[128:131]
    s_waitcnt lgkmcnt(2)
    v_mfma_f32_16x16x32_bf16 v[132:135], a[68:71], a[44:47], v[132:135]
    v_mfma_f32_16x16x32_bf16 v[92:95], a[68:71], a[40:43], v[92:95]
    s_waitcnt lgkmcnt(1)
    v_mfma_f32_16x16x32_bf16 v[96:99], a[72:75], a[40:43], v[96:99]
    v_mfma_f32_16x16x32_bf16 v[136:139], a[72:75], a[44:47], v[136:139]
    s_waitcnt lgkmcnt(0)
    v_mfma_f32_16x16x32_bf16 v[140:143], a[76:79], a[44:47], v[140:143]
    v_mfma_f32_16x16x32_bf16 v[100:103], a[76:79], a[40:43], v[100:103]
    s_nop 1
    v_cvt_pk_bf16_f32 v144, v84, v85
    v_cvt_pk_bf16_f32 v145, v86, v87
    v_cvt_pk_bf16_f32 v146, v88, v89
    v_cvt_pk_bf16_f32 v147, v90, v91
    v_cvt_pk_bf16_f32 v148, v92, v93
    v_cvt_pk_bf16_f32 v149, v94, v95
    v_cvt_pk_bf16_f32 v150, v96, v97
    v_cvt_pk_bf16_f32 v151, v98, v99
    v_cvt_pk_bf16_f32 v152, v100, v101
    v_cvt_pk_bf16_f32 v153, v102, v103
    v_min_u32 v144, -2, v144
    v_min_u32 v145, -2, v145
    v_min_u32 v146, -2, v146
    v_min_u32 v147, -2, v147
    v_min_u32 v148, -2, v148
    v_min_u32 v149, -2, v149
    v_min_u32 v150, -2, v150
    v_min_u32 v151, -2, v151
    v_min_u32 v152, -2, v152
    v_min_u32 v153, -2, v153
    buffer_store_dwordx4 v[144:147], v54, s[44:47], s62 offen sc1
    buffer_store_dwordx4 v[148:151], v54, s[44:47], s62 offen offset:1024 sc1
    buffer_store_dwordx2 v[152:153], v5, s[44:47], s62 offen offset:2048 sc1
    v_cvt_pk_bf16_f32 v156, v124, v125
    v_cvt_pk_bf16_f32 v157, v126, v127
    v_cvt_pk_bf16_f32 v158, v128, v129
    v_cvt_pk_bf16_f32 v159, v130, v131
    v_cvt_pk_bf16_f32 v160, v132, v133
    v_cvt_pk_bf16_f32 v161, v134, v135
    v_cvt_pk_bf16_f32 v162, v136, v137
    v_cvt_pk_bf16_f32 v163, v138, v139
    v_cvt_pk_bf16_f32 v164, v140, v141
    v_cvt_pk_bf16_f32 v165, v142, v143
    v_min_u32 v156, -2, v156
    v_min_u32 v157, -2, v157
    v_min_u32 v158, -2, v158
    v_min_u32 v159, -2, v159
    v_min_u32 v160, -2, v160
    v_min_u32 v161, -2, v161
    v_min_u32 v162, -2, v162
    v_min_u32 v163, -2, v163
    v_min_u32 v164, -2, v164
    v_min_u32 v165, -2, v165
    buffer_store_dwordx4 v[156:159], v54, s[44:47], s63 offen sc1
    buffer_store_dwordx4 v[160:163], v54, s[44:47], s63 offen offset:1024 sc1
    buffer_store_dwordx2 v[164:165], v5, s[44:47], s63 offen offset:2048 sc1
    s_cmp_lg_u32 s48, s53
    s_cbranch_scc1 p1_no1
    ds_write_b128 v6, v[64:67] offset:0
    ds_write_b128 v6, v[68:71] offset:1024
    ds_write_b128 v6, v[72:75] offset:2048
    ds_write_b128 v6, v[76:79] offset:3072
    ds_write_b128 v6, v[80:83] offset:4096
    ds_write_b128 v6, v[84:87] offset:5120
    ds_write_b128 v6, v[88:91] offset:6144
    ds_write_b128 v6, v[92:95] offset:7168
    ds_write_b128 v6, v[96:99] offset:8192
    ds_write_b128 v6, v[100:103] offset:9216
    ds_write_b128 v6, v[104:107] offset:10240
    ds_write_b128 v6, v[108:111] offset:11264
    ds_write_b128 v6, v[112:115] offset:12288
    ds_write_b128 v6, v[116:119] offset:13312
    ds_write_b128 v6, v[120:123] offset:14336
    ds_write_b128 v6, v[124:127] offset:15360
    ds_write_b128 v6, v[128:131] offset:16384
    ds_write_b128 v6, v[132:135] offset:17408
    ds_write_b128 v6, v[136:139] offset:18432
    ds_write_b128 v6, v[140:143] offset:19456
    s_waitcnt lgkmcnt(0)
p1_no1:
    s_mul_i32 s61, s48, 5120
    v_add_u32 v6, s61, v6
    s_mul_i32 s61, s53, 30720
    s_mul_i32 s62, s48, 2560
    s_add_u32 s61, s61, s62
    s_lshl_b32 s6, s53, 3
    s_lshr_b32 s6, 0x24091824, s6
    s_bfe_u32 s7, s6, 0x20000
    s_mul_i32 s7, s7, 10240
    s_add_u32 s24, s61, s7
    s_bfe_u32 s7, s6, 0x20002
    s_mul_i32 s7, s7, 10240
    s_add_u32 s25, s61, s7
    s_bfe_u32 s7, s6, 0x20004
    s_mul_i32 s7, s7, 10240
    s_add_u32 s26, s61, s7
    s_barrier
    buffer_load_dwordx4 v[104:107], v54, s[44:47], s24 offen sc1
    buffer_load_dwordx4 v[108:111], v54, s[44:47], s24 offen offset:1024 sc1
    buffer_load_dwordx2 v[112:113], v5, s[44:47], s24 offen offset:2048 sc1
    buffer_load_dwordx4 v[114:117], v54, s[44:47], s25 offen sc1
    buffer_load_dwordx4 v[118:121], v54, s[44:47], s25 offen offset:1024 sc1
    buffer_load_dwordx2 v[122:123], v5, s[44:47], s25 offen offset:2048 sc1
    buffer_load_dwordx4 v[124:127], v54, s[44:47], s26 offen sc1
    buffer_load_dwordx4 v[128:131], v54, s[44:47], s26 offen offset:1024 sc1
    buffer_load_dwordx2 v[132:133], v5, s[44:47], s26 offen offset:2048 sc1
    ds_read_b128 v[64:67], v6 offset:0
    ds_read_b128 v[68:71], v6 offset:1024
    ds_read_b128 v[72:75], v6 offset:2048
    ds_read_b128 v[76:79], v6 offset:3072
    ds_read_b128 v[80:83], v6 offset:4096
    v_accvgpr_read_b32 v168, a96
    v_accvgpr_read_b32 v169, a97
    v_accvgpr_read_b32 v170, a98
    v_accvgpr_read_b32 v171, a99
    v_accvgpr_read_b32 v172, a100
    v_accvgpr_read_b32 v173, a101
    v_accvgpr_read_b32 v174, a102
    v_accvgpr_read_b32 v175, a103
    v_accvgpr_read_b32 v176, a104
    v_accvgpr_read_b32 v177, a105
    v_lshlrev_b32_e64 v184, 16, v168
    v_and_b32 v185, 0xffff0000, v168
    v_lshlrev_b32_e64 v186, 16, v169
    v_and_b32 v187, 0xffff0000, v169
    v_lshlrev_b32_e64 v188, 16, v170
    v_and_b32 v189, 0xffff0000, v170
    v_lshlrev_b32_e64 v190, 16, v171
    v_and_b32 v191, 0xffff0000, v171
    v_lshlrev_b32_e64 v192, 16, v172
    v_and_b32 v193, 0xffff0000, v172
    v_lshlrev_b32_e64 v194, 16, v173
    v_and_b32 v195, 0xffff0000, v173
    v_lshlrev_b32_e64 v196, 16, v174
    v_and_b32 v197, 0xffff0000, v174
    v_lshlrev_b32_e64 v198, 16, v175
    v_and_b32 v199, 0xffff0000, v175
    v_lshlrev_b32_e64 v200, 16, v176
    v_and_b32 v201, 0xffff0000, v176
    v_lshlrev_b32_e64 v202, 16, v177
    v_and_b32 v203, 0xffff0000, v177
    s_mov_b32 s61, 0xbfb8aa3b
    s_mov_b32 s62, 0
    s_mov_b32 s63, 7
    s_cmp_lg_u32 s53, 3
    s_waitcnt lgkmcnt(0)
    s_cbranch_scc1 p1_sc
    v_mul_f32 v204, s61, v64
    v_mul_f32 v205, s61, v65
    v_mul_f32 v206, s61, v66
    v_mul_f32 v207, s61, v67
    v_mul_f32 v208, s61, v68
    v_mul_f32 v209, s61, v69
    v_mul_f32 v210, s61, v70
    v_mul_f32 v211, s61, v71
    v_mul_f32 v212, s61, v72
    v_mul_f32 v213, s61, v73
    v_mul_f32 v214, s61, v74
    v_mul_f32 v215, s61, v75
    v_mul_f32 v216, s61, v76
    v_mul_f32 v217, s61, v77
    v_mul_f32 v218, s61, v78
    v_mul_f32 v219, s61, v79
    v_mul_f32 v220, s61, v80
    v_mul_f32 v221, s61, v81
    v_mul_f32 v222, s61, v82
    v_mul_f32 v223, s61, v83
    v_exp_f32 v204, v204
    v_exp_f32 v205, v205
    v_exp_f32 v206, v206
    v_exp_f32 v207, v207
    v_exp_f32 v208, v208
    v_exp_f32 v209, v209
    v_exp_f32 v210, v210
    v_exp_f32 v211, v211
    v_exp_f32 v212, v212
    v_exp_f32 v213, v213
    v_exp_f32 v214, v214
    v_exp_f32 v215, v215
    v_exp_f32 v216, v216
    v_exp_f32 v217, v217
    v_exp_f32 v218, v218
    v_exp_f32 v219, v219
    v_exp_f32 v220, v220
    v_exp_f32 v221, v221
    v_exp_f32 v222, v222
    v_exp_f32 v223, v223
    v_add_f32 v204, 1.0, v204
    v_add_f32 v205, 1.0, v205
    v_add_f32 v206, 1.0, v206
    v_add_f32 v207, 1.0, v207
    v_add_f32 v208, 1.0, v208
    v_add_f32 v209, 1.0, v209
    v_add_f32 v210, 1.0, v210
    v_add_f32 v211, 1.0, v211
    v_add_f32 v212, 1.0, v212
    v_add_f32 v213, 1.0, v213
    v_add_f32 v214, 1.0, v214
    v_add_f32 v215, 1.0, v215
    v_add_f32 v216, 1.0, v216
    v_add_f32 v217, 1.0, v217
    v_add_f32 v218, 1.0, v218
    v_add_f32 v219, 1.0, v219
    v_add_f32 v220, 1.0, v220
    v_add_f32 v221, 1.0, v221
    v_add_f32 v222, 1.0, v222
    v_add_f32 v223, 1.0, v223
    v_rcp_f32 v204, v204
    v_rcp_f32 v205, v205
    v_rcp_f32 v206, v206
    v_rcp_f32 v207, v207
    v_rcp_f32 v208, v208
    v_rcp_f32 v209, v209
    v_rcp_f32 v210, v210
    v_rcp_f32 v211, v211
    v_rcp_f32 v212, v212
    v_rcp_f32 v213, v213
    v_rcp_f32 v214, v214
    v_rcp_f32 v215, v215
    v_rcp_f32 v216, v216
    v_rcp_f32 v217, v217
    v_rcp_f32 v218, v218
    v_rcp_f32 v219, v219
    v_rcp_f32 v220, v220
    v_rcp_f32 v221, v221
    v_rcp_f32 v222, v222
    v_rcp_f32 v223, v223
    s_nop 0
    v_pk_mul_f32 v[84:85], v[64:65], v[204:205]
    v_pk_mul_f32 v[86:87], v[66:67], v[206:207]
    v_pk_mul_f32 v[88:89], v[68:69], v[208:209]
    v_pk_mul_f32 v[90:91], v[70:71], v[210:211]
    v_pk_mul_f32 v[92:93], v[72:73], v[212:213]
    v_pk_mul_f32 v[94:95], v[74:75], v[214:215]
    v_pk_mul_f32 v[96:97], v[76:77], v[216:217]
    v_pk_mul_f32 v[98:99], v[78:79], v[218:219]
    v_pk_mul_f32 v[100:101], v[80:81], v[220:221]
    v_pk_mul_f32 v[102:103], v[82:83], v[222:223]
p1_sc:
    s_waitcnt vmcnt(0)
    s_bitcmp1_b32 s63, 2
    s_cbranch_scc0 p1_sn2
    v_max3_u32 v154, v124, v125, v126
    v_max3_u32 v155, v127, v128, v129
    v_max3_u32 v154, v154, v130, v131
    v_max3_u32 v155, v155, v132, v133
    v_max_u32 v154, v154, v155
    v_cmp_eq_u32_e64 vcc, -1, v154
    s_cmp_ge_u32 s62, 0x40000
    s_cbranch_scc1 p1_sy2
    s_nop 1
    s_cbranch_vccnz p1_sm2
p1_sy2:
    s_bitset0_b32 s63, 2
    s_cmp_eq_u32 s53, 3
    s_cbranch_scc1 p1_s3
    v_lshlrev_b32_e64 v84, 16, v124
    v_and_b32 v85, 0xffff0000, v124
    v_lshlrev_b32_e64 v86, 16, v125
    v_and_b32 v87, 0xffff0000, v125
    v_lshlrev_b32_e64 v88, 16, v126
    v_and_b32 v89, 0xffff0000, v126
    v_lshlrev_b32_e64 v90, 16, v127
    v_and_b32 v91, 0xffff0000, v127
    v_lshlrev_b32_e64 v92, 16, v128
    v_and_b32 v93, 0xffff0000, v128
    v_lshlrev_b32_e64 v94, 16, v129
    v_and_b32 v95, 0xffff0000, v129
    v_lshlrev_b32_e64 v96, 16, v130
    v_and_b32 v97, 0xffff0000, v130
    v_lshlrev_b32_e64 v98, 16, v131
    v_and_b32 v99, 0xffff0000, v131
    v_lshlrev_b32_e64 v100, 16, v132
    v_and_b32 v101, 0xffff0000, v132
    v_lshlrev_b32_e64 v102, 16, v133
    v_and_b32 v103, 0xffff0000, v133
    v_mul_f32 v204, s61, v84
    v_mul_f32 v205, s61, v85
    v_mul_f32 v206, s61, v86
    v_mul_f32 v207, s61, v87
    v_mul_f32 v208, s61, v88
    v_mul_f32 v209, s61, v89
    v_mul_f32 v210, s61, v90
    v_mul_f32 v211, s61, v91
    v_mul_f32 v212, s61, v92
    v_mul_f32 v213, s61, v93
    v_mul_f32 v214, s61, v94
    v_mul_f32 v215, s61, v95
    v_mul_f32 v216, s61, v96
    v_mul_f32 v217, s61, v97
    v_mul_f32 v218, s61, v98
    v_mul_f32 v219, s61, v99
    v_mul_f32 v220, s61, v100
    v_mul_f32 v221, s61, v101
    v_mul_f32 v222, s61, v102
    v_mul_f32 v223, s61, v103
    v_exp_f32 v204, v204
    v_exp_f32 v205, v205
    v_exp_f32 v206, v206
    v_exp_f32 v207, v207
    v_exp_f32 v208, v208
    v_exp_f32 v209, v209
    v_exp_f32 v210, v210
    v_exp_f32 v211, v211
    v_exp_f32 v212, v212
    v_exp_f32 v213, v213
    v_exp_f32 v214, v214
    v_exp_f32 v215, v215
    v_exp_f32 v216, v216
    v_exp_f32 v217, v217
    v_exp_f32 v218, v218
    v_exp_f32 v219, v219
    v_exp_f32 v220, v220
    v_exp_f32 v221, v221
    v_exp_f32 v222, v222
    v_exp_f32 v223, v223
    v_add_f32 v204, 1.0, v204
    v_add_f32 v205, 1.0, v205
    v_add_f32 v206, 1.0, v206
    v_add_f32 v207, 1.0, v207
    v_add_f32 v208, 1.0, v208
    v_add_f32 v209, 1.0, v209
    v_add_f32 v210, 1.0, v210
    v_add_f32 v211, 1.0, v211
    v_add_f32 v212, 1.0, v212
    v_add_f32 v213, 1.0, v213
    v_add_f32 v214, 1.0, v214
    v_add_f32 v215, 1.0, v215
    v_add_f32 v216, 1.0, v216
    v_add_f32 v217, 1.0, v217
    v_add_f32 v218, 1.0, v218
    v_add_f32 v219, 1.0, v219
    v_add_f32 v220, 1.0, v220
    v_add_f32 v221, 1.0, v221
    v_add_f32 v222, 1.0, v222
    v_add_f32 v223, 1.0, v223
    v_rcp_f32 v204, v204
    v_rcp_f32 v205, v205
    v_rcp_f32 v206, v206
    v_rcp_f32 v207, v207
    v_rcp_f32 v208, v208
    v_rcp_f32 v209, v209
    v_rcp_f32 v210, v210
    v_rcp_f32 v211, v211
    v_rcp_f32 v212, v212
    v_rcp_f32 v213, v213
    v_rcp_f32 v214, v214
    v_rcp_f32 v215, v215
    v_rcp_f32 v216, v216
    v_rcp_f32 v217, v217
    v_rcp_f32 v218, v218
    v_rcp_f32 v219, v219
    v_rcp_f32 v220, v220
    v_rcp_f32 v221, v221
    v_rcp_f32_e64 v222, v222
    v_rcp_f32 v223, v223
    s_nop 0
    v_pk_mul_f32 v[84:85], v[84:85], v[204:205]
    v_pk_mul_f32 v[86:87], v[86:87], v[206:207]
    v_pk_mul_f32 v[88:89], v[88:89], v[208:209]
    v_pk_mul_f32 v[90:91], v[90:91], v[210:211]
    v_pk_mul_f32 v[92:93], v[92:93], v[212:213]
    v_pk_mul_f32 v[94:95], v[94:95], v[214:215]
    v_pk_mul_f32 v[96:97], v[96:97], v[216:217]
    v_pk_mul_f32 v[98:99], v[98:99], v[218:219]
    v_pk_mul_f32 v[100:101], v[100:101], v[220:221]
    v_pk_mul_f32 v[102:103], v[102:103], v[222:223]
    s_branch p1_sn2
p1_s3:
    v_lshlrev_b32 v64, 16, v124
    v_and_b32 v65, 0xffff0000, v124
    v_lshlrev_b32_e64 v66, 16, v125
    v_and_b32 v67, 0xffff0000, v125
    v_lshlrev_b32_e64 v68, 16, v126
    v_and_b32 v69, 0xffff0000, v126
    v_lshlrev_b32_e64 v70, 16, v127
    v_and_b32 v71, 0xffff0000, v127
    v_lshlrev_b32_e64 v72, 16, v128
    v_and_b32 v73, 0xffff0000, v128
    v_lshlrev_b32_e64 v74, 16, v129
    v_and_b32 v75, 0xffff0000, v129
    v_lshlrev_b32_e64 v76, 16, v130
    v_and_b32 v77, 0xffff0000, v130
    v_lshlrev_b32_e64 v78, 16, v131
    v_and_b32 v79, 0xffff0000, v131
    v_lshlrev_b32_e64 v80, 16, v132
    v_and_b32 v81, 0xffff0000, v132
    v_lshlrev_b32 v82, 16, v133
    v_and_b32 v83, 0xffff0000, v133
    s_branch p1_sn2
p1_sm2:
    buffer_load_dwordx4 v[124:127], v54, s[44:47], s26 offen sc1
    buffer_load_dwordx4 v[128:131], v54, s[44:47], s26 offen offset:1024 sc1
    buffer_load_dwordx2 v[132:133], v5, s[44:47], s26 offen offset:2048 sc1
p1_sn2:
    s_bitcmp1_b32 s63, 0
    s_cbranch_scc0 p1_sn0
    v_max3_u32 v154, v104, v105, v106
    v_max3_u32 v155, v107, v108, v109
    v_max3_u32 v154, v154, v110, v111
    v_max3_u32 v155, v155, v112, v113
    v_max_u32 v154, v154, v155
    v_cmp_eq_u32 vcc, -1, v154
    s_cmp_ge_u32 s62, 0x40000
    s_cbranch_scc1 p1_sy0
    s_nop 1
    s_cbranch_vccnz p1_sm0
p1_sy0:
    s_bitset0_b32 s63, 0
    v_lshlrev_b32_e64 v134, 16, v104
    v_and_b32 v135, 0xffff0000, v104
    v_lshlrev_b32_e64 v136, 16, v105
    v_and_b32 v137, 0xffff0000, v105
    v_lshlrev_b32_e64 v138, 16, v106
    v_and_b32 v139, 0xffff0000, v106
    v_lshlrev_b32_e64 v140, 16, v107
    v_and_b32 v141, 0xffff0000, v107
    v_lshlrev_b32_e64 v142, 16, v108
    v_and_b32 v143, 0xffff0000, v108
    v_lshlrev_b32_e64 v144, 16, v109
    v_and_b32 v145, 0xffff0000, v109
    v_lshlrev_b32_e64 v146, 16, v110
    v_and_b32 v147, 0xffff0000, v110
    v_lshlrev_b32_e64 v148, 16, v111
    v_and_b32 v149, 0xffff0000, v111
    v_lshlrev_b32_e64 v150, 16, v112
    v_and_b32 v151, 0xffff0000, v112
    v_lshlrev_b32 v152, 16, v113
    v_and_b32 v153, 0xffff0000, v113
    s_branch p1_sn0
p1_sm0:
    buffer_load_dwordx4 v[104:107], v54, s[44:47], s24 offen sc1
    buffer_load_dwordx4 v[108:111], v54, s[44:47], s24 offen offset:1024 sc1
    buffer_load_dwordx2 v[112:113], v5, s[44:47], s24 offen offset:2048 sc1
p1_sn0:
    s_bitcmp1_b32 s63, 1
    s_cbranch_scc0 p1_sn1
    v_max3_u32 v154, v114, v115, v116
    v_max3_u32 v155, v117, v118, v119
    v_max3_u32 v154, v154, v120, v121
    v_max3_u32 v155, v155, v122, v123
    v_max_u32 v154, v154, v155
    v_cmp_eq_u32 vcc, -1, v154
    s_cmp_ge_u32 s62, 0x40000
    s_cbranch_scc1 p1_sy1
    s_nop 1
    s_cbranch_vccnz p1_sm1
p1_sy1:
    s_bitset0_b32 s63, 1
    v_lshlrev_b32_e64 v224, 16, v114
    v_and_b32 v225, 0xffff0000, v114
    v_lshlrev_b32_e64 v226, 16, v115
    v_and_b32 v227, 0xffff0000, v115
    v_lshlrev_b32_e64 v228, 16, v116
    v_and_b32 v229, 0xffff0000, v116
    v_lshlrev_b32_e64 v230, 16, v117
    v_and_b32 v231, 0xffff0000, v117
    v_lshlrev_b32_e64 v232, 16, v118
    v_and_b32 v233, 0xffff0000, v118
    v_lshlrev_b32_e64 v234, 16, v119
    v_and_b32 v235, 0xffff0000, v119
    v_lshlrev_b32_e64 v236, 16, v120
    v_and_b32 v237, 0xffff0000, v120
    v_lshlrev_b32_e64 v238, 16, v121
    v_and_b32 v239, 0xffff0000, v121
    v_lshlrev_b32_e64 v240, 16, v122
    v_and_b32 v241, 0xffff0000, v122
    v_lshlrev_b32_e64 v242, 16, v123
    v_and_b32 v243, 0xffff0000, v123
    s_branch p1_sn1
p1_sm1:
    buffer_load_dwordx4 v[114:117], v54, s[44:47], s25 offen sc1
    buffer_load_dwordx4 v[118:121], v54, s[44:47], s25 offen offset:1024 sc1
    buffer_load_dwordx2 v[122:123], v5, s[44:47], s25 offen offset:2048 sc1
p1_sn1:
    s_add_u32 s62, s62, 1
    s_cmp_lg_u32 s63, 0
    s_cbranch_scc1 p1_sc
    v_pk_add_f32 v[64:65], v[64:65], v[134:135]
    v_pk_add_f32 v[66:67], v[66:67], v[136:137]
    v_pk_add_f32 v[68:69], v[68:69], v[138:139]
    v_pk_add_f32 v[70:71], v[70:71], v[140:141]
    v_pk_add_f32 v[72:73], v[72:73], v[142:143]
    v_pk_add_f32 v[74:75], v[74:75], v[144:145]
    v_pk_add_f32 v[76:77], v[76:77], v[146:147]
    v_pk_add_f32 v[78:79], v[78:79], v[148:149]
    v_pk_add_f32 v[80:81], v[80:81], v[150:151]
    v_pk_add_f32 v[82:83], v[82:83], v[152:153]
    v_pk_add_f32 v[64:65], v[64:65], v[224:225]
    v_pk_add_f32 v[66:67], v[66:67], v[226:227]
    v_pk_add_f32 v[68:69], v[68:69], v[228:229]
    v_pk_add_f32 v[70:71], v[70:71], v[230:231]
    v_pk_add_f32 v[72:73], v[72:73], v[232:233]
    v_pk_add_f32 v[74:75], v[74:75], v[234:235]
    v_pk_add_f32 v[76:77], v[76:77], v[236:237]
    v_pk_add_f32 v[78:79], v[78:79], v[238:239]
    v_pk_add_f32 v[80:81], v[80:81], v[240:241]
    v_pk_add_f32 v[82:83], v[82:83], v[242:243]
    v_pk_fma_f32 v[184:185], v[64:65], v[84:85], v[184:185]
    v_pk_fma_f32 v[186:187], v[66:67], v[86:87], v[186:187]
    v_pk_fma_f32 v[188:189], v[68:69], v[88:89], v[188:189]
    v_pk_fma_f32 v[190:191], v[70:71], v[90:91], v[190:191]
    v_pk_fma_f32 v[192:193], v[72:73], v[92:93], v[192:193]
    v_pk_fma_f32 v[194:195], v[74:75], v[94:95], v[194:195]
    v_pk_fma_f32 v[196:197], v[76:77], v[96:97], v[196:197]
    v_pk_fma_f32 v[198:199], v[78:79], v[98:99], v[198:199]
    v_pk_fma_f32 v[200:201], v[80:81], v[100:101], v[200:201]
    v_pk_fma_f32 v[202:203], v[82:83], v[102:103], v[202:203]
    v_cvt_pk_bf16_f32 v168, v184, v185
    v_cvt_pk_bf16_f32 v169, v186, v187
    v_cvt_pk_bf16_f32 v170, v188, v189
    v_cvt_pk_bf16_f32 v171, v190, v191
    v_cvt_pk_bf16_f32 v172, v192, v193
    v_cvt_pk_bf16_f32 v173, v194, v195
    v_cvt_pk_bf16_f32 v174, v196, v197
    v_cvt_pk_bf16_f32 v175, v198, v199
    v_cvt_pk_bf16_f32 v176, v200, v201
    v_cvt_pk_bf16_f32 v177, v202, v203
    buffer_store_dwordx2 v[168:169], v8, s[20:23], s94 offen offset:0
    buffer_store_dwordx2 v[170:171], v8, s[20:23], s94 offen offset:32
    buffer_store_dwordx2 v[172:173], v8, s[20:23], s94 offen offset:64
    buffer_store_dwordx2 v[174:175], v8, s[20:23], s94 offen offset:96
    buffer_store_dwordx2 v[176:177], v8, s[20:23], s94 offen offset:128
p1_end:
    s_endpgm
p1_c1:
    v_lshrrev_b32 v49, 2, v1
    v_and_b32 v57, 3, v1
    v_lshlrev_b32 v57, 4, v57
    s_movk_i32 s6, 1280
    v_mad_u32_u24 v57, v49, s6, v57
    s_lshl2_add_u32 s6, s50, s4
    s_lshl2_add_u32 s6, s6, s48
    s_lshl_b32 s7, s6, 8
    v_lshl_add_u32 v49, v49, 4, s7
    s_mul_i32 s6, s6, 20480
    buffer_load_dwordx4 v[64:67], v57, s[8:11], s6 offen offset:0
    buffer_load_dwordx4 v[68:71], v57, s[8:11], s6 offen offset:64
    buffer_load_dwordx4 v[72:75], v57, s[8:11], s6 offen offset:128
    buffer_load_dwordx4 v[76:79], v57, s[8:11], s6 offen offset:192
    buffer_load_dwordx4 v[80:83], v57, s[8:11], s6 offen offset:256
    buffer_load_dwordx4 v[84:87], v57, s[8:11], s6 offen offset:320
    buffer_load_dwordx4 v[88:91], v57, s[8:11], s6 offen offset:384
    buffer_load_dwordx4 v[92:95], v57, s[8:11], s6 offen offset:448
    buffer_load_dwordx4 v[96:99], v57, s[8:11], s6 offen offset:512
    buffer_load_dwordx4 v[100:103], v57, s[8:11], s6 offen offset:576
    buffer_load_dwordx4 v[104:107], v57, s[8:11], s6 offen offset:640
    buffer_load_dwordx4 v[108:111], v57, s[8:11], s6 offen offset:704
    buffer_load_dwordx4 v[112:115], v57, s[8:11], s6 offen offset:768
    buffer_load_dwordx4 v[116:119], v57, s[8:11], s6 offen offset:832
    buffer_load_dwordx4 v[120:123], v57, s[8:11], s6 offen offset:896
    buffer_load_dwordx4 v[124:127], v57, s[8:11], s6 offen offset:960
    buffer_load_dwordx4 v[128:131], v57, s[8:11], s6 offen offset:1024
    buffer_load_dwordx4 v[132:135], v57, s[8:11], s6 offen offset:1088
    buffer_load_dwordx4 v[136:139], v57, s[8:11], s6 offen offset:1152
    buffer_load_dwordx4 v[140:143], v57, s[8:11], s6 offen offset:1216
    s_branch p1_np1
p1_c2:
    s_waitcnt vmcnt(8)
    v_and_b32 v255, 0xffff0000, v143
    v_lshlrev_b32_e64 v254, 16, v143
    v_and_b32 v253, 0xffff0000, v142
    v_lshlrev_b32_e64 v252, 16, v142
    v_and_b32 v251, 0xffff0000, v141
    v_lshlrev_b32_e64 v250, 16, v141
    v_and_b32 v249, 0xffff0000, v140
    v_lshlrev_b32_e64 v248, 16, v140
    v_and_b32 v247, 0xffff0000, v139
    v_lshlrev_b32_e64 v246, 16, v139
    v_and_b32 v245, 0xffff0000, v138
    v_lshlrev_b32_e64 v244, 16, v138
    v_and_b32 v243, 0xffff0000, v137
    v_lshlrev_b32_e64 v242, 16, v137
    v_and_b32 v241, 0xffff0000, v136
    v_lshlrev_b32_e64 v240, 16, v136
    v_and_b32 v239, 0xffff0000, v135
    v_lshlrev_b32_e64 v238, 16, v135
    v_and_b32 v237, 0xffff0000, v134
    v_lshlrev_b32_e64 v236, 16, v134
    v_and_b32 v235, 0xffff0000, v133
    v_lshlrev_b32_e64 v234, 16, v133
    v_and_b32 v233, 0xffff0000, v132
    v_lshlrev_b32_e64 v232, 16, v132
    v_and_b32 v231, 0xffff0000, v131
    v_lshlrev_b32_e64 v230, 16, v131
    v_and_b32 v229, 0xffff0000, v130
    v_lshlrev_b32_e64 v228, 16, v130
    v_and_b32 v227, 0xffff0000, v129
    v_lshlrev_b32_e64 v226, 16, v129
    v_and_b32 v225, 0xffff0000, v128
    v_lshlrev_b32_e64 v224, 16, v128
    v_and_b32 v223, 0xffff0000, v127
    v_lshlrev_b32_e64 v222, 16, v127
    v_and_b32 v221, 0xffff0000, v126
    v_lshlrev_b32_e64 v220, 16, v126
    v_and_b32 v219, 0xffff0000, v125
    v_lshlrev_b32_e64 v218, 16, v125
    v_and_b32 v217, 0xffff0000, v124
    v_lshlrev_b32_e64 v216, 16, v124
    v_and_b32 v215, 0xffff0000, v123
    v_lshlrev_b32_e64 v214, 16, v123
    v_and_b32 v213, 0xffff0000, v122
    v_lshlrev_b32_e64 v212, 16, v122
    v_and_b32 v211, 0xffff0000, v121
    v_lshlrev_b32_e64 v210, 16, v121
    v_and_b32 v209, 0xffff0000, v120
    v_lshlrev_b32_e64 v208, 16, v120
    v_and_b32 v207, 0xffff0000, v119
    v_lshlrev_b32_e64 v206, 16, v119
    v_and_b32 v205, 0xffff0000, v118
    v_lshlrev_b32_e64 v204, 16, v118
    v_and_b32 v203, 0xffff0000, v117
    v_lshlrev_b32_e64 v202, 16, v117
    v_and_b32 v201, 0xffff0000, v116
    v_lshlrev_b32_e64 v200, 16, v116
    v_and_b32 v199, 0xffff0000, v115
    v_lshlrev_b32_e64 v198, 16, v115
    v_and_b32 v197, 0xffff0000, v114
    v_lshlrev_b32_e64 v196, 16, v114
    v_and_b32 v195, 0xffff0000, v113
    v_lshlrev_b32_e64 v194, 16, v113
    v_and_b32 v193, 0xffff0000, v112
    v_lshlrev_b32_e64 v192, 16, v112
    v_and_b32 v191, 0xffff0000, v111
    v_lshlrev_b32_e64 v190, 16, v111
    v_and_b32 v189, 0xffff0000, v110
    v_lshlrev_b32_e64 v188, 16, v110
    v_and_b32 v187, 0xffff0000, v109
    v_lshlrev_b32_e64 v186, 16, v109
    v_and_b32 v185, 0xffff0000, v108
    v_lshlrev_b32_e64 v184, 16, v108
    v_and_b32 v183, 0xffff0000, v107
    v_lshlrev_b32_e64 v182, 16, v107
    v_and_b32 v181, 0xffff0000, v106
    v_lshlrev_b32_e64 v180, 16, v106
    v_and_b32 v179, 0xffff0000, v105
    v_lshlrev_b32_e64 v178, 16, v105
    v_and_b32 v177, 0xffff0000, v104
    v_lshlrev_b32_e64 v176, 16, v104
    v_and_b32 v175, 0xffff0000, v103
    v_lshlrev_b32_e64 v174, 16, v103
    v_and_b32 v173, 0xffff0000, v102
    v_lshlrev_b32_e64 v172, 16, v102
    v_and_b32 v171, 0xffff0000, v101
    v_lshlrev_b32_e64 v170, 16, v101
    v_and_b32 v169, 0xffff0000, v100
    v_lshlrev_b32_e64 v168, 16, v100
    v_and_b32 v167, 0xffff0000, v99
    v_lshlrev_b32_e64 v166, 16, v99
    v_and_b32 v165, 0xffff0000, v98
    v_lshlrev_b32_e64 v164, 16, v98
    v_and_b32 v163, 0xffff0000, v97
    v_lshlrev_b32_e64 v162, 16, v97
    v_and_b32 v161, 0xffff0000, v96
    v_lshlrev_b32_e64 v160, 16, v96
    v_and_b32 v159, 0xffff0000, v95
    v_lshlrev_b32_e64 v158, 16, v95
    v_and_b32 v157, 0xffff0000, v94
    v_lshlrev_b32_e64 v156, 16, v94
    v_and_b32 v155, 0xffff0000, v93
    v_lshlrev_b32_e64 v154, 16, v93
    v_and_b32 v153, 0xffff0000, v92
    v_lshlrev_b32_e64 v152, 16, v92
    v_and_b32 v151, 0xffff0000, v91
    v_lshlrev_b32_e64 v150, 16, v91
    v_and_b32 v149, 0xffff0000, v90
    v_lshlrev_b32_e64 v148, 16, v90
    v_and_b32 v147, 0xffff0000, v89
    v_lshlrev_b32_e64 v146, 16, v89
    v_and_b32 v145, 0xffff0000, v88
    v_lshlrev_b32_e64 v144, 16, v88
    v_and_b32 v143, 0xffff0000, v87
    v_lshlrev_b32_e64 v142, 16, v87
    v_and_b32 v141, 0xffff0000, v86
    v_lshlrev_b32_e64 v140, 16, v86
    v_and_b32 v139, 0xffff0000, v85
    v_lshlrev_b32_e64 v138, 16, v85
    v_and_b32 v137, 0xffff0000, v84
    v_lshlrev_b32_e64 v136, 16, v84
    v_and_b32 v135, 0xffff0000, v83
    v_lshlrev_b32_e64 v134, 16, v83
    v_and_b32 v133, 0xffff0000, v82
    v_lshlrev_b32_e64 v132, 16, v82
    v_and_b32 v131, 0xffff0000, v81
    v_lshlrev_b32_e64 v130, 16, v81
    v_and_b32 v129, 0xffff0000, v80
    v_lshlrev_b32_e64 v128, 16, v80
    v_and_b32 v127, 0xffff0000, v79
    v_lshlrev_b32_e64 v126, 16, v79
    v_and_b32 v125, 0xffff0000, v78
    v_lshlrev_b32_e64 v124, 16, v78
    v_and_b32 v123, 0xffff0000, v77
    v_lshlrev_b32_e64 v122, 16, v77
    v_and_b32 v121, 0xffff0000, v76
    v_lshlrev_b32_e64 v120, 16, v76
    v_and_b32 v119, 0xffff0000, v75
    v_lshlrev_b32_e64 v118, 16, v75
    v_and_b32 v117, 0xffff0000, v74
    v_lshlrev_b32_e64 v116, 16, v74
    v_and_b32 v115, 0xffff0000, v73
    v_lshlrev_b32_e64 v114, 16, v73
    v_and_b32 v113, 0xffff0000, v72
    v_lshlrev_b32_e64 v112, 16, v72
    v_and_b32 v111, 0xffff0000, v71
    v_lshlrev_b32_e64 v110, 16, v71
    v_and_b32 v109, 0xffff0000, v70
    v_lshlrev_b32_e64 v108, 16, v70
    v_and_b32 v107, 0xffff0000, v69
    v_lshlrev_b32_e64 v106, 16, v69
    v_and_b32 v105, 0xffff0000, v68
    v_lshlrev_b32_e64 v104, 16, v68
    v_and_b32 v103, 0xffff0000, v67
    v_lshlrev_b32_e64 v102, 16, v67
    v_and_b32 v101, 0xffff0000, v66
    v_lshlrev_b32_e64 v100, 16, v66
    v_and_b32 v99, 0xffff0000, v65
    v_lshlrev_b32_e64 v98, 16, v65
    v_and_b32 v97, 0xffff0000, v64
    v_lshlrev_b32_e64 v96, 16, v64
    v_pk_add_f32 v[64:65], v[96:97], v[104:105]
    v_pk_add_f32 v[66:67], v[98:99], v[106:107]
    v_pk_add_f32 v[68:69], v[100:101], v[108:109]
    v_pk_add_f32 v[70:71], v[102:103], v[110:111]
    v_pk_add_f32 v[64:65], v[64:65], v[112:113]
    v_pk_add_f32 v[66:67], v[66:67], v[114:115]
    v_pk_add_f32 v[68:69], v[68:69], v[116:117]
    v_pk_add_f32 v[70:71], v[70:71], v[118:119]
    v_pk_add_f32 v[64:65], v[64:65], v[120:121]
    v_pk_add_f32 v[66:67], v[66:67], v[122:123]
    v_pk_add_f32 v[68:69], v[68:69], v[124:125]
    v_pk_add_f32 v[70:71], v[70:71], v[126:127]
    v_pk_add_f32 v[64:65], v[64:65], v[128:129]
    v_pk_add_f32 v[66:67], v[66:67], v[130:131]
    v_pk_add_f32 v[68:69], v[68:69], v[132:133]
    v_pk_add_f32 v[70:71], v[70:71], v[134:135]
    v_pk_add_f32 v[64:65], v[64:65], v[136:137]
    v_pk_add_f32 v[66:67], v[66:67], v[138:139]
    v_pk_add_f32 v[68:69], v[68:69], v[140:141]
    v_pk_add_f32 v[70:71], v[70:71], v[142:143]
    v_pk_add_f32 v[64:65], v[64:65], v[144:145]
    v_pk_add_f32 v[66:67], v[66:67], v[146:147]
    v_pk_add_f32 v[68:69], v[68:69], v[148:149]
    v_pk_add_f32 v[70:71], v[70:71], v[150:151]
    v_pk_add_f32 v[64:65], v[64:65], v[152:153]
    v_pk_add_f32 v[66:67], v[66:67], v[154:155]
    v_pk_add_f32 v[68:69], v[68:69], v[156:157]
    v_pk_add_f32 v[70:71], v[70:71], v[158:159]
    v_pk_add_f32 v[64:65], v[64:65], v[160:161]
    v_pk_add_f32 v[66:67], v[66:67], v[162:163]
    v_pk_add_f32 v[68:69], v[68:69], v[164:165]
    v_pk_add_f32 v[70:71], v[70:71], v[166:167]
    v_pk_add_f32 v[64:65], v[64:65], v[168:169]
    v_pk_add_f32 v[66:67], v[66:67], v[170:171]
    v_pk_add_f32 v[68:69], v[68:69], v[172:173]
    v_pk_add_f32 v[70:71], v[70:71], v[174:175]
    v_pk_add_f32 v[64:65], v[64:65], v[176:177]
    v_pk_add_f32 v[66:67], v[66:67], v[178:179]
    v_pk_add_f32 v[68:69], v[68:69], v[180:181]
    v_pk_add_f32 v[70:71], v[70:71], v[182:183]
    v_pk_add_f32 v[64:65], v[64:65], v[184:185]
    v_pk_add_f32 v[66:67], v[66:67], v[186:187]
    v_pk_add_f32 v[68:69], v[68:69], v[188:189]
    v_pk_add_f32 v[70:71], v[70:71], v[190:191]
    v_pk_add_f32 v[64:65], v[64:65], v[192:193]
    v_pk_add_f32 v[66:67], v[66:67], v[194:195]
    v_pk_add_f32 v[68:69], v[68:69], v[196:197]
    v_pk_add_f32 v[70:71], v[70:71], v[198:199]
    v_pk_add_f32 v[64:65], v[64:65], v[200:201]
    v_pk_add_f32 v[66:67], v[66:67], v[202:203]
    v_pk_add_f32 v[68:69], v[68:69], v[204:205]
    v_pk_add_f32 v[70:71], v[70:71], v[206:207]
    v_pk_add_f32 v[64:65], v[64:65], v[208:209]
    v_pk_add_f32 v[66:67], v[66:67], v[210:211]
    v_pk_add_f32 v[68:69], v[68:69], v[212:213]
    v_pk_add_f32 v[70:71], v[70:71], v[214:215]
    v_pk_add_f32 v[64:65], v[64:65], v[216:217]
    v_pk_add_f32 v[66:67], v[66:67], v[218:219]
    v_pk_add_f32 v[68:69], v[68:69], v[220:221]
    v_pk_add_f32 v[70:71], v[70:71], v[222:223]
    v_pk_add_f32 v[64:65], v[64:65], v[224:225]
    v_pk_add_f32 v[66:67], v[66:67], v[226:227]
    v_pk_add_f32 v[68:69], v[68:69], v[228:229]
    v_pk_add_f32 v[70:71], v[70:71], v[230:231]
    v_pk_add_f32 v[64:65], v[64:65], v[232:233]
    v_pk_add_f32 v[66:67], v[66:67], v[234:235]
    v_pk_add_f32 v[68:69], v[68:69], v[236:237]
    v_pk_add_f32 v[70:71], v[70:71], v[238:239]
    v_pk_add_f32 v[64:65], v[64:65], v[240:241]
    v_pk_add_f32 v[66:67], v[66:67], v[242:243]
    v_pk_add_f32 v[68:69], v[68:69], v[244:245]
    v_pk_add_f32 v[70:71], v[70:71], v[246:247]
    v_pk_add_f32 v[64:65], v[64:65], v[248:249]
    v_pk_add_f32 v[66:67], v[66:67], v[250:251]
    v_pk_add_f32 v[68:69], v[68:69], v[252:253]
    v_pk_add_f32 v[70:71], v[70:71], v[254:255]
    v_pk_add_f32 v[64:65], v[64:65], v[66:67]
    v_pk_add_f32 v[68:69], v[68:69], v[70:71]
    v_pk_add_f32 v[64:65], v[64:65], v[68:69]
    v_add_f32_e64 v64, v64, v65
    s_nop 1
    v_add_f32_dpp v64, v64, v64 quad_perm:[1,0,3,2] row_mask:0xf bank_mask:0xf
    s_nop 1
    v_add_f32_dpp v64, v64, v64 quad_perm:[2,3,0,1] row_mask:0xf bank_mask:0xf
    v_mul_f32 v72, 0xbacccccd, v64
    v_pk_add_f32 v[96:97], v[96:97], v[72:73] op_sel_hi:[1,0]
    v_pk_add_f32 v[98:99], v[98:99], v[72:73] op_sel_hi:[1,0]
    v_pk_add_f32 v[100:101], v[100:101], v[72:73] op_sel_hi:[1,0]
    v_pk_add_f32 v[102:103], v[102:103], v[72:73] op_sel_hi:[1,0]
    v_pk_add_f32 v[104:105], v[104:105], v[72:73] op_sel_hi:[1,0]
    v_pk_add_f32 v[106:107], v[106:107], v[72:73] op_sel_hi:[1,0]
    v_pk_add_f32 v[108:109], v[108:109], v[72:73] op_sel_hi:[1,0]
    v_pk_add_f32 v[110:111], v[110:111], v[72:73] op_sel_hi:[1,0]
    v_pk_add_f32 v[112:113], v[112:113], v[72:73] op_sel_hi:[1,0]
    v_pk_add_f32 v[114:115], v[114:115], v[72:73] op_sel_hi:[1,0]
    v_pk_add_f32 v[116:117], v[116:117], v[72:73] op_sel_hi:[1,0]
    v_pk_add_f32 v[118:119], v[118:119], v[72:73] op_sel_hi:[1,0]
    v_pk_add_f32 v[120:121], v[120:121], v[72:73] op_sel_hi:[1,0]
    v_pk_add_f32 v[122:123], v[122:123], v[72:73] op_sel_hi:[1,0]
    v_pk_add_f32 v[124:125], v[124:125], v[72:73] op_sel_hi:[1,0]
    v_pk_add_f32 v[126:127], v[126:127], v[72:73] op_sel_hi:[1,0]
    v_pk_add_f32 v[128:129], v[128:129], v[72:73] op_sel_hi:[1,0]
    v_pk_add_f32 v[130:131], v[130:131], v[72:73] op_sel_hi:[1,0]
    v_pk_add_f32 v[132:133], v[132:133], v[72:73] op_sel_hi:[1,0]
    v_pk_add_f32 v[134:135], v[134:135], v[72:73] op_sel_hi:[1,0]
    v_pk_add_f32 v[136:137], v[136:137], v[72:73] op_sel_hi:[1,0]
    v_pk_add_f32 v[138:139], v[138:139], v[72:73] op_sel_hi:[1,0]
    v_pk_add_f32 v[140:141], v[140:141], v[72:73] op_sel_hi:[1,0]
    v_pk_add_f32 v[142:143], v[142:143], v[72:73] op_sel_hi:[1,0]
    v_pk_add_f32 v[144:145], v[144:145], v[72:73] op_sel_hi:[1,0]
    v_pk_add_f32 v[146:147], v[146:147], v[72:73] op_sel_hi:[1,0]
    v_pk_add_f32 v[148:149], v[148:149], v[72:73] op_sel_hi:[1,0]
    v_pk_add_f32 v[150:151], v[150:151], v[72:73] op_sel_hi:[1,0]
    v_pk_add_f32 v[152:153], v[152:153], v[72:73] op_sel_hi:[1,0]
    v_pk_add_f32 v[154:155], v[154:155], v[72:73] op_sel_hi:[1,0]
    v_pk_add_f32 v[156:157], v[156:157], v[72:73] op_sel_hi:[1,0]
    v_pk_add_f32 v[158:159], v[158:159], v[72:73] op_sel_hi:[1,0]
    v_pk_add_f32 v[160:161], v[160:161], v[72:73] op_sel_hi:[1,0]
    v_pk_add_f32 v[162:163], v[162:163], v[72:73] op_sel_hi:[1,0]
    v_pk_add_f32 v[164:165], v[164:165], v[72:73] op_sel_hi:[1,0]
    v_pk_add_f32 v[166:167], v[166:167], v[72:73] op_sel_hi:[1,0]
    v_pk_add_f32 v[168:169], v[168:169], v[72:73] op_sel_hi:[1,0]
    v_pk_add_f32 v[170:171], v[170:171], v[72:73] op_sel_hi:[1,0]
    v_pk_add_f32 v[172:173], v[172:173], v[72:73] op_sel_hi:[1,0]
    v_pk_add_f32 v[174:175], v[174:175], v[72:73] op_sel_hi:[1,0]
    v_pk_add_f32 v[176:177], v[176:177], v[72:73] op_sel_hi:[1,0]
    v_pk_add_f32 v[178:179], v[178:179], v[72:73] op_sel_hi:[1,0]
    v_pk_add_f32 v[180:181], v[180:181], v[72:73] op_sel_hi:[1,0]
    v_pk_add_f32 v[182:183], v[182:183], v[72:73] op_sel_hi:[1,0]
    v_pk_add_f32 v[184:185], v[184:185], v[72:73] op_sel_hi:[1,0]
    v_pk_add_f32 v[186:187], v[186:187], v[72:73] op_sel_hi:[1,0]
    v_pk_add_f32 v[188:189], v[188:189], v[72:73] op_sel_hi:[1,0]
    v_pk_add_f32 v[190:191], v[190:191], v[72:73] op_sel_hi:[1,0]
    v_pk_add_f32 v[192:193], v[192:193], v[72:73] op_sel_hi:[1,0]
    v_pk_add_f32 v[194:195], v[194:195], v[72:73] op_sel_hi:[1,0]
    v_pk_add_f32 v[196:197], v[196:197], v[72:73] op_sel_hi:[1,0]
    v_pk_add_f32 v[198:199], v[198:199], v[72:73] op_sel_hi:[1,0]
    v_pk_add_f32 v[200:201], v[200:201], v[72:73] op_sel_hi:[1,0]
    v_pk_add_f32 v[202:203], v[202:203], v[72:73] op_sel_hi:[1,0]
    v_pk_add_f32 v[204:205], v[204:205], v[72:73] op_sel_hi:[1,0]
    v_pk_add_f32 v[206:207], v[206:207], v[72:73] op_sel_hi:[1,0]
    v_pk_add_f32 v[208:209], v[208:209], v[72:73] op_sel_hi:[1,0]
    v_pk_add_f32 v[210:211], v[210:211], v[72:73] op_sel_hi:[1,0]
    v_pk_add_f32 v[212:213], v[212:213], v[72:73] op_sel_hi:[1,0]
    v_pk_add_f32 v[214:215], v[214:215], v[72:73] op_sel_hi:[1,0]
    v_pk_add_f32 v[216:217], v[216:217], v[72:73] op_sel_hi:[1,0]
    v_pk_add_f32 v[218:219], v[218:219], v[72:73] op_sel_hi:[1,0]
    v_pk_add_f32 v[220:221], v[220:221], v[72:73] op_sel_hi:[1,0]
    v_pk_add_f32 v[222:223], v[222:223], v[72:73] op_sel_hi:[1,0]
    v_pk_add_f32 v[224:225], v[224:225], v[72:73] op_sel_hi:[1,0]
    v_pk_add_f32 v[226:227], v[226:227], v[72:73] op_sel_hi:[1,0]
    v_pk_add_f32 v[228:229], v[228:229], v[72:73] op_sel_hi:[1,0]
    v_pk_add_f32 v[230:231], v[230:231], v[72:73] op_sel_hi:[1,0]
    v_pk_add_f32 v[232:233], v[232:233], v[72:73] op_sel_hi:[1,0]
    v_pk_add_f32 v[234:235], v[234:235], v[72:73] op_sel_hi:[1,0]
    v_pk_add_f32 v[236:237], v[236:237], v[72:73] op_sel_hi:[1,0]
    v_pk_add_f32 v[238:239], v[238:239], v[72:73] op_sel_hi:[1,0]
    v_pk_add_f32 v[240:241], v[240:241], v[72:73] op_sel_hi:[1,0]
    v_pk_add_f32 v[242:243], v[242:243], v[72:73] op_sel_hi:[1,0]
    v_pk_add_f32 v[244:245], v[244:245], v[72:73] op_sel_hi:[1,0]
    v_pk_add_f32 v[246:247], v[246:247], v[72:73] op_sel_hi:[1,0]
    v_pk_add_f32 v[248:249], v[248:249], v[72:73] op_sel_hi:[1,0]
    v_pk_add_f32 v[250:251], v[250:251], v[72:73] op_sel_hi:[1,0]
    v_pk_add_f32 v[252:253], v[252:253], v[72:73] op_sel_hi:[1,0]
    v_pk_add_f32 v[254:255], v[254:255], v[72:73] op_sel_hi:[1,0]
    v_pk_mul_f32 v[64:65], v[96:97], v[96:97]
    v_pk_mul_f32 v[66:67], v[98:99], v[98:99]
    v_pk_mul_f32 v[68:69], v[100:101], v[100:101]
    v_pk_mul_f32 v[70:71], v[102:103], v[102:103]
    v_pk_fma_f32 v[64:65], v[104:105], v[104:105], v[64:65]
    v_pk_fma_f32 v[66:67], v[106:107], v[106:107], v[66:67]
    v_pk_fma_f32 v[68:69], v[108:109], v[108:109], v[68:69]
    v_pk_fma_f32 v[70:71], v[110:111], v[110:111], v[70:71]
    v_pk_fma_f32 v[64:65], v[112:113], v[112:113], v[64:65]
    v_pk_fma_f32 v[66:67], v[114:115], v[114:115], v[66:67]
    v_pk_fma_f32 v[68:69], v[116:117], v[116:117], v[68:69]
    v_pk_fma_f32 v[70:71], v[118:119], v[118:119], v[70:71]
    v_pk_fma_f32 v[64:65], v[120:121], v[120:121], v[64:65]
    v_pk_fma_f32 v[66:67], v[122:123], v[122:123], v[66:67]
    v_pk_fma_f32 v[68:69], v[124:125], v[124:125], v[68:69]
    v_pk_fma_f32 v[70:71], v[126:127], v[126:127], v[70:71]
    v_pk_fma_f32 v[64:65], v[128:129], v[128:129], v[64:65]
    v_pk_fma_f32 v[66:67], v[130:131], v[130:131], v[66:67]
    v_pk_fma_f32 v[68:69], v[132:133], v[132:133], v[68:69]
    v_pk_fma_f32 v[70:71], v[134:135], v[134:135], v[70:71]
    v_pk_fma_f32 v[64:65], v[136:137], v[136:137], v[64:65]
    v_pk_fma_f32 v[66:67], v[138:139], v[138:139], v[66:67]
    v_pk_fma_f32 v[68:69], v[140:141], v[140:141], v[68:69]
    v_pk_fma_f32 v[70:71], v[142:143], v[142:143], v[70:71]
    v_pk_fma_f32 v[64:65], v[144:145], v[144:145], v[64:65]
    v_pk_fma_f32 v[66:67], v[146:147], v[146:147], v[66:67]
    v_pk_fma_f32 v[68:69], v[148:149], v[148:149], v[68:69]
    v_pk_fma_f32 v[70:71], v[150:151], v[150:151], v[70:71]
    v_pk_fma_f32 v[64:65], v[152:153], v[152:153], v[64:65]
    v_pk_fma_f32 v[66:67], v[154:155], v[154:155], v[66:67]
    v_pk_fma_f32 v[68:69], v[156:157], v[156:157], v[68:69]
    v_pk_fma_f32 v[70:71], v[158:159], v[158:159], v[70:71]
    v_pk_fma_f32 v[64:65], v[160:161], v[160:161], v[64:65]
    v_pk_fma_f32 v[66:67], v[162:163], v[162:163], v[66:67]
    v_pk_fma_f32 v[68:69], v[164:165], v[164:165], v[68:69]
    v_pk_fma_f32 v[70:71], v[166:167], v[166:167], v[70:71]
    v_pk_fma_f32 v[64:65], v[168:169], v[168:169], v[64:65]
    v_pk_fma_f32 v[66:67], v[170:171], v[170:171], v[66:67]
    v_pk_fma_f32 v[68:69], v[172:173], v[172:173], v[68:69]
    v_pk_fma_f32 v[70:71], v[174:175], v[174:175], v[70:71]
    v_pk_fma_f32 v[64:65], v[176:177], v[176:177], v[64:65]
    v_pk_fma_f32 v[66:67], v[178:179], v[178:179], v[66:67]
    v_pk_fma_f32 v[68:69], v[180:181], v[180:181], v[68:69]
    v_pk_fma_f32 v[70:71], v[182:183], v[182:183], v[70:71]
    v_pk_fma_f32 v[64:65], v[184:185], v[184:185], v[64:65]
    v_pk_fma_f32 v[66:67], v[186:187], v[186:187], v[66:67]
    v_pk_fma_f32 v[68:69], v[188:189], v[188:189], v[68:69]
    v_pk_fma_f32 v[70:71], v[190:191], v[190:191], v[70:71]
    v_pk_fma_f32 v[64:65], v[192:193], v[192:193], v[64:65]
    v_pk_fma_f32 v[66:67], v[194:195], v[194:195], v[66:67]
    v_pk_fma_f32 v[68:69], v[196:197], v[196:197], v[68:69]
    v_pk_fma_f32 v[70:71], v[198:199], v[198:199], v[70:71]
    v_pk_fma_f32 v[64:65], v[200:201], v[200:201], v[64:65]
    v_pk_fma_f32 v[66:67], v[202:203], v[202:203], v[66:67]
    v_pk_fma_f32 v[68:69], v[204:205], v[204:205], v[68:69]
    v_pk_fma_f32 v[70:71], v[206:207], v[206:207], v[70:71]
    v_pk_fma_f32 v[64:65], v[208:209], v[208:209], v[64:65]
    v_pk_fma_f32 v[66:67], v[210:211], v[210:211], v[66:67]
    v_pk_fma_f32 v[68:69], v[212:213], v[212:213], v[68:69]
    v_pk_fma_f32 v[70:71], v[214:215], v[214:215], v[70:71]
    v_pk_fma_f32 v[64:65], v[216:217], v[216:217], v[64:65]
    v_pk_fma_f32 v[66:67], v[218:219], v[218:219], v[66:67]
    v_pk_fma_f32 v[68:69], v[220:221], v[220:221], v[68:69]
    v_pk_fma_f32 v[70:71], v[222:223], v[222:223], v[70:71]
    v_pk_fma_f32 v[64:65], v[224:225], v[224:225], v[64:65]
    v_pk_fma_f32 v[66:67], v[226:227], v[226:227], v[66:67]
    v_pk_fma_f32 v[68:69], v[228:229], v[228:229], v[68:69]
    v_pk_fma_f32 v[70:71], v[230:231], v[230:231], v[70:71]
    v_pk_fma_f32 v[64:65], v[232:233], v[232:233], v[64:65]
    v_pk_fma_f32 v[66:67], v[234:235], v[234:235], v[66:67]
    v_pk_fma_f32 v[68:69], v[236:237], v[236:237], v[68:69]
    v_pk_fma_f32 v[70:71], v[238:239], v[238:239], v[70:71]
    v_pk_fma_f32 v[64:65], v[240:241], v[240:241], v[64:65]
    v_pk_fma_f32 v[66:67], v[242:243], v[242:243], v[66:67]
    v_pk_fma_f32 v[68:69], v[244:245], v[244:245], v[68:69]
    v_pk_fma_f32 v[70:71], v[246:247], v[246:247], v[70:71]
    v_pk_fma_f32 v[64:65], v[248:249], v[248:249], v[64:65]
    v_pk_fma_f32 v[66:67], v[250:251], v[250:251], v[66:67]
    v_pk_fma_f32 v[68:69], v[252:253], v[252:253], v[68:69]
    v_pk_fma_f32 v[70:71], v[254:255], v[254:255], v[70:71]
    v_pk_add_f32 v[64:65], v[64:65], v[66:67]
    v_pk_add_f32 v[68:69], v[68:69], v[70:71]
    v_pk_add_f32 v[64:65], v[64:65], v[68:69]
    v_add_f32_e64 v64, v64, v65
    s_nop 1
    v_add_f32_dpp v64, v64, v64 quad_perm:[1,0,3,2] row_mask:0xf bank_mask:0xf
    s_nop 1
    v_add_f32_dpp v64, v64, v64 quad_perm:[2,3,0,1] row_mask:0xf bank_mask:0xf
    v_mov_b32 v75, 0x3727c5ac
    v_fmac_f32 v75, 0x3acccccd, v64
    v_mov_b32 v74, v75
    v_rsq_f32 v73, v75
    s_mov_b32 exec_lo, 0x11111111
    s_mov_b32 exec_hi, 0x11111111
    buffer_store_dwordx4 v[72:75], v49, s[44:47], 0 offen sc1
    s_mov_b64 exec, -1
    s_waitcnt vmcnt(0)
    s_branch p1_np2
p1_c3:
p1_gn_ev:
    s_cmp_eq_u32 s58, 8
    s_cbranch_scc1 p1_gn_ev8
    global_load_dword v44, v46, s[84:85] sc1
    global_load_dwordx2 v[48:49], v50, s[84:85] offset:128 sc1
    s_branch p1_gn_evret
p1_gn_ev8:
    s_mov_b32 s59, 196608
    s_mov_b32 s14, 0
    s_mov_b32 s18, 0
    s_mov_b32 s22, 0
    s_mov_b64 s[8:9], s[24:25]
    s_mov_b64 s[10:11], s[26:27]
    s_mov_b64 s[76:77], s[28:29]
    s_mov_b64 s[78:79], s[30:31]
    v_mov_b32 v2, v64
    v_mov_b32 v3, v65
    v_mov_b32 v4, v66
    v_mov_b32 v5, v67
    v_mov_b32 v6, v68
    v_mov_b32 v7, v68
    v_mov_b32 v8, v68
    v_mov_b32_e64 v9, v68
    s_lshl_b32 s56, s48, 12
    s_mov_b32 s53, s88
    s_movk_i32 s74, 16384
    s_movk_i32 s75, 16384
    s_mov_b32 s3, 0x8000
    s_waitcnt vmcnt(12)
    s_mov_b32 s62, 0
p1_gn_chk:
    v_cmp_ne_u32 vcc, 0x01010101, v44
    v_cmp_eq_u32 s[6:7], 0, v49
    s_nop 3
    s_or_b64 s[6:7], s[6:7], vcc
    s_cbranch_scc0 p1_gn_rdy
    s_add_u32 s62, s62, 1
    s_cmp_ge_u32 s62, 0x40000
    s_cbranch_scc1 p1_gn_rdy
    global_load_dword v44, v46, s[84:85] sc1
    global_load_dwordx2 v[48:49], v50, s[84:85] offset:128 sc1
    s_waitcnt vmcnt(0)
    s_branch p1_gn_chk
p1_gn_rdy:
    v_readfirstlane_b32 s100, v48
    v_readfirstlane_b32 s101, v49
    s_add_u32 s84, s86, 34078720
    s_addc_u32 s85, s87, 0
    s_lshl2_add_u32 s61, s50, s48
    s_lshl_b32 s61, s61, 10
    buffer_load_dwordx4 v[28:31], v47, s[44:47], s61 offen offset:0 sc1
    buffer_load_dwordx4 v[32:35], v47, s[44:47], s61 offen offset:256 sc1
    buffer_load_dwordx4 v[36:39], v47, s[44:47], s61 offen offset:512 sc1
    buffer_load_dwordx4 v[40:43], v47, s[44:47], s61 offen offset:768 sc1
    s_branch p1_gn_evret
.p2align 6
p1_gn:
    s_waitcnt lgkmcnt(4)
    v_mfma_f32_16x16x32_bf16 v[128:131], a[176:179], a[144:147], v[128:131]
    ds_read_b64_tr_b16 a[188:189], v18 offset:0
    v_mfma_f32_16x16x32_bf16 v[132:135], a[176:179], a[148:151], v[132:135]
    ds_read_b64_tr_b16 a[190:191], v18 offset:1024
    v_mfma_f32_16x16x32_bf16 v[136:139], a[176:179], a[152:155], v[136:139]
    ds_read_b128 a[160:163], v14 offset:0
    ds_read_b128 a[164:167], v14 offset:2048
    v_mfma_f32_16x16x32_bf16 v[140:143], a[176:179], a[156:159], v[140:143]
    ds_read_b128 a[168:171], v14 offset:4096
    v_mfma_f32_16x16x32_bf16 a[128:131], a[176:179], a[192:195], a[128:131]
    s_waitcnt lgkmcnt(7)
    v_mfma_f32_16x16x32_bf16 v[156:159], a[180:183], a[156:159], v[156:159]
    ds_read_b64_tr_b16 a[176:177], v19 offset:0
    v_mfma_f32_16x16x32_bf16 v[152:155], a[180:183], a[152:155], v[152:155]
    ds_read_b64_tr_b16 a[178:179], v19 offset:1024
    v_mfma_f32_16x16x32_bf16 v[148:151], a[180:183], a[148:151], v[148:151]
    ds_read_b128 a[172:175], v14 offset:6144
    v_mfma_f32_16x16x32_bf16 v[144:147], a[180:183], a[144:147], v[144:147]
    s_add_u32 m0, s56, s74
    s_nop 0
    buffer_load_dwordx4 v6, s[76:79], s53 offen offset:0 lds
    v_mfma_f32_16x16x32_bf16 a[132:135], a[180:183], a[192:195], a[132:135]
    s_waitcnt lgkmcnt(8)
    v_mfma_f32_16x16x32_bf16 v[160:163], a[184:187], a[144:147], v[160:163]
    ds_read_b64_tr_b16 a[180:181], v20 offset:0
    v_mfma_f32_16x16x32_bf16 v[164:167], a[184:187], a[148:151], v[164:167]
    ds_read_b64_tr_b16 a[182:183], v20 offset:1024
    v_mfma_f32_16x16x32_bf16 v[168:171], a[184:187], a[152:155], v[168:171]
    buffer_load_dwordx4 v7, s[76:79], s53 offen offset:1024 lds
    v_mfma_f32_16x16x32_bf16 v[172:175], a[184:187], a[156:159], v[172:175]
    buffer_load_dwordx4 v8, s[76:79], s53 offen offset:2048 lds
    v_xor_b32 v13, 0x18000, v13
    s_waitcnt lgkmcnt(8)
    v_mfma_f32_16x16x32_bf16 v[188:191], a[188:191], a[156:159], v[188:191]
    ds_read_b64_tr_b16 a[184:185], v21 offset:0
    v_mfma_f32_16x16x32_bf16 v[184:187], a[188:191], a[152:155], v[184:187]
    ds_read_b64_tr_b16 a[186:187], v21 offset:1024
    v_mfma_f32_16x16x32_bf16 v[180:183], a[188:191], a[148:151], v[180:183]
    buffer_load_dwordx4 v9, s[76:79], s53 offen offset:3072 lds
    s_add_u32 s53, s53, s75
    s_xor_b32 s56, s56, s3
    v_mfma_f32_16x16x32_bf16 v[176:179], a[188:191], a[144:147], v[176:179]
    s_max_u32 m0, s57, s59
    s_waitcnt lgkmcnt(5)
    v_mfma_f32_16x16x32_bf16 v[192:195], a[176:179], a[144:147], v[192:195]
    ds_read_b64_tr_b16 a[188:189], v22 offset:0
    v_mfma_f32_16x16x32_bf16 v[196:199], a[176:179], a[148:151], v[196:199]
    ds_read_b64_tr_b16 a[190:191], v22 offset:1024
    v_mfma_f32_16x16x32_bf16 v[200:203], a[176:179], a[152:155], v[200:203]
    buffer_load_dwordx4 v10, s[12:15], s54 offen lds
    v_mfma_f32_16x16x32_bf16 v[204:207], a[176:179], a[156:159], v[204:207]
    buffer_load_dwordx4 v11, s[12:15], s54 offen offset:1024 lds
    s_add_u32 s54, s54, 262144
    s_waitcnt lgkmcnt(4)
    v_mfma_f32_16x16x32_bf16 v[220:223], a[180:183], a[156:159], v[220:223]
    v_mfma_f32_16x16x32_bf16 v[216:219], a[180:183], a[152:155], v[216:219]
    v_mfma_f32_16x16x32_bf16 v[212:215], a[180:183], a[148:151], v[212:215]
    s_add_u32 s60, s60, 16384
    s_and_b32 s60, s60, 0xffff
    v_mfma_f32_16x16x32_bf16 v[208:211], a[180:183], a[144:147], v[208:211]
    s_add_u32 s57, s60, s95
    s_waitcnt vmcnt(12) lgkmcnt(0)
    s_barrier
    v_mfma_f32_16x16x32_bf16 v[224:227], a[184:187], a[144:147], v[224:227]
    ds_read_b64_tr_b16 a[176:177], v15 offset:16384
    v_mfma_f32_16x16x32_bf16 v[228:231], a[184:187], a[148:151], v[228:231]
    ds_read_b64_tr_b16 a[178:179], v15 offset:17408
    v_mfma_f32_16x16x32_bf16 v[232:235], a[184:187], a[152:155], v[232:235]
    ds_read_b64_tr_b16 a[180:181], v16 offset:16384
    v_mfma_f32_16x16x32_bf16 v[236:239], a[184:187], a[156:159], v[236:239]
    ds_read_b64_tr_b16 a[182:183], v16 offset:17408
    v_mfma_f32_16x16x32_bf16 v[252:255], a[188:191], a[156:159], v[252:255]
    ds_read_b64_tr_b16 a[184:185], v17 offset:16384
    v_mfma_f32_16x16x32_bf16 v[248:251], a[188:191], a[152:155], v[248:251]
    ds_read_b64_tr_b16 a[186:187], v17 offset:17408
    v_mfma_f32_16x16x32_bf16 v[244:247], a[188:191], a[148:151], v[244:247]
    v_mfma_f32_16x16x32_bf16 v[240:243], a[188:191], a[144:147], v[240:243]
    s_bitcmp1_b32 s93, s58
    s_cbranch_scc1 p1_gn_ev
p1_gn_evret:
    s_waitcnt lgkmcnt(4)
    v_mfma_f32_16x16x32_bf16 v[128:131], a[176:179], a[160:163], v[128:131]
    ds_read_b64_tr_b16 a[188:189], v18 offset:16384
    v_mfma_f32_16x16x32_bf16 v[132:135], a[176:179], a[164:167], v[132:135]
    ds_read_b64_tr_b16 a[190:191], v18 offset:17408
    v_mfma_f32_16x16x32_bf16 v[136:139], a[176:179], a[168:171], v[136:139]
    s_mov_b32 m0, s56
    s_nop 0
    buffer_load_dwordx4 v2, s[8:11], s53 offen offset:0 lds
    v_mfma_f32_16x16x32_bf16 v[140:143], a[176:179], a[172:175], v[140:143]
    buffer_load_dwordx4 v3, s[8:11], s53 offen offset:1024 lds
    buffer_load_dwordx4 v4, s[8:11], s53 offen offset:2048 lds
    v_xor_b32 v14, 0x18000, v14
    v_xor_b32 v15, 0x38000, v15
    v_xor_b32 v16, 0x38000, v16
    v_xor_b32 v17, 0x38000, v17
    v_mfma_f32_16x16x32_bf16 a[128:131], a[176:179], a[192:195], a[128:131]
    s_waitcnt lgkmcnt(4)
    v_mfma_f32_16x16x32_bf16 v[156:159], a[180:183], a[172:175], v[156:159]
    ds_read_b64_tr_b16 a[176:177], v19 offset:16384
    v_mfma_f32_16x16x32_bf16 v[152:155], a[180:183], a[168:171], v[152:155]
    ds_read_b64_tr_b16 a[178:179], v19 offset:17408
    v_mfma_f32_16x16x32_bf16 v[148:151], a[180:183], a[164:167], v[148:151]
    buffer_load_dwordx4 v5, s[8:11], s53 offen offset:3072 lds
    s_max_u32 m0, s57, s59
    v_mfma_f32_16x16x32_bf16 v[144:147], a[180:183], a[160:163], v[144:147]
    buffer_load_dwordx4 v10, s[12:15], s54 offen lds
    buffer_load_dwordx4 v11, s[12:15], s54 offen offset:1024 lds
    v_xor_b32 v18, 0x38000, v18
    v_mfma_f32_16x16x32_bf16 a[132:135], a[180:183], a[192:195], a[132:135]
    s_waitcnt lgkmcnt(4)
    v_mfma_f32_16x16x32_bf16 v[160:163], a[184:187], a[160:163], v[160:163]
    ds_read_b64_tr_b16 a[180:181], v20 offset:16384
    v_mfma_f32_16x16x32_bf16 v[164:167], a[184:187], a[164:167], v[164:167]
    ds_read_b64_tr_b16 a[182:183], v20 offset:17408
    v_mfma_f32_16x16x32_bf16 v[168:171], a[184:187], a[168:171], v[168:171]
    s_add_u32 s54, s54, 262144
    s_add_u32 s60, s60, 16384
    s_and_b32 s60, s60, 0xffff
    v_mfma_f32_16x16x32_bf16 v[172:175], a[184:187], a[172:175], v[172:175]
    s_add_u32 s57, s60, s95
    s_add_u32 s58, s58, 1
    v_xor_b32 v19, 0x38000, v19
    s_waitcnt lgkmcnt(4)
    v_mfma_f32_16x16x32_bf16 v[188:191], a[188:191], a[172:175], v[188:191]
    ds_read_b64_tr_b16 a[184:185], v21 offset:16384
    v_mfma_f32_16x16x32_bf16 v[184:187], a[188:191], a[168:171], v[184:187]
    ds_read_b64_tr_b16 a[186:187], v21 offset:17408
    v_mfma_f32_16x16x32_bf16 v[180:183], a[188:191], a[164:167], v[180:183]
    s_cmp_eq_u32 s58, 10
    s_cbranch_scc1 p1_gn_nw
    s_waitcnt vmcnt(8)
p1_gn_nw:
    v_mfma_f32_16x16x32_bf16 v[176:179], a[188:191], a[160:163], v[176:179]
    ds_read_b128 a[144:147], v13 offset:0
    v_xor_b32 v20, 0x38000, v20
    s_waitcnt lgkmcnt(5)
    v_mfma_f32_16x16x32_bf16 v[192:195], a[176:179], a[160:163], v[192:195]
    ds_read_b64_tr_b16 a[188:189], v22 offset:16384
    v_mfma_f32_16x16x32_bf16 v[196:199], a[176:179], a[164:167], v[196:199]
    ds_read_b64_tr_b16 a[190:191], v22 offset:17408
    v_mfma_f32_16x16x32_bf16 v[200:203], a[176:179], a[168:171], v[200:203]
    ds_read_b128 a[148:151], v13 offset:2048
    v_mfma_f32_16x16x32_bf16 v[204:207], a[176:179], a[172:175], v[204:207]
    ds_read_b128 a[152:155], v13 offset:4096
    v_xor_b32 v21, 0x38000, v21
    s_waitcnt lgkmcnt(7)
    v_mfma_f32_16x16x32_bf16 v[220:223], a[180:183], a[172:175], v[220:223]
    v_mfma_f32_16x16x32_bf16 v[216:219], a[180:183], a[168:171], v[216:219]
    v_mfma_f32_16x16x32_bf16 v[212:215], a[180:183], a[164:167], v[212:215]
    ds_read_b128 a[156:159], v13 offset:6144
    v_mfma_f32_16x16x32_bf16 v[208:211], a[180:183], a[160:163], v[208:211]
    v_xor_b32 v22, 0x38000, v22
    s_waitcnt vmcnt(12) lgkmcnt(0)
    s_barrier
    v_mfma_f32_16x16x32_bf16 v[224:227], a[184:187], a[160:163], v[224:227]
    ds_read_b64_tr_b16 a[176:177], v15 offset:0
    v_mfma_f32_16x16x32_bf16 v[228:231], a[184:187], a[164:167], v[228:231]
    ds_read_b64_tr_b16 a[178:179], v15 offset:1024
    v_mfma_f32_16x16x32_bf16 v[232:235], a[184:187], a[168:171], v[232:235]
    ds_read_b64_tr_b16 a[180:181], v16 offset:0
    v_mfma_f32_16x16x32_bf16 v[236:239], a[184:187], a[172:175], v[236:239]
    ds_read_b64_tr_b16 a[182:183], v16 offset:1024
    v_mfma_f32_16x16x32_bf16 v[252:255], a[188:191], a[172:175], v[252:255]
    ds_read_b64_tr_b16 a[184:185], v17 offset:0
    v_mfma_f32_16x16x32_bf16 v[248:251], a[188:191], a[168:171], v[248:251]
    ds_read_b64_tr_b16 a[186:187], v17 offset:1024
    v_mfma_f32_16x16x32_bf16 v[244:247], a[188:191], a[164:167], v[244:247]
    v_mfma_f32_16x16x32_bf16 v[240:243], a[188:191], a[160:163], v[240:243]
    s_cmp_lt_u32 s58, 10
    s_cbranch_scc1 p1_gn
    ds_write_b128 v52, a[128:131]
    ds_write_b128 v52, a[132:135] offset:64
    s_mov_b32 s88, s53
    s_mov_b32 s89, s56
    s_and_b32 s53, s2, 3
    v_mul_f32 v31, 0x3e0293ee, v29
    v_mul_f32 v29, 0xbfb8aa3b, v29
    v_mul_f32 v35, 0x3e0293ee, v33
    v_mul_f32 v33, 0xbfb8aa3b, v33
    v_mul_f32 v39, 0x3e0293ee, v37
    v_mul_f32 v37, 0xbfb8aa3b, v37
    v_mul_f32 v43, 0x3e0293ee, v41
    v_mul_f32 v41, 0xbfb8aa3b, v41
    v_mov_b32 v48, 0
    v_mov_b32 v49, 0
    v_mov_b32 v50, 0
    v_mov_b32_e64 v51, 0
    s_waitcnt lgkmcnt(0)
    s_barrier
    ds_read_b128 v[14:17], v52
    v_xor_b32 v55, 64, v52
    ds_read_b128 v[18:21], v55
    s_branch p1_gdone
p1_noffn:
    s_lshl_b32 s6, s48, 13
    s_add_u32 m0, s6, 135168
    s_nop 0
    buffer_load_dwordx4 v56, s[40:43], s5 offen offset:0 lds
    s_add_u32 s5, s5, 9216
    buffer_load_dwordx4 v56, s[40:43], s5 offen offset:1024 lds
    s_add_u32 s5, s5, 9216
    buffer_load_dwordx4 v56, s[40:43], s5 offen offset:2048 lds
    s_add_u32 s5, s5, 9216
    buffer_load_dwordx4 v56, s[40:43], s5 offen offset:3072 lds
    s_sub_u32 s5, s5, 27520
    s_mov_b32 m0, s89
    s_nop 0
    buffer_load_dwordx4 v2, s[24:27], s88 offen offset:0 lds
    buffer_load_dwordx4 v3, s[24:27], s88 offen offset:1024 lds
    buffer_load_dwordx4 v4, s[24:27], s88 offen offset:2048 lds
    buffer_load_dwordx4 v5, s[24:27], s88 offen offset:3072 lds
    s_mov_b32 s78, 0x1000000
    s_mov_b32 s79, 0x1000000
    s_barrier
    s_mov_b32 s8, s80
    s_and_b32 s9, s81, 0xffff
    s_mov_b32 s10, 2211840
    s_mov_b32 s11, 0x20000
    v_mov_b32 v136, v57
    v_mov_b32 v137, v58
    v_mov_b32 v138, v59
    v_lshrrev_b32 v56, 4, v1
    v_lshlrev_b32 v56, 1, v56
    v_and_b32 v57, 7, v1
    v_xor_b32 v56, v56, v57
    v_lshlrev_b32 v56, 4, v56
    v_lshrrev_b32_e64 v57, 3, v1
    v_mul_u32_u24 v57, 1280, v57
    v_add_u32_e64 v128, v56, v57
    v_add_u32 v129, 9216, v128
    v_add_u32 v130, 18432, v128
    v_add_u32 v131, 27648, v128
    v_add_u32 v132, 128, v128
    v_add_u32 v133, 9344, v128
    v_add_u32 v134, 18560, v128
    v_add_u32 v135, 27776, v128
    v_bfe_u32 v58, v1, 2, 2
    v_bfe_u32 v60, v1, 4, 1
    v_lshl_add_u32 v58, v60, 2, v58
    v_lshrrev_b32 v57, 1, v58
    v_lshlrev_b32 v57, 5, v57
    v_lshl_add_u32 v57, v58, 7, v57
    v_lshrrev_b32_e64 v59, 5, v1
    v_lshl_add_u32 v57, v59, 10, v57
    v_and_b32 v59, 3, v1
    v_lshl_add_u32 v57, v59, 3, v57
    s_lshl_b32 s6, s48, 13
    s_add_u32 s6, s6, 98304
    v_add_u32 v48, s6, v57
    v_xor_b32 v49, 32, v48
    v_xor_b32_e64 v50, 64, v48
    v_xor_b32 v51, 96, v48
    v_mov_b32 v57, v136
    v_mov_b32 v58, v137
    v_mov_b32_e64 v59, v138
    s_mul_i32 s63, s50, 5
    s_add_u32 s63, s63, s4
    s_lshl2_add_u32 s63, s63, s48
p1_w2j:
    s_mul_hi_u32 s61, s63, 0x33333334
    s_mul_i32 s62, s61, 5
    s_sub_u32 s62, s63, s62
    s_mul_i32 s7, s61, 40960
    s_lshl_b32 s6, s62, 8
    s_add_u32 s61, s7, s6
    s_lshl_b32 s6, s62, 13
    s_add_u32 s7, s7, s6
    s_add_u32 s62, s7, 5242880
    s_lshl_b32 s6, s48, 13
    s_add_u32 m0, s6, 98304
    s_nop 0
    buffer_load_dwordx4 v128, s[8:11], s61 offen offset:0 lds
    buffer_load_dwordx4 v129, s[8:11], s61 offen offset:1024 lds
    buffer_load_dwordx4 v130, s[8:11], s61 offen offset:2048 lds
    buffer_load_dwordx4 v131, s[8:11], s61 offen offset:3072 lds
    s_add_u32 m0, s6, 102400
    s_nop 0
    buffer_load_dwordx4 v132, s[8:11], s61 offen offset:0 lds
    buffer_load_dwordx4 v133, s[8:11], s61 offen offset:1024 lds
    buffer_load_dwordx4 v134, s[8:11], s61 offen offset:2048 lds
    buffer_load_dwordx4 v135, s[8:11], s61 offen offset:3072 lds
    s_waitcnt vmcnt(0)
    ds_read_b64_tr_b16 a[64:65], v48 offset:0
    ds_read_b64_tr_b16 a[66:67], v48 offset:2048
    ds_read_b64_tr_b16 a[68:69], v49 offset:0
    ds_read_b64_tr_b16 a[70:71], v49 offset:2048
    ds_read_b64_tr_b16 a[72:73], v50 offset:0
    ds_read_b64_tr_b16 a[74:75], v50 offset:2048
    ds_read_b64_tr_b16 a[76:77], v51 offset:0
    ds_read_b64_tr_b16 a[78:79], v51 offset:2048
    ds_read_b64_tr_b16 a[80:81], v48 offset:4096
    ds_read_b64_tr_b16 a[82:83], v48 offset:6144
    ds_read_b64_tr_b16 a[84:85], v49 offset:4096
    ds_read_b64_tr_b16 a[86:87], v49 offset:6144
    ds_read_b64_tr_b16 a[88:89], v50 offset:4096
    ds_read_b64_tr_b16 a[90:91], v50 offset:6144
    ds_read_b64_tr_b16 a[92:93], v51 offset:4096
    ds_read_b64_tr_b16 a[94:95], v51 offset:6144
    s_waitcnt lgkmcnt(0)
    buffer_store_dwordx4 a[64:67], v54, s[36:39], s62 offen offset:0 sc1
    buffer_store_dwordx4 a[68:71], v54, s[36:39], s62 offen offset:1024 sc1
    buffer_store_dwordx4 a[72:75], v54, s[36:39], s62 offen offset:2048 sc1
    buffer_store_dwordx4 a[76:79], v54, s[36:39], s62 offen offset:3072 sc1
    s_add_u32 s62, s62, 4096
    buffer_store_dwordx4 a[80:83], v54, s[36:39], s62 offen offset:0 sc1
    buffer_store_dwordx4 a[84:87], v54, s[36:39], s62 offen offset:1024 sc1
    buffer_store_dwordx4 a[88:91], v54, s[36:39], s62 offen offset:2048 sc1
    buffer_store_dwordx4 a[92:95], v54, s[36:39], s62 offen offset:3072 sc1
    s_add_u32 s63, s63, 160
    s_cmp_lt_u32 s63, 270
    s_cbranch_scc1 p1_w2j
    ds_read_b128 v[208:211], v14 offset:0
    ds_read_b128 v[212:215], v15 offset:0
    ds_read_b128 v[216:219], v16 offset:0
    s_waitcnt lgkmcnt(2)
    v_mfma_f32_32x32x16_bf16 v[128:143], v[208:211], v[64:67], 0
    ds_read_b128 v[220:223], v17 offset:0
    v_mfma_f32_32x32x16_bf16 v[144:159], v[208:211], v[96:99], 0
    s_waitcnt lgkmcnt(2)
    v_mfma_f32_32x32x16_bf16 v[128:143], v[212:215], v[68:71], v[128:143]
    ds_read_b128 v[208:211], v18 offset:0
    v_mfma_f32_32x32x16_bf16 v[144:159], v[212:215], v[100:103], v[144:159]
    s_waitcnt lgkmcnt(2)
    v_mfma_f32_32x32x16_bf16 v[128:143], v[216:219], v[72:75], v[128:143]
    ds_read_b128 v[212:215], v19 offset:0
    v_mfma_f32_32x32x16_bf16 v[144:159], v[216:219], v[104:107], v[144:159]
    s_waitcnt lgkmcnt(2)
    v_mfma_f32_32x32x16_bf16 v[128:143], v[220:223], v[76:79], v[128:143]
    ds_read_b128 v[216:219], v20 offset:0
    v_mfma_f32_32x32x16_bf16 v[144:159], v[220:223], v[108:111], v[144:159]
    s_waitcnt lgkmcnt(2)
    v_mfma_f32_32x32x16_bf16 v[128:143], v[208:211], v[80:83], v[128:143]
    ds_read_b128 v[220:223], v21 offset:0
    v_mfma_f32_32x32x16_bf16 v[144:159], v[208:211], v[112:115], v[144:159]
    s_waitcnt lgkmcnt(2)
    v_mfma_f32_32x32x16_bf16 v[128:143], v[212:215], v[84:87], v[128:143]
    v_mfma_f32_32x32x16_bf16 v[144:159], v[212:215], v[116:119], v[144:159]
    s_waitcnt lgkmcnt(1)
    v_mfma_f32_32x32x16_bf16 v[128:143], v[216:219], v[88:91], v[128:143]
    v_mfma_f32_32x32x16_bf16 v[144:159], v[216:219], v[120:123], v[144:159]
    s_waitcnt lgkmcnt(0)
    v_mfma_f32_32x32x16_bf16 v[128:143], v[220:223], v[92:95], v[128:143]
    v_mfma_f32_32x32x16_bf16 v[144:159], v[220:223], v[124:127], v[144:159]
    s_add_u32 m0, s89, 16384
    s_nop 0
    buffer_load_dwordx4 v6, s[28:31], s88 offen offset:0 lds
    buffer_load_dwordx4 v6, s[28:31], s88 offen offset:1024 lds
    buffer_load_dwordx4 v6, s[28:31], s88 offen offset:2048 lds
    buffer_load_dwordx4 v6, s[28:31], s88 offen offset:3072 lds
    s_add_u32 s88, s88, 16384
    s_add_u32 s89, s89, 32768
    s_branch p1_ffnd
p1_oep:
    s_lshl_b32 s89, s49, 14
    v_accvgpr_read_b32 v128, a128
    v_accvgpr_read_b32 v129, a129
    v_accvgpr_read_b32 v130, a130
    v_accvgpr_read_b32 v131, a131
    v_accvgpr_read_b32 v132, a132
    v_accvgpr_read_b32 v133, a133
    v_accvgpr_read_b32 v134, a134
    v_accvgpr_read_b32 v135, a135
    v_accvgpr_read_b32 v136, a136
    v_accvgpr_read_b32 v137, a137
    v_accvgpr_read_b32 v138, a138
    v_accvgpr_read_b32 v139, a139
    v_accvgpr_read_b32 v140, a140
    v_accvgpr_read_b32 v141, a141
    v_accvgpr_read_b32 v142, a142
    v_accvgpr_read_b32 v143, a143
    v_pk_mul_f32 v[128:129], v[128:129], v[44:45] op_sel_hi:[1,0]
    v_pk_mul_f32 v[130:131], v[130:131], v[44:45] op_sel_hi:[1,0]
    v_pk_mul_f32 v[132:133], v[132:133], v[44:45] op_sel_hi:[1,0]
    v_pk_mul_f32 v[134:135], v[134:135], v[44:45] op_sel_hi:[1,0]
    v_pk_mul_f32 v[136:137], v[136:137], v[44:45] op_sel_hi:[1,0]
    v_pk_mul_f32 v[138:139], v[138:139], v[44:45] op_sel_hi:[1,0]
    v_pk_mul_f32 v[140:141], v[140:141], v[44:45] op_sel_hi:[1,0]
    v_pk_mul_f32 v[142:143], v[142:143], v[44:45] op_sel_hi:[1,0]
    v_cvt_pk_bf16_f32 v224, v128, v129
    v_cvt_pk_bf16_f32 v225, v130, v131
    v_cvt_pk_bf16_f32 v226, v132, v133
    v_cvt_pk_bf16_f32 v227, v134, v135
    v_cvt_pk_bf16_f32 v228, v136, v137
    v_cvt_pk_bf16_f32 v229, v138, v139
    v_cvt_pk_bf16_f32 v230, v140, v141
    v_cvt_pk_bf16_f32 v231, v142, v143
    buffer_store_dwordx4 v[224:227], v24, s[32:35], s89 offen offset:0 sc1
    buffer_store_dwordx4 v[228:231], v24, s[32:35], s89 offen offset:512 sc1
    v_accvgpr_read_b32 v144, a192
    v_accvgpr_read_b32 v145, a193
    v_accvgpr_read_b32 v146, a194
    v_accvgpr_read_b32 v147, a195
    v_accvgpr_read_b32 v148, a196
    v_accvgpr_read_b32 v149, a197
    v_accvgpr_read_b32 v150, a198
    v_accvgpr_read_b32 v151, a199
    v_accvgpr_read_b32 v152, a200
    v_accvgpr_read_b32 v153, a201
    v_accvgpr_read_b32 v154, a202
    v_accvgpr_read_b32 v155, a203
    v_accvgpr_read_b32 v156, a204
    v_accvgpr_read_b32 v157, a205
    v_accvgpr_read_b32 v158, a206
    v_accvgpr_read_b32 v159, a207
    v_pk_mul_f32 v[144:145], v[144:145], v[44:45] op_sel:[0,1]
    v_pk_mul_f32 v[146:147], v[146:147], v[44:45] op_sel:[0,1]
    v_pk_mul_f32 v[148:149], v[148:149], v[44:45] op_sel:[0,1]
    v_pk_mul_f32 v[150:151], v[150:151], v[44:45] op_sel:[0,1]
    v_pk_mul_f32 v[152:153], v[152:153], v[44:45] op_sel:[0,1]
    v_pk_mul_f32 v[154:155], v[154:155], v[44:45] op_sel:[0,1]
    v_pk_mul_f32 v[156:157], v[156:157], v[44:45] op_sel:[0,1]
    v_pk_mul_f32 v[158:159], v[158:159], v[44:45] op_sel:[0,1]
    v_cvt_pk_bf16_f32 v232, v144, v145
    v_cvt_pk_bf16_f32 v233, v146, v147
    v_cvt_pk_bf16_f32 v234, v148, v149
    v_cvt_pk_bf16_f32 v235, v150, v151
    v_cvt_pk_bf16_f32 v236, v152, v153
    v_cvt_pk_bf16_f32 v237, v154, v155
    v_cvt_pk_bf16_f32 v238, v156, v157
    v_cvt_pk_bf16_f32 v239, v158, v159
    buffer_store_dwordx4 v[232:235], v24, s[32:35], s89 offen offset:2048 sc1
    buffer_store_dwordx4 v[236:239], v24, s[32:35], s89 offen offset:2560 sc1
    s_add_u32 s89, s89, 4096
    v_accvgpr_read_b32 v160, a144
    v_accvgpr_read_b32 v161, a145
    v_accvgpr_read_b32 v162, a146
    v_accvgpr_read_b32 v163, a147
    v_accvgpr_read_b32 v164, a148
    v_accvgpr_read_b32 v165, a149
    v_accvgpr_read_b32 v166, a150
    v_accvgpr_read_b32 v167, a151
    v_accvgpr_read_b32 v168, a152
    v_accvgpr_read_b32 v169, a153
    v_accvgpr_read_b32 v170, a154
    v_accvgpr_read_b32 v171, a155
    v_accvgpr_read_b32 v172, a156
    v_accvgpr_read_b32 v173, a157
    v_accvgpr_read_b32 v174, a158
    v_accvgpr_read_b32 v175, a159
    v_pk_mul_f32 v[160:161], v[160:161], v[44:45] op_sel_hi:[1,0]
    v_pk_mul_f32 v[162:163], v[162:163], v[44:45] op_sel_hi:[1,0]
    v_pk_mul_f32 v[164:165], v[164:165], v[44:45] op_sel_hi:[1,0]
    v_pk_mul_f32 v[166:167], v[166:167], v[44:45] op_sel_hi:[1,0]
    v_pk_mul_f32 v[168:169], v[168:169], v[44:45] op_sel_hi:[1,0]
    v_pk_mul_f32 v[170:171], v[170:171], v[44:45] op_sel_hi:[1,0]
    v_pk_mul_f32 v[172:173], v[172:173], v[44:45] op_sel_hi:[1,0]
    v_pk_mul_f32 v[174:175], v[174:175], v[44:45] op_sel_hi:[1,0]
    v_cvt_pk_bf16_f32 v240, v160, v161
    v_cvt_pk_bf16_f32 v241, v162, v163
    v_cvt_pk_bf16_f32 v242, v164, v165
    v_cvt_pk_bf16_f32 v243, v166, v167
    v_cvt_pk_bf16_f32 v244, v168, v169
    v_cvt_pk_bf16_f32 v245, v170, v171
    v_cvt_pk_bf16_f32 v246, v172, v173
    v_cvt_pk_bf16_f32 v247, v174, v175
    buffer_store_dwordx4 v[240:243], v24, s[32:35], s89 offen offset:0 sc1
    buffer_store_dwordx4 v[244:247], v24, s[32:35], s89 offen offset:512 sc1
    v_accvgpr_read_b32 v176, a208
    v_accvgpr_read_b32 v177, a209
    v_accvgpr_read_b32 v178, a210
    v_accvgpr_read_b32 v179, a211
    v_accvgpr_read_b32 v180, a212
    v_accvgpr_read_b32 v181, a213
    v_accvgpr_read_b32 v182, a214
    v_accvgpr_read_b32 v183, a215
    v_accvgpr_read_b32 v184, a216
    v_accvgpr_read_b32 v185, a217
    v_accvgpr_read_b32 v186, a218
    v_accvgpr_read_b32 v187, a219
    v_accvgpr_read_b32 v188, a220
    v_accvgpr_read_b32 v189, a221
    v_accvgpr_read_b32 v190, a222
    v_accvgpr_read_b32 v191, a223
    v_pk_mul_f32 v[176:177], v[176:177], v[44:45] op_sel:[0,1]
    v_pk_mul_f32 v[178:179], v[178:179], v[44:45] op_sel:[0,1]
    v_pk_mul_f32 v[180:181], v[180:181], v[44:45] op_sel:[0,1]
    v_pk_mul_f32 v[182:183], v[182:183], v[44:45] op_sel:[0,1]
    v_pk_mul_f32 v[184:185], v[184:185], v[44:45] op_sel:[0,1]
    v_pk_mul_f32 v[186:187], v[186:187], v[44:45] op_sel:[0,1]
    v_pk_mul_f32 v[188:189], v[188:189], v[44:45] op_sel:[0,1]
    v_pk_mul_f32 v[190:191], v[190:191], v[44:45] op_sel:[0,1]
    v_cvt_pk_bf16_f32 v248, v176, v177
    v_cvt_pk_bf16_f32 v249, v178, v179
    v_cvt_pk_bf16_f32 v250, v180, v181
    v_cvt_pk_bf16_f32 v251, v182, v183
    v_cvt_pk_bf16_f32 v252, v184, v185
    v_cvt_pk_bf16_f32 v253, v186, v187
    v_cvt_pk_bf16_f32 v254, v188, v189
    v_cvt_pk_bf16_f32 v255, v190, v191
    buffer_store_dwordx4 v[248:251], v24, s[32:35], s89 offen offset:2048 sc1
    buffer_store_dwordx4 v[252:255], v24, s[32:35], s89 offen offset:2560 sc1
    s_add_u32 s89, s89, 4096
    v_accvgpr_read_b32 v128, a160
    v_accvgpr_read_b32 v129, a161
    v_accvgpr_read_b32 v130, a162
    v_accvgpr_read_b32 v131, a163
    v_accvgpr_read_b32 v132, a164
    v_accvgpr_read_b32 v133, a165
    v_accvgpr_read_b32 v134, a166
    v_accvgpr_read_b32 v135, a167
    v_accvgpr_read_b32 v136, a168
    v_accvgpr_read_b32 v137, a169
    v_accvgpr_read_b32 v138, a170
    v_accvgpr_read_b32 v139, a171
    v_accvgpr_read_b32 v140, a172
    v_accvgpr_read_b32 v141, a173
    v_accvgpr_read_b32 v142, a174
    v_accvgpr_read_b32 v143, a175
    v_pk_mul_f32 v[128:129], v[128:129], v[44:45] op_sel_hi:[1,0]
    v_pk_mul_f32 v[130:131], v[130:131], v[44:45] op_sel_hi:[1,0]
    v_pk_mul_f32 v[132:133], v[132:133], v[44:45] op_sel_hi:[1,0]
    v_pk_mul_f32 v[134:135], v[134:135], v[44:45] op_sel_hi:[1,0]
    v_pk_mul_f32 v[136:137], v[136:137], v[44:45] op_sel_hi:[1,0]
    v_pk_mul_f32 v[138:139], v[138:139], v[44:45] op_sel_hi:[1,0]
    v_pk_mul_f32 v[140:141], v[140:141], v[44:45] op_sel_hi:[1,0]
    v_pk_mul_f32 v[142:143], v[142:143], v[44:45] op_sel_hi:[1,0]
    v_cvt_pk_bf16_f32 v224, v128, v129
    v_cvt_pk_bf16_f32 v225, v130, v131
    v_cvt_pk_bf16_f32 v226, v132, v133
    v_cvt_pk_bf16_f32 v227, v134, v135
    v_cvt_pk_bf16_f32 v228, v136, v137
    v_cvt_pk_bf16_f32 v229, v138, v139
    v_cvt_pk_bf16_f32 v230, v140, v141
    v_cvt_pk_bf16_f32 v231, v142, v143
    buffer_store_dwordx4 v[224:227], v24, s[32:35], s89 offen offset:0 sc1
    buffer_store_dwordx4 v[228:231], v24, s[32:35], s89 offen offset:512 sc1
    v_accvgpr_read_b32 v144, a224
    v_accvgpr_read_b32 v145, a225
    v_accvgpr_read_b32 v146, a226
    v_accvgpr_read_b32 v147, a227
    v_accvgpr_read_b32 v148, a228
    v_accvgpr_read_b32 v149, a229
    v_accvgpr_read_b32 v150, a230
    v_accvgpr_read_b32 v151, a231
    v_accvgpr_read_b32 v152, a232
    v_accvgpr_read_b32 v153, a233
    v_accvgpr_read_b32 v154, a234
    v_accvgpr_read_b32 v155, a235
    v_accvgpr_read_b32 v156, a236
    v_accvgpr_read_b32 v157, a237
    v_accvgpr_read_b32 v158, a238
    v_accvgpr_read_b32 v159, a239
    v_pk_mul_f32 v[144:145], v[144:145], v[44:45] op_sel:[0,1]
    v_pk_mul_f32 v[146:147], v[146:147], v[44:45] op_sel:[0,1]
    v_pk_mul_f32 v[148:149], v[148:149], v[44:45] op_sel:[0,1]
    v_pk_mul_f32 v[150:151], v[150:151], v[44:45] op_sel:[0,1]
    v_pk_mul_f32 v[152:153], v[152:153], v[44:45] op_sel:[0,1]
    v_pk_mul_f32 v[154:155], v[154:155], v[44:45] op_sel:[0,1]
    v_pk_mul_f32 v[156:157], v[156:157], v[44:45] op_sel:[0,1]
    v_pk_mul_f32 v[158:159], v[158:159], v[44:45] op_sel:[0,1]
    v_cvt_pk_bf16_f32 v232, v144, v145
    v_cvt_pk_bf16_f32 v233, v146, v147
    v_cvt_pk_bf16_f32 v234, v148, v149
    v_cvt_pk_bf16_f32 v235, v150, v151
    v_cvt_pk_bf16_f32 v236, v152, v153
    v_cvt_pk_bf16_f32 v237, v154, v155
    v_cvt_pk_bf16_f32 v238, v156, v157
    v_cvt_pk_bf16_f32 v239, v158, v159
    buffer_store_dwordx4 v[232:235], v24, s[32:35], s89 offen offset:2048 sc1
    buffer_store_dwordx4 v[236:239], v24, s[32:35], s89 offen offset:2560 sc1
    s_add_u32 s89, s89, 4096
    v_accvgpr_read_b32 v160, a176
    v_accvgpr_read_b32 v161, a177
    v_accvgpr_read_b32 v162, a178
    v_accvgpr_read_b32 v163, a179
    v_accvgpr_read_b32 v164, a180
    v_accvgpr_read_b32 v165, a181
    v_accvgpr_read_b32 v166, a182
    v_accvgpr_read_b32 v167, a183
    v_accvgpr_read_b32 v168, a184
    v_accvgpr_read_b32 v169, a185
    v_accvgpr_read_b32 v170, a186
    v_accvgpr_read_b32 v171, a187
    v_accvgpr_read_b32 v172, a188
    v_accvgpr_read_b32 v173, a189
    v_accvgpr_read_b32 v174, a190
    v_accvgpr_read_b32 v175, a191
    v_pk_mul_f32 v[160:161], v[160:161], v[44:45] op_sel_hi:[1,0]
    v_pk_mul_f32 v[162:163], v[162:163], v[44:45] op_sel_hi:[1,0]
    v_pk_mul_f32 v[164:165], v[164:165], v[44:45] op_sel_hi:[1,0]
    v_pk_mul_f32 v[166:167], v[166:167], v[44:45] op_sel_hi:[1,0]
    v_pk_mul_f32 v[168:169], v[168:169], v[44:45] op_sel_hi:[1,0]
    v_pk_mul_f32 v[170:171], v[170:171], v[44:45] op_sel_hi:[1,0]
    v_pk_mul_f32 v[172:173], v[172:173], v[44:45] op_sel_hi:[1,0]
    v_pk_mul_f32 v[174:175], v[174:175], v[44:45] op_sel_hi:[1,0]
    v_cvt_pk_bf16_f32 v240, v160, v161
    v_cvt_pk_bf16_f32 v241, v162, v163
    v_cvt_pk_bf16_f32 v242, v164, v165
    v_cvt_pk_bf16_f32 v243, v166, v167
    v_cvt_pk_bf16_f32 v244, v168, v169
    v_cvt_pk_bf16_f32 v245, v170, v171
    v_cvt_pk_bf16_f32 v246, v172, v173
    v_cvt_pk_bf16_f32 v247, v174, v175
    buffer_store_dwordx4 v[240:243], v24, s[32:35], s89 offen offset:0 sc1
    buffer_store_dwordx4 v[244:247], v24, s[32:35], s89 offen offset:512 sc1
    v_accvgpr_read_b32 v176, a240
    v_accvgpr_read_b32 v177, a241
    v_accvgpr_read_b32 v178, a242
    v_accvgpr_read_b32 v179, a243
    v_accvgpr_read_b32 v180, a244
    v_accvgpr_read_b32 v181, a245
    v_accvgpr_read_b32 v182, a246
    v_accvgpr_read_b32 v183, a247
    v_accvgpr_read_b32 v184, a248
    v_accvgpr_read_b32 v185, a249
    v_accvgpr_read_b32 v186, a250
    v_accvgpr_read_b32 v187, a251
    v_accvgpr_read_b32 v188, a252
    v_accvgpr_read_b32 v189, a253
    v_accvgpr_read_b32 v190, a254
    v_accvgpr_read_b32 v191, a255
    v_pk_mul_f32 v[176:177], v[176:177], v[44:45] op_sel:[0,1]
    v_pk_mul_f32 v[178:179], v[178:179], v[44:45] op_sel:[0,1]
    v_pk_mul_f32 v[180:181], v[180:181], v[44:45] op_sel:[0,1]
    v_pk_mul_f32 v[182:183], v[182:183], v[44:45] op_sel:[0,1]
    v_pk_mul_f32 v[184:185], v[184:185], v[44:45] op_sel:[0,1]
    v_pk_mul_f32 v[186:187], v[186:187], v[44:45] op_sel:[0,1]
    v_pk_mul_f32 v[188:189], v[188:189], v[44:45] op_sel:[0,1]
    v_pk_mul_f32 v[190:191], v[190:191], v[44:45] op_sel:[0,1]
    v_cvt_pk_bf16_f32 v248, v176, v177
    v_cvt_pk_bf16_f32 v249, v178, v179
    v_cvt_pk_bf16_f32 v250, v180, v181
    v_cvt_pk_bf16_f32 v251, v182, v183
    v_cvt_pk_bf16_f32 v252, v184, v185
    v_cvt_pk_bf16_f32 v253, v186, v187
    v_cvt_pk_bf16_f32 v254, v188, v189
    v_cvt_pk_bf16_f32 v255, v190, v191
    buffer_store_dwordx4 v[248:251], v24, s[32:35], s89 offen offset:2048 sc1
    buffer_store_dwordx4 v[252:255], v24, s[32:35], s89 offen offset:2560 sc1
    s_branch p1_oed
p1_c4:
p1_qe1:
    global_load_dwordx2 v[32:33], v37, s[84:85] sc1
    s_branch p1_qr1
p1_slow:
    s_waitcnt vmcnt(0) lgkmcnt(0)
    s_mov_b32 s24, s66
    s_and_b32 s25, s67, 0xffff
    s_mov_b32 s26, 16777216
    s_mov_b32 s27, 0x20000
    s_mov_b32 s28, s68
    s_and_b32 s29, s69, 0xffff
    s_mov_b32 s30, 16777216
    s_mov_b32 s31, 0x20000
    v_lshrrev_b32 v56, 4, v1
    v_and_b32 v58, 15, v1
    v_xor_b32 v57, v58, v56
    v_lshlrev_b32_e64 v57, 4, v57
    v_lshl_add_u32 v2, v56, 8, v57
    v_xor_b32_e64 v3, 64, v2
    v_xor_b32 v4, 128, v2
    v_xor_b32 v5, 192, v2
    v_lshlrev_b32 v57, 2, v56
    v_xor_b32 v57, v57, v58
    v_lshlrev_b32 v57, 4, v57
    v_lshl_add_u32 v6, v56, 8, v57
    s_lshl_b32 s62, s48, 13
    s_add_u32 s62, s62, 65536
    v_and_b32 v56, 31, v1
    v_lshrrev_b32 v57, 5, v1
    v_and_b32 v58, 15, v1
    v_xor_b32 v58, v58, v57
    s_lshl_b32 s61, s48, 2
    v_xor_b32 v58, s61, v58
    v_lshlrev_b32_e64 v58, 4, v58
    v_lshl_add_u32 v58, v56, 8, v58
    v_add_u32 v14, s62, v58
    v_xor_b32 v15, 32, v14
    v_xor_b32_e64 v16, 64, v14
    v_xor_b32 v17, 96, v14
    v_xor_b32 v18, 128, v14
    v_xor_b32 v19, 160, v14
    v_xor_b32 v20, 192, v14
    v_xor_b32 v21, 224, v14
    v_bfe_u32 v56, v1, 2, 2
    v_lshl_add_u32 v58, v57, 2, v56
    v_lshlrev_b32_e64 v58, 8, v58
    v_lshl_add_u32 v58, v56, 6, v58
    v_bfe_u32 v59, v1, 1, 1
    v_lshl_add_u32 v58, v59, 5, v58
    v_bfe_u32 v59, v1, 4, 1
    v_lshl_add_u32 v58, v59, 4, v58
    v_and_b32_e64 v59, 1, v1
    v_lshl_add_u32 v58, v59, 3, v58
    s_add_u32 s61, s62, 16384
    v_add_u32 v10, s61, v58
    v_xor_b32 v11, 64, v10
    v_xor_b32 v12, 128, v10
    v_xor_b32 v13, 192, v10
    v_add_u32 v10, 49152, v10
    v_add_u32 v11, 49152, v11
    v_add_u32 v12, 49152, v12
    v_add_u32 v13, 49152, v13
    v_mov_b32 v50, 0xff800000
    v_mov_b32 v51, 0xff800000
    v_mov_b32 v22, 0
    v_mov_b32 v23, 0
    v_mov_b32 v56, 0
    v_mov_b32 v57, 0
    v_mov_b32_e64 v58, 0
    v_mov_b32 v59, 0
    s_nop 1
    v_mfma_f32_32x32x16_bf16 a[128:143], v[56:59], v[56:59], 0
    v_mfma_f32_32x32x16_bf16 a[144:159], v[56:59], v[56:59], 0
    v_mfma_f32_32x32x16_bf16 a[160:175], v[56:59], v[56:59], 0
    v_mfma_f32_32x32x16_bf16 a[176:191], v[56:59], v[56:59], 0
    v_mfma_f32_32x32x16_bf16 a[192:207], v[56:59], v[56:59], 0
    v_mfma_f32_32x32x16_bf16 a[208:223], v[56:59], v[56:59], 0
    v_mfma_f32_32x32x16_bf16 a[224:239], v[56:59], v[56:59], 0
    v_mfma_f32_32x32x16_bf16 a[240:255], v[56:59], v[56:59], 0
    s_mov_b32 s91, 0
p1_sl:
    s_and_b32 s61, s91, 15
    s_lshl_b32 s61, s61, 13
    s_lshl_b32 s88, s49, 19
    s_add_u32 s88, s88, s61
    s_add_u32 s88, s88, 393216
    s_add_u32 m0, s62, 0
    s_nop 0
    buffer_load_dwordx4 v2, s[24:27], s88 offen offset:0 lds
    buffer_load_dwordx4 v3, s[24:27], s88 offen offset:1024 lds
    buffer_load_dwordx4 v4, s[24:27], s88 offen offset:2048 lds
    buffer_load_dwordx4 v5, s[24:27], s88 offen offset:3072 lds
    s_add_u32 m0, s62, 65536
    s_nop 0
    buffer_load_dwordx4 v6, s[28:31], s88 offen offset:0 lds
    buffer_load_dwordx4 v6, s[28:31], s88 offen offset:1024 lds
    buffer_load_dwordx4 v6, s[28:31], s88 offen offset:2048 lds
    buffer_load_dwordx4 v6, s[28:31], s88 offen offset:3072 lds
    s_add_u32 s88, s88, 4096
    s_add_u32 m0, s62, 4096
    s_nop 0
    buffer_load_dwordx4 v2, s[24:27], s88 offen offset:0 lds
    buffer_load_dwordx4 v3, s[24:27], s88 offen offset:1024 lds
    buffer_load_dwordx4 v4, s[24:27], s88 offen offset:2048 lds
    buffer_load_dwordx4 v5, s[24:27], s88 offen offset:3072 lds
    s_add_u32 m0, s62, 69632
    s_nop 0
    buffer_load_dwordx4 v6, s[28:31], s88 offen offset:0 lds
    buffer_load_dwordx4 v6, s[28:31], s88 offen offset:1024 lds
    buffer_load_dwordx4 v6, s[28:31], s88 offen offset:2048 lds
    buffer_load_dwordx4 v6, s[28:31], s88 offen offset:3072 lds
    s_waitcnt vmcnt(0)
    ds_read_b128 v[208:211], v14 offset:0
    s_waitcnt lgkmcnt(0)
    v_mfma_f32_32x32x16_bf16 v[128:143], v[208:211], v[64:67], 0
    v_mfma_f32_32x32x16_bf16 v[144:159], v[208:211], v[96:99], 0
    ds_read_b128 v[212:215], v15 offset:0
    s_waitcnt lgkmcnt(0)
    v_mfma_f32_32x32x16_bf16 v[128:143], v[212:215], v[68:71], v[128:143]
    v_mfma_f32_32x32x16_bf16 v[144:159], v[212:215], v[100:103], v[144:159]
    ds_read_b128 v[216:219], v16 offset:0
    s_waitcnt lgkmcnt(0)
    v_mfma_f32_32x32x16_bf16 v[128:143], v[216:219], v[72:75], v[128:143]
    v_mfma_f32_32x32x16_bf16 v[144:159], v[216:219], v[104:107], v[144:159]
    ds_read_b128 v[220:223], v17 offset:0
    s_waitcnt lgkmcnt(0)
    v_mfma_f32_32x32x16_bf16 v[128:143], v[220:223], v[76:79], v[128:143]
    v_mfma_f32_32x32x16_bf16 v[144:159], v[220:223], v[108:111], v[144:159]
    ds_read_b128 v[208:211], v18 offset:0
    s_waitcnt lgkmcnt(0)
    v_mfma_f32_32x32x16_bf16 v[128:143], v[208:211], v[80:83], v[128:143]
    v_mfma_f32_32x32x16_bf16 v[144:159], v[208:211], v[112:115], v[144:159]
    ds_read_b128 v[212:215], v19 offset:0
    s_waitcnt lgkmcnt(0)
    v_mfma_f32_32x32x16_bf16 v[128:143], v[212:215], v[84:87], v[128:143]
    v_mfma_f32_32x32x16_bf16 v[144:159], v[212:215], v[116:119], v[144:159]
    ds_read_b128 v[216:219], v20 offset:0
    s_waitcnt lgkmcnt(0)
    v_mfma_f32_32x32x16_bf16 v[128:143], v[216:219], v[88:91], v[128:143]
    v_mfma_f32_32x32x16_bf16 v[144:159], v[216:219], v[120:123], v[144:159]
    ds_read_b128 v[220:223], v21 offset:0
    s_waitcnt lgkmcnt(0)
    v_mfma_f32_32x32x16_bf16 v[128:143], v[220:223], v[92:95], v[128:143]
    v_mfma_f32_32x32x16_bf16 v[144:159], v[220:223], v[124:127], v[144:159]
    s_nop 11
    s_cmp_ge_u32 s91, 16
    s_cbranch_scc1 p1_sl2
    v_max3_f32 v50, v128, v129, v50
    v_max3_f32 v50, v130, v131, v50
    v_max3_f32 v50, v132, v133, v50
    v_max3_f32 v50, v134, v135, v50
    v_max3_f32 v50, v136, v137, v50
    v_max3_f32 v50, v138, v139, v50
    v_max3_f32 v50, v140, v141, v50
    v_max3_f32 v50, v142, v143, v50
    v_max3_f32 v51, v144, v145, v51
    v_max3_f32 v51, v146, v147, v51
    v_max3_f32 v51, v148, v149, v51
    v_max3_f32 v51, v150, v151, v51
    v_max3_f32 v51, v152, v153, v51
    v_max3_f32 v51, v154, v155, v51
    v_max3_f32 v51, v156, v157, v51
    v_max3_f32 v51, v158, v159, v51
    s_cmp_lg_u32 s91, 15
    s_cbranch_scc1 p1_sl3
    v_mov_b32 v52, v50
    v_mov_b32 v53, v51
    s_nop 1
    v_permlane32_swap_b32 v52, v50
    v_permlane32_swap_b32 v53, v51
    v_max_f32 v50, v50, v52
    v_max_f32 v51, v51, v53
    s_branch p1_sl3
p1_sl2:
    v_sub_f32 v128, v128, v50
    v_exp_f32 v128, v128
    s_nop 0
    v_add_f32 v22, v22, v128
    v_sub_f32 v129, v129, v50
    v_exp_f32 v129, v129
    s_nop 0
    v_add_f32 v22, v22, v129
    v_cvt_pk_bf16_f32 v192, v128, v129
    v_sub_f32 v130, v130, v50
    v_exp_f32 v130, v130
    s_nop 0
    v_add_f32 v22, v22, v130
    v_sub_f32 v131, v131, v50
    v_exp_f32 v131, v131
    s_nop 0
    v_add_f32 v22, v22, v131
    v_cvt_pk_bf16_f32 v193, v130, v131
    v_sub_f32 v132, v132, v50
    v_exp_f32 v132, v132
    s_nop 0
    v_add_f32 v22, v22, v132
    v_sub_f32 v133, v133, v50
    v_exp_f32 v133, v133
    s_nop 0
    v_add_f32 v22, v22, v133
    v_cvt_pk_bf16_f32 v194, v132, v133
    v_sub_f32 v134, v134, v50
    v_exp_f32 v134, v134
    s_nop 0
    v_add_f32 v22, v22, v134
    v_sub_f32 v135, v135, v50
    v_exp_f32 v135, v135
    s_nop 0
    v_add_f32 v22, v22, v135
    v_cvt_pk_bf16_f32 v195, v134, v135
    v_sub_f32 v144, v144, v51
    v_exp_f32 v144, v144
    s_nop 0
    v_add_f32 v23, v23, v144
    v_sub_f32 v145, v145, v51
    v_exp_f32 v145, v145
    s_nop 0
    v_add_f32 v23, v23, v145
    v_cvt_pk_bf16_f32 v200, v144, v145
    v_sub_f32 v146, v146, v51
    v_exp_f32 v146, v146
    s_nop 0
    v_add_f32 v23, v23, v146
    v_sub_f32 v147, v147, v51
    v_exp_f32 v147, v147
    s_nop 0
    v_add_f32 v23, v23, v147
    v_cvt_pk_bf16_f32 v201, v146, v147
    v_sub_f32 v148, v148, v51
    v_exp_f32 v148, v148
    s_nop 0
    v_add_f32 v23, v23, v148
    v_sub_f32 v149, v149, v51
    v_exp_f32 v149, v149
    s_nop 0
    v_add_f32 v23, v23, v149
    v_cvt_pk_bf16_f32 v202, v148, v149
    v_sub_f32 v150, v150, v51
    v_exp_f32 v150, v150
    s_nop 0
    v_add_f32 v23, v23, v150
    v_sub_f32 v151, v151, v51
    v_exp_f32 v151, v151
    s_nop 0
    v_add_f32 v23, v23, v151
    v_cvt_pk_bf16_f32 v203, v150, v151
    v_sub_f32 v136, v136, v50
    v_exp_f32 v136, v136
    s_nop 0
    v_add_f32 v22, v22, v136
    v_sub_f32 v137, v137, v50
    v_exp_f32 v137, v137
    s_nop 0
    v_add_f32 v22, v22, v137
    v_cvt_pk_bf16_f32 v196, v136, v137
    v_sub_f32 v138, v138, v50
    v_exp_f32 v138, v138
    s_nop 0
    v_add_f32 v22, v22, v138
    v_sub_f32 v139, v139, v50
    v_exp_f32 v139, v139
    s_nop 0
    v_add_f32 v22, v22, v139
    v_cvt_pk_bf16_f32 v197, v138, v139
    v_sub_f32 v140, v140, v50
    v_exp_f32 v140, v140
    s_nop 0
    v_add_f32 v22, v22, v140
    v_sub_f32 v141, v141, v50
    v_exp_f32 v141, v141
    s_nop 0
    v_add_f32 v22, v22, v141
    v_cvt_pk_bf16_f32 v198, v140, v141
    v_sub_f32 v142, v142, v50
    v_exp_f32 v142, v142
    s_nop 0
    v_add_f32 v22, v22, v142
    v_sub_f32 v143, v143, v50
    v_exp_f32 v143, v143
    s_nop 0
    v_add_f32 v22, v22, v143
    v_cvt_pk_bf16_f32 v199, v142, v143
    v_sub_f32 v152, v152, v51
    v_exp_f32 v152, v152
    s_nop 0
    v_add_f32 v23, v23, v152
    v_sub_f32 v153, v153, v51
    v_exp_f32 v153, v153
    s_nop 0
    v_add_f32 v23, v23, v153
    v_cvt_pk_bf16_f32 v204, v152, v153
    v_sub_f32 v154, v154, v51
    v_exp_f32 v154, v154
    s_nop 0
    v_add_f32 v23, v23, v154
    v_sub_f32 v155, v155, v51
    v_exp_f32 v155, v155
    s_nop 0
    v_add_f32 v23, v23, v155
    v_cvt_pk_bf16_f32 v205, v154, v155
    v_sub_f32 v156, v156, v51
    v_exp_f32 v156, v156
    s_nop 0
    v_add_f32 v23, v23, v156
    v_sub_f32 v157, v157, v51
    v_exp_f32 v157, v157
    s_nop 0
    v_add_f32 v23, v23, v157
    v_cvt_pk_bf16_f32 v206, v156, v157
    v_sub_f32 v158, v158, v51
    v_exp_f32 v158, v158
    s_nop 0
    v_add_f32 v23, v23, v158
    v_sub_f32 v159, v159, v51
    v_exp_f32 v159, v159
    s_nop 0
    v_add_f32 v23, v23, v159
    v_cvt_pk_bf16_f32 v207, v158, v159
    ds_read_b64_tr_b16 v[208:209], v10 offset:0
    ds_read_b64_tr_b16 v[210:211], v10 offset:2048
    s_waitcnt lgkmcnt(0)
    v_mfma_f32_32x32x16_bf16 a[128:143], v[208:211], v[192:195], a[128:143]
    v_mfma_f32_32x32x16_bf16 a[192:207], v[208:211], v[200:203], a[192:207]
    ds_read_b64_tr_b16 v[212:213], v11 offset:0
    ds_read_b64_tr_b16 v[214:215], v11 offset:2048
    s_waitcnt lgkmcnt(0)
    v_mfma_f32_32x32x16_bf16 a[144:159], v[212:215], v[192:195], a[144:159]
    v_mfma_f32_32x32x16_bf16 a[208:223], v[212:215], v[200:203], a[208:223]
    ds_read_b64_tr_b16 v[216:217], v12 offset:0
    ds_read_b64_tr_b16 v[218:219], v12 offset:2048
    s_waitcnt lgkmcnt(0)
    v_mfma_f32_32x32x16_bf16 a[160:175], v[216:219], v[192:195], a[160:175]
    v_mfma_f32_32x32x16_bf16 a[224:239], v[216:219], v[200:203], a[224:239]
    ds_read_b64_tr_b16 v[220:221], v13 offset:0
    ds_read_b64_tr_b16 v[222:223], v13 offset:2048
    s_waitcnt lgkmcnt(0)
    v_mfma_f32_32x32x16_bf16 a[176:191], v[220:223], v[192:195], a[176:191]
    v_mfma_f32_32x32x16_bf16 a[240:255], v[220:223], v[200:203], a[240:255]
    ds_read_b64_tr_b16 v[208:209], v10 offset:4096
    ds_read_b64_tr_b16 v[210:211], v10 offset:6144
    s_waitcnt lgkmcnt(0)
    v_mfma_f32_32x32x16_bf16 a[128:143], v[208:211], v[196:199], a[128:143]
    v_mfma_f32_32x32x16_bf16 a[192:207], v[208:211], v[204:207], a[192:207]
    ds_read_b64_tr_b16 v[212:213], v11 offset:4096
    ds_read_b64_tr_b16 v[214:215], v11 offset:6144
    s_waitcnt lgkmcnt(0)
    v_mfma_f32_32x32x16_bf16 a[144:159], v[212:215], v[196:199], a[144:159]
    v_mfma_f32_32x32x16_bf16 a[208:223], v[212:215], v[204:207], a[208:223]
    ds_read_b64_tr_b16 v[216:217], v12 offset:4096
    ds_read_b64_tr_b16 v[218:219], v12 offset:6144
    s_waitcnt lgkmcnt(0)
    v_mfma_f32_32x32x16_bf16 a[160:175], v[216:219], v[196:199], a[160:175]
    v_mfma_f32_32x32x16_bf16 a[224:239], v[216:219], v[204:207], a[224:239]
    ds_read_b64_tr_b16 v[220:221], v13 offset:4096
    ds_read_b64_tr_b16 v[222:223], v13 offset:6144
    s_waitcnt lgkmcnt(0)
    v_mfma_f32_32x32x16_bf16 a[176:191], v[220:223], v[196:199], a[176:191]
    v_mfma_f32_32x32x16_bf16 a[240:255], v[220:223], v[204:207], a[240:255]
p1_sl3:
    s_add_u32 s91, s91, 1
    s_cmp_lt_u32 s91, 32
    s_cbranch_scc1 p1_sl
    v_mov_b32 v44, v22
    v_mov_b32 v45, v23
    s_nop 1
    v_permlane32_swap_b32 v44, v22
    v_permlane32_swap_b32 v45, v23
    v_add_f32 v22, v22, v44
    v_add_f32 v23, v23, v45
    v_rcp_f32 v44, v22
    v_rcp_f32 v45, v23
    s_nop 7
    s_branch p1_oep
p1_last:
.section .rodata,"a"
.p2align 6
.amdhsa_kernel recurrent_scan__sliding_block_cached__glu_gated_swiglu__prompt_kernel
.amdhsa_next_free_vgpr 512
.amdhsa_next_free_sgpr 102
.amdhsa_accum_offset 256
.amdhsa_group_segment_fixed_size 0
.amdhsa_kernarg_size 96
.amdhsa_user_sgpr_count 2
.amdhsa_user_sgpr_kernarg_segment_ptr 1
.amdhsa_system_sgpr_workgroup_id_x 1
.amdhsa_float_denorm_mode_32 3
.end_amdhsa_kernel
.text
```
